```python
import torch

def _softmax(x, axis=-1):
    return torch.softmax(x, dim=axis)
def _gelu(x):
    return torch.nn.functional.gelu(x, approximate="tanh")
def _silu(x):
    return torch.nn.functional.silu(x)
def _sigmoid(x):
    return torch.sigmoid(x)
def _layernorm(x, axis=-1, eps=1e-5):
    m = x.mean(dim=axis, keepdim=True)
    v = x.var(dim=axis, keepdim=True, unbiased=False)
    return (x - m) / torch.sqrt(v + eps)
def _scatter_add(tgt, idx, src, axis=0):
    return tgt.clone().index_add_(axis, idx, src)
def _segment_sum(src, seg, n):
    out = torch.zeros((n,) + src.shape[1:], dtype=src.dtype)
    return out.index_add_(0, seg, src)
def _pad(x, pw):
    flat = tuple(v for pair in reversed(pw) for v in pair)
    return torch.nn.functional.pad(x, flat)

kernel_name = 'gated_mix__linear_kernel_hedgehog__glu_gated_bilinear__prompt'

def setup_inputs():

    _w = (lambda a: (lambda t: t.to(torch.bfloat16) if t.is_floating_point() else t)(torch.as_tensor(a)))
    def _A_setup():
        B, S, D, H = 1, 2048, 512, 32
        Dh = D // H
        return {
            "x": _w((lambda *s: torch.randn(*s, dtype=torch.bfloat16) * 0.05)(B, S, D)),
            "wqkv": _w((lambda *s: torch.randn(*s, dtype=torch.bfloat16) * 0.8)(D, 3 * D)),
            "w_phi": _w((lambda *s: torch.randn(*s, dtype=torch.bfloat16) * 0.8)(H, Dh, Dh) * (Dh ** -0.5)),
            "wo": _w((lambda *s: torch.randn(*s, dtype=torch.bfloat16) * 0.05)(D, D)),
        }
    _A_in = _A_setup()

    def _B_setup():
        B, S, D, F = 1, 2048, 512, 1376
        return {
            "x": _w((lambda *s: torch.randn(*s, dtype=torch.bfloat16) * 0.05)(B, S, D)),
            "w_gate": _w((lambda *s: torch.randn(*s, dtype=torch.bfloat16) * 1.6)(D, F) * (D ** -0.5)),
            "w_up": _w((lambda *s: torch.randn(*s, dtype=torch.bfloat16) * 1.6)(D, F) * (D ** -0.5)),
            "w_down": _w((lambda *s: torch.randn(*s, dtype=torch.bfloat16) * 1.6)(F, D) * (F ** -0.5)),
        }
    _B_in = _B_setup()

    return {
        "A_x": _A_in["x"],
        "A_wqkv": _A_in["wqkv"],
        "A_w_phi": _A_in["w_phi"],
        "A_wo": _A_in["wo"],
        "B_x": _B_in["x"],
        "B_w_gate": _B_in["w_gate"],
        "B_w_up": _B_in["w_up"],
        "B_w_down": _B_in["w_down"],
        "gate_w": _w((lambda *s: torch.randn(*s, dtype=torch.bfloat16) * 0.05)(512) * 16.0),
    }

def reference(A_x, A_wqkv, A_w_phi, A_wo, B_x, B_w_gate, B_w_up, B_w_down, gate_w):
    def _A_ref(x, wqkv, w_phi, wo):
        B, S, D = x.shape
        H = 32; Dh = D // H
        qkv = (lambda x, *d: x.permute(*d))((x @ wqkv).reshape(B, S, 3, H, Dh), 2, 0, 3, 1, 4)
        q, k, v = qkv[0], qkv[1], qkv[2]
        pq = torch.einsum("bhsd,hdf->bhsf", q, w_phi)
        pk = torch.einsum("bhsd,hdf->bhsf", k, w_phi)
        phi_q = torch.concatenate([_softmax(pq, axis=-1), _softmax(-pq, axis=-1)], axis=-1)
        phi_k = torch.concatenate([_softmax(pk, axis=-1), _softmax(-pk, axis=-1)], axis=-1)
        kv = torch.einsum("bhsf,bhsd->bhfd", phi_k, v)
        z  = torch.einsum("bhsf->bhf", phi_k)
        num = torch.einsum("bhqf,bhfd->bhqd", phi_q, kv)
        den = torch.einsum("bhqf,bhf->bhq", phi_q, z)[..., None] + 1e-6
        o = num / den
        return (lambda x, *d: x.permute(*d))(o, 0, 2, 1, 3).reshape(B, S, D) @ wo

    def _B_ref(x, w_gate, w_up, w_down):
        g = torch.einsum("bsd,df->bsf", x, w_gate)
        u = torch.einsum("bsd,df->bsf", x, w_up)
        h = g * u
        return torch.einsum("bsf,fd->bsd", h, w_down)

    x = A_x
    g = _sigmoid((x * gate_w).sum(-1, keepdims=True))
    a = _A_ref(x, A_wqkv, A_w_phi, A_wo)
    b = _B_ref(x, B_w_gate, B_w_up, B_w_down)
    return g * a + (1 - g) * b
```

```asm
; @launch grid=(256,1,1) block=(256,1,1) lds=163840
.amdgcn_target "amdgcn-amd-amdhsa--gfx950"
.text
.globl gated_mix__linear_kernel_hedgehog__glu_gated_bilinear__prompt_kernel
.p2align 8
.type gated_mix__linear_kernel_hedgehog__glu_gated_bilinear__prompt_kernel,@function
gated_mix__linear_kernel_hedgehog__glu_gated_bilinear__prompt_kernel:
    s_cmp_ge_u32 s2, 256
    s_cbranch_scc1 L_end
    s_load_dwordx16 s[48:63], s[0:1], 0
    s_load_dwordx8 s[64:71], s[0:1], 64
    v_lshrrev_b32 v1, 6, v0
    v_and_b32 v255, 63, v0
    s_getpc_b64 s[4:5]
L_pc:
    v_readfirstlane_b32 s91, v1
    s_mov_b32 s6, 64288
    s_mov_b32 s7, 0x20000
    s_lshr_b32 s101, s2, 3
    s_mul_i32 s8, s101, 2048
    v_min_u32 v2, 16, v0
    v_lshlrev_b32 v2, 7, v2
    buffer_load_dword v3, v2, s[4:7], s8 offen
    s_and_b32 s3, s2, 7
    s_and_b32 s100, s101, 3
    s_lshr_b32 s99, s101, 2
    s_lshl_b32 s98, s3, 2
    s_add_u32 s98, s98, s100
    s_and_b32 s94, s3, 1
    s_lshl_b32 s94, s94, 3
    s_and_b32 s9, s101, 7
    s_add_u32 s94, s94, s9
    s_lshr_b32 s10, s101, 3
    s_mul_i32 s96, s10, 0
    s_mul_i32 s9, s9, 2
    s_add_u32 s96, s96, s9
    s_and_b32 s9, s3, 1
    s_mul_i32 s9, s9, 1
    s_add_u32 s96, s96, s9
    s_lshr_b32 s9, s3, 1
    s_mul_i32 s9, s9, 2
    s_add_u32 s96, s96, s9
    s_and_b32 s95, s3, 6
    s_and_b32 s9, s10, 1
    s_add_u32 s95, s95, s9
    s_and_b32 s92, s91, 1
    s_lshr_b32 s93, s91, 1
    s_lshl_b32 s97, s91, 12
    s_mov_b32 s86, s10
    s_mov_b32 s30, 0x20000
    s_mov_b32 s31, 0x20000
    s_mov_b32 s34, 0x180000
    s_mov_b32 s35, 0x20000
    s_mov_b32 s42, 0x7f5000
    s_mov_b32 s43, 0x20000
    s_mov_b32 s78, 0x4000
    s_mov_b32 s79, 0x20000
    s_mov_b32 s82, 0x400
    s_mov_b32 s83, 0x20000
    s_mov_b32 s46, 0x100
    s_mov_b32 s47, 0x20000
    s_mov_b32 s38, 0x158000
    s_mov_b32 s39, 0x20000
    s_add_u32 s4, s96, 0
    s_and_b32 s4, s4, 7
    s_mul_i32 s4, s4, 128
    s_add_u32 s5, s96, 1
    s_and_b32 s5, s5, 7
    s_mul_i32 s5, s5, 128
    s_lshl_b32 s101, s91, 15
    v_lshrrev_b32 v5, 3, v255
    v_lshl_add_u32 v4, v5, 10, s101
    v_and_b32 v8, 7, v255
    v_lshrrev_b32 v9, 4, v255
    v_xor_b32 v7, v8, v9
    v_lshlrev_b32 v6, 4, v7
    v_add_u32 v226, v4, v6
    v_add_u32 v11, 7, v5
    v_lshl_add_u32 v10, v11, 10, s101
    v_add_u32 v14, 4, v9
    v_xor_b32 v13, v8, v14
    v_lshlrev_b32 v12, 4, v13
    v_add_u32 v227, v10, v12
    v_add_u32 v16, 14, v5
    v_lshl_add_u32 v15, v16, 10, s101
    v_add_u32 v228, v15, v6
    v_add_u32 v18, 21, v5
    v_lshl_add_u32 v17, v18, 10, s101
    v_add_u32 v229, v17, v12
    v_lshlrev_b32 v244, 4, v255
    v_min_u32 v19, 1, v255
    v_lshlrev_b32 v237, 31, v19
    s_cmp_lt_u32 s86, 2
    s_cbranch_scc1 L_role_kv
    s_cmp_eq_u32 s95, 7
    s_cbranch_scc1 L_role_qg
L_role_q:
    s_add_u32 s20, s96, 0
    s_and_b32 s20, s20, 7
    s_mul_i32 s20, s20, 176128
    s_add_u32 s21, s96, 1
    s_and_b32 s21, s21, 7
    s_mul_i32 s21, s21, 176128
    s_mul_i32 s13, s95, 7
    s_add_u32 s13, s13, 32
    s_cmp_ge_u32 s95, 6
    s_cselect_b32 s101, 1, 0
    s_sub_u32 s13, s13, s101
    s_mul_i32 s101, s92, 22016
    s_lshl_b32 s3, s13, 5
    s_add_u32 s101, s101, s3
    v_lshl_add_u32 v240, v255, 4, s101
    s_movk_i32 s3, 2528
    s_movk_i32 s87, 2752
    v_mul_u32_u24 v5, 0x124a, v255
    v_lshrrev_b32 v4, 16, v5
    v_and_b32 v241, 24, v4
    v_mad_u32_u24 v176, v4, s3, v240
    v_mad_u32_u24 v176, v241, s87, v176
    v_add_u32 v7, 0x49280, v5
    v_lshrrev_b32 v6, 16, v7
    v_and_b32 v241, 24, v6
    v_mad_u32_u24 v177, v6, s3, v240
    v_mad_u32_u24 v177, v241, s87, v177
    v_add_u32 v9, 0x92500, v5
    v_lshrrev_b32 v8, 16, v9
    v_and_b32 v241, 24, v8
    v_mad_u32_u24 v178, v8, s3, v240
    v_mad_u32_u24 v178, v241, s87, v178
    v_add_u32 v11, 0xdb780, v5
    v_lshrrev_b32 v10, 16, v11
    v_and_b32 v241, 24, v10
    v_mad_u32_u24 v179, v10, s3, v240
    v_mad_u32_u24 v179, v241, s87, v179
    v_add_u32 v240, 0x1000, v240
    v_add_u32 v13, 0x124a00, v5
    v_lshrrev_b32 v12, 16, v13
    v_and_b32 v241, 24, v12
    v_mad_u32_u24 v180, v12, s3, v240
    v_mad_u32_u24 v180, v241, s87, v180
    v_add_u32 v15, 0x16dc80, v5
    v_lshrrev_b32 v14, 16, v15
    v_and_b32 v241, 24, v14
    v_mad_u32_u24 v181, v14, s3, v240
    v_mad_u32_u24 v181, v241, s87, v181
    v_add_u32 v17, 0x1b6f00, v5
    v_lshrrev_b32 v16, 16, v17
    v_and_b32 v241, 24, v16
    v_mad_u32_u24 v182, v16, s3, v240
    v_mad_u32_u24 v182, v241, s87, v182
    s_mul_i32 s12, s93, 14464
    s_mul_i32 s101, s92, 7296
    s_add_u32 s12, s12, s101
    s_add_u32 s12, s12, 16384
    s_waitcnt lgkmcnt(0)
    s_mov_b64 s[28:29], s[48:49]
    s_mov_b64 s[32:33], s[50:51]
    s_mov_b64 s[36:37], s[58:59]
    s_mov_b64 s[84:85], s[60:61]
    s_mov_b64 s[40:41], s[70:71]
    s_mov_b64 s[76:77], s[52:53]
    s_mov_b64 s[80:81], s[64:65]
    s_mov_b64 s[44:45], s[68:69]
    s_lshl_b32 s101, s94, 17
    s_add_u32 s28, s28, s101
    s_addc_u32 s29, s29, 0
    s_cmp_ge_u32 s91, 2
    s_cselect_b32 s36, s84, s36
    s_cselect_b32 s37, s85, s37
    s_add_u32 m0, s97, 0
    s_nop 0
    buffer_load_dwordx4 v226, s[28:31], s4 offen lds
    buffer_load_dwordx4 v227, s[28:31], s4 offen offset:1024 lds
    buffer_load_dwordx4 v228, s[28:31], s4 offen offset:2048 lds
    buffer_load_dwordx4 v229, s[28:31], s4 offen offset:3072 lds
    s_add_u32 m0, s12, 0
    s_nop 0
    buffer_load_dwordx4 v176, s[36:39], s20 offen lds
    buffer_load_dwordx4 v177, s[36:39], s20 offen offset:1024 lds
    buffer_load_dwordx4 v178, s[36:39], s20 offen offset:2048 lds
    buffer_load_dwordx4 v179, s[36:39], s20 offen offset:3072 lds
    s_add_u32 m0, s12, 4096
    s_nop 0
    buffer_load_dwordx4 v180, s[36:39], s20 offen lds
    buffer_load_dwordx4 v181, s[36:39], s20 offen offset:1024 lds
    buffer_load_dwordx4 v182, s[36:39], s20 offen offset:2048 lds
    s_lshl_b32 s101, s91, 10
    s_add_u32 m0, s101, 149504
    s_lshl_b32 s3, s95, 11
    s_lshl_b32 s101, s93, 10
    s_add_u32 s3, s3, s101
    buffer_load_dwordx4 v244, s[76:79], s3 offen lds
    s_add_u32 m0, s97, 45312
    s_nop 0
    buffer_load_dwordx4 v226, s[28:31], s5 offen lds
    buffer_load_dwordx4 v227, s[28:31], s5 offen offset:1024 lds
    buffer_load_dwordx4 v228, s[28:31], s5 offen offset:2048 lds
    buffer_load_dwordx4 v229, s[28:31], s5 offen offset:3072 lds
    s_add_u32 m0, s12, 45312
    s_nop 0
    buffer_load_dwordx4 v176, s[36:39], s21 offen lds
    buffer_load_dwordx4 v177, s[36:39], s21 offen offset:1024 lds
    buffer_load_dwordx4 v178, s[36:39], s21 offen offset:2048 lds
    buffer_load_dwordx4 v179, s[36:39], s21 offen offset:3072 lds
    s_branch L_body_q
L_role_kv:
    s_add_u32 s12, s96, 0
    s_and_b32 s12, s12, 7
    s_mul_i32 s12, s12, 196608
    s_add_u32 s13, s96, 1
    s_and_b32 s13, s13, 7
    s_mul_i32 s13, s13, 196608
    s_mul_i32 s101, s92, 98304
    s_lshl_b32 s3, s93, 10
    s_add_u32 s101, s101, s3
    s_lshl_b32 s3, s95, 7
    s_add_u32 s101, s101, s3
    s_add_u32 s101, s101, 1024
    v_lshrrev_b32 v10, 3, v255
    v_mul_u32_u24 v9, 0xc00, v10
    v_add_u32 v8, s101, v9
    v_and_b32 v14, 7, v255
    v_lshrrev_b32 v13, 1, v14
    v_bfe_u32 v15, v255, 4, 1
    v_xor_b32 v12, v13, v15
    v_and_b32 v17, 1, v255
    v_lshlrev_b32 v16, 4, v17
    v_lshl_add_u32 v11, v12, 5, v16
    v_add_u32 v68, v8, v11
    v_add_u32 v19, 0x5c00, v9
    v_add_u32 v18, s101, v19
    v_xor_b32 v21, 2, v12
    v_lshl_add_u32 v20, v21, 5, v16
    v_add_u32 v69, v18, v20
    v_add_u32 v23, 0xb800, v9
    v_add_u32 v22, s101, v23
    v_add_u32 v70, v22, v11
    v_add_u32 v25, 0x11400, v9
    v_add_u32 v24, s101, v25
    v_add_u32 v71, v24, v20
    s_lshl_b32 s73, s95, 2
    s_add_u32 s73, s73, s91
    s_mul_i32 s75, s73, 2176
    s_add_u32 s75, s75, 7741440
    s_lshl_b32 s73, s73, 2
    v_min_u32 v26, 1, v10
    v_lshlrev_b32 v27, 4, v255
    v_lshl_add_u32 v239, v26, 31, v27
    v_mov_b32 v60, 0
    v_mov_b32 v61, 0
    v_mov_b32 v62, 0
    v_mov_b32 v63, 0
    s_waitcnt lgkmcnt(0)
    s_mov_b64 s[28:29], s[48:49]
    s_mov_b64 s[32:33], s[50:51]
    s_mov_b64 s[36:37], s[58:59]
    s_mov_b64 s[84:85], s[60:61]
    s_mov_b64 s[40:41], s[70:71]
    s_mov_b64 s[76:77], s[52:53]
    s_mov_b64 s[80:81], s[64:65]
    s_mov_b64 s[44:45], s[68:69]
    s_lshl_b32 s101, s94, 17
    s_add_u32 s28, s28, s101
    s_addc_u32 s29, s29, 0
    s_cmp_ge_u32 s91, 2
    s_cselect_b32 s36, s84, s36
    s_cselect_b32 s37, s85, s37
    s_add_u32 s1, s2, s91
    s_cmp_lg_u32 s1, 0
    s_cbranch_scc1 L_ep11
    s_mov_b32 s1, 8077312
    buffer_load_dword v241, v237, s[40:43], s1 offen sc1
L_ep11:
    s_cmp_lg_u32 s94, 0
    s_cbranch_scc1 L_nz1
    buffer_store_dwordx4 v[60:63], v244, s[40:43], s75 offen sc1
    buffer_store_dwordx4 v[60:63], v244, s[40:43], s75 offen offset:1024 sc1
    buffer_store_dwordx4 v[60:63], v239, s[40:43], s75 offen offset:2048 sc1
L_nz1:
    s_add_u32 m0, s97, 0
    s_nop 0
    buffer_load_dwordx4 v226, s[28:31], s4 offen lds
    buffer_load_dwordx4 v227, s[28:31], s4 offen offset:1024 lds
    buffer_load_dwordx4 v228, s[28:31], s4 offen offset:2048 lds
    buffer_load_dwordx4 v229, s[28:31], s4 offen offset:3072 lds
    s_add_u32 m0, s97, 65536
    s_nop 0
    buffer_load_dwordx4 v68, s[32:35], s12 offen lds
    buffer_load_dwordx4 v69, s[32:35], s12 offen offset:1024 lds
    buffer_load_dwordx4 v70, s[32:35], s12 offen offset:2048 lds
    buffer_load_dwordx4 v71, s[32:35], s12 offen offset:3072 lds
    s_lshl_b32 s101, s91, 10
    s_add_u32 m0, s101, 147456
    s_lshl_b32 s3, s95, 11
    s_lshl_b32 s101, s93, 10
    s_add_u32 s3, s3, s101
    buffer_load_dwordx4 v244, s[76:79], s3 offen lds
    s_add_u32 m0, s97, 16384
    s_nop 0
    buffer_load_dwordx4 v226, s[28:31], s5 offen lds
    buffer_load_dwordx4 v227, s[28:31], s5 offen offset:1024 lds
    buffer_load_dwordx4 v228, s[28:31], s5 offen offset:2048 lds
    buffer_load_dwordx4 v229, s[28:31], s5 offen offset:3072 lds
    s_add_u32 m0, s97, 81920
    s_nop 0
    buffer_load_dwordx4 v68, s[32:35], s13 offen lds
    buffer_load_dwordx4 v69, s[32:35], s13 offen offset:1024 lds
    buffer_load_dwordx4 v70, s[32:35], s13 offen offset:2048 lds
    buffer_load_dwordx4 v71, s[32:35], s13 offen offset:3072 lds
    s_branch L_body_kv
L_role_qg:
    s_add_u32 s20, s96, 0
    s_and_b32 s20, s20, 7
    s_mul_i32 s20, s20, 176128
    s_add_u32 s21, s96, 1
    s_and_b32 s21, s21, 7
    s_mul_i32 s21, s21, 176128
    s_mul_i32 s13, s95, 7
    s_add_u32 s13, s13, 32
    s_cmp_ge_u32 s95, 6
    s_cselect_b32 s101, 1, 0
    s_sub_u32 s13, s13, s101
    s_mul_i32 s101, s92, 22016
    s_lshl_b32 s3, s13, 5
    s_add_u32 s101, s101, s3
    v_lshl_add_u32 v240, v255, 4, s101
    s_movk_i32 s3, 2528
    s_movk_i32 s87, 2752
    v_mul_u32_u24 v5, 0x124a, v255
    v_lshrrev_b32 v4, 16, v5
    v_and_b32 v241, 24, v4
    v_mad_u32_u24 v176, v4, s3, v240
    v_mad_u32_u24 v176, v241, s87, v176
    v_add_u32 v7, 0x49280, v5
    v_lshrrev_b32 v6, 16, v7
    v_and_b32 v241, 24, v6
    v_mad_u32_u24 v177, v6, s3, v240
    v_mad_u32_u24 v177, v241, s87, v177
    v_add_u32 v9, 0x92500, v5
    v_lshrrev_b32 v8, 16, v9
    v_and_b32 v241, 24, v8
    v_mad_u32_u24 v178, v8, s3, v240
    v_mad_u32_u24 v178, v241, s87, v178
    v_add_u32 v11, 0xdb780, v5
    v_lshrrev_b32 v10, 16, v11
    v_and_b32 v241, 24, v10
    v_mad_u32_u24 v179, v10, s3, v240
    v_mad_u32_u24 v179, v241, s87, v179
    v_add_u32 v240, 0x1000, v240
    v_add_u32 v13, 0x124a00, v5
    v_lshrrev_b32 v12, 16, v13
    v_and_b32 v241, 24, v12
    v_mad_u32_u24 v180, v12, s3, v240
    v_mad_u32_u24 v180, v241, s87, v180
    v_add_u32 v15, 0x16dc80, v5
    v_lshrrev_b32 v14, 16, v15
    v_and_b32 v241, 24, v14
    v_mad_u32_u24 v181, v14, s3, v240
    v_mad_u32_u24 v181, v241, s87, v181
    v_add_u32 v17, 0x1b6f00, v5
    v_lshrrev_b32 v16, 16, v17
    v_and_b32 v241, 24, v16
    v_mad_u32_u24 v182, v16, s3, v240
    v_mad_u32_u24 v182, v241, s87, v182
    s_mul_i32 s12, s93, 14464
    s_mul_i32 s101, s92, 7296
    s_add_u32 s12, s12, s101
    s_add_u32 s12, s12, 16384
    v_lshrrev_b32 v20, 3, v255
    v_add_u32 v19, s96, v20
    v_and_b32 v18, 7, v19
    v_and_b32 v22, 7, v255
    v_lshlrev_b32 v21, 4, v22
    v_lshl_add_u32 v239, v18, 7, v21
    s_lshl_b32 s86, s91, 10
    s_add_u32 s86, s86, 153600
    v_lshrrev_b32 v23, 4, v255
    v_lshl_add_u32 v193, v23, 4, s86
    s_waitcnt lgkmcnt(0)
    s_mov_b64 s[28:29], s[48:49]
    s_mov_b64 s[32:33], s[50:51]
    s_mov_b64 s[36:37], s[58:59]
    s_mov_b64 s[84:85], s[60:61]
    s_mov_b64 s[40:41], s[70:71]
    s_mov_b64 s[76:77], s[52:53]
    s_mov_b64 s[80:81], s[64:65]
    s_mov_b64 s[44:45], s[68:69]
    s_lshl_b32 s101, s94, 17
    s_add_u32 s28, s28, s101
    s_addc_u32 s29, s29, 0
    s_cmp_ge_u32 s91, 2
    s_cselect_b32 s36, s84, s36
    s_cselect_b32 s37, s85, s37
    s_mov_b32 m0, s86
    s_nop 0
    buffer_load_dwordx4 v239, s[80:83], 0 offen lds
    s_add_u32 m0, s97, 0
    s_nop 0
    buffer_load_dwordx4 v226, s[28:31], s4 offen lds
    buffer_load_dwordx4 v227, s[28:31], s4 offen offset:1024 lds
    buffer_load_dwordx4 v228, s[28:31], s4 offen offset:2048 lds
    buffer_load_dwordx4 v229, s[28:31], s4 offen offset:3072 lds
    s_add_u32 m0, s12, 0
    s_nop 0
    buffer_load_dwordx4 v176, s[36:39], s20 offen lds
    buffer_load_dwordx4 v177, s[36:39], s20 offen offset:1024 lds
    buffer_load_dwordx4 v178, s[36:39], s20 offen offset:2048 lds
    buffer_load_dwordx4 v179, s[36:39], s20 offen offset:3072 lds
    s_add_u32 m0, s12, 4096
    s_nop 0
    buffer_load_dwordx4 v180, s[36:39], s20 offen lds
    buffer_load_dwordx4 v181, s[36:39], s20 offen offset:1024 lds
    buffer_load_dwordx4 v182, s[36:39], s20 offen offset:2048 lds
    s_lshl_b32 s101, s91, 10
    s_add_u32 m0, s101, 149504
    s_lshl_b32 s3, s95, 11
    s_lshl_b32 s101, s93, 10
    s_add_u32 s3, s3, s101
    buffer_load_dwordx4 v244, s[76:79], s3 offen lds
    s_add_u32 m0, s97, 45312
    s_nop 0
    buffer_load_dwordx4 v226, s[28:31], s5 offen lds
    buffer_load_dwordx4 v227, s[28:31], s5 offen offset:1024 lds
    buffer_load_dwordx4 v228, s[28:31], s5 offen offset:2048 lds
    buffer_load_dwordx4 v229, s[28:31], s5 offen offset:3072 lds
    s_add_u32 m0, s12, 45312
    s_nop 0
    buffer_load_dwordx4 v176, s[36:39], s21 offen lds
    buffer_load_dwordx4 v177, s[36:39], s21 offen offset:1024 lds
    buffer_load_dwordx4 v178, s[36:39], s21 offen offset:2048 lds
    buffer_load_dwordx4 v179, s[36:39], s21 offen offset:3072 lds
    s_branch L_body_qg
    .p2align 12
L_body_q:
    s_add_u32 s22, s96, 2
    s_and_b32 s22, s22, 7
    s_mul_i32 s22, s22, 176128
    s_add_u32 s23, s96, 3
    s_and_b32 s23, s23, 7
    s_mul_i32 s23, s23, 176128
    s_add_u32 s24, s96, 4
    s_and_b32 s24, s24, 7
    s_mul_i32 s24, s24, 176128
    s_add_u32 s25, s96, 5
    s_and_b32 s25, s25, 7
    s_mul_i32 s25, s25, 176128
    s_add_u32 s26, s96, 6
    s_and_b32 s26, s26, 7
    s_mul_i32 s26, s26, 176128
    s_add_u32 s27, s96, 7
    s_and_b32 s27, s27, 7
    s_mul_i32 s27, s27, 176128
    s_add_u32 s6, s96, 2
    s_and_b32 s6, s6, 7
    s_mul_i32 s6, s6, 128
    s_add_u32 s7, s96, 3
    s_and_b32 s7, s7, 7
    s_mul_i32 s7, s7, 128
    s_add_u32 s8, s96, 4
    s_and_b32 s8, s8, 7
    s_mul_i32 s8, s8, 128
    s_add_u32 s9, s96, 5
    s_and_b32 s9, s9, 7
    s_mul_i32 s9, s9, 128
    s_add_u32 s10, s96, 6
    s_and_b32 s10, s10, 7
    s_mul_i32 s10, s10, 128
    s_add_u32 s11, s96, 7
    s_and_b32 s11, s11, 7
    s_mul_i32 s11, s11, 128
    s_lshl_b32 s101, s92, 13
    v_and_b32 v19, 15, v255
    v_lshl_add_u32 v18, v19, 7, s101
    v_lshrrev_b32 v22, 4, v255
    v_lshrrev_b32 v23, 1, v19
    v_xor_b32 v21, v22, v23
    v_lshlrev_b32 v20, 4, v21
    v_add_u32 v200, v18, v20
    v_xor_b32 v201, 64, v200
    s_lshl_b32 s101, s93, 12
    v_add_u32 v200, s101, v200
    v_xor_b32 v202, 0x1000, v200
    v_add_u32 v201, s101, v201
    v_xor_b32 v203, 0x1000, v201
    v_lshrrev_b32 v27, 5, v255
    v_bfe_u32 v28, v255, 2, 2
    v_lshl_add_u32 v26, v27, 3, v28
    v_mul_u32_u24 v25, 0xe0, v26
    v_add_u32 v24, 0x4000, v25
    v_and_b32 v31, 1, v22
    v_mul_u32_u24 v30, 0x1c80, v31
    v_and_b32 v33, 3, v255
    v_lshlrev_b32 v32, 3, v33
    v_add_u32 v29, v30, v32
    v_add_u32 v188, v24, v29
    s_mul_i32 s101, s93, 96
    v_add_u32 v187, s101, v188
    s_mov_b64 s[48:49], s[62:63]
    s_mov_b64 s[52:53], s[54:55]
    s_mov_b64 s[64:65], s[66:67]
    s_mov_b32 s50, 0x158000
    s_mov_b32 s51, 0x20000
    s_mov_b32 s54, 0x80000
    s_mov_b32 s55, 0x20000
    s_mov_b32 s58, 0x15800
    s_mov_b32 s59, 0x20000
    s_mov_b32 s62, 0x15800
    s_mov_b32 s63, 0x20000
    s_mov_b32 s66, 0x10000
    s_mov_b32 s67, 0x20000
    s_mul_i32 s101, s98, 176128
    s_add_u32 s56, s40, s101
    s_addc_u32 s57, s41, 0
    s_add_u32 s60, s56, 88064
    s_addc_u32 s61, s57, 0
    s_lshl_b32 s101, s98, 16
    s_add_u32 s64, s64, s101
    s_addc_u32 s65, s65, 0
    s_lshl_b32 s101, s2, 2
    s_add_u32 s101, s101, s91
    s_mul_i32 s3, s101, 1408
    s_lshl_b32 s101, s101, 9
    v_min_u32 v34, 10, v255
    v_lshl_add_u32 v196, v34, 7, s3
    v_min_u32 v35, 3, v255
    v_lshl_add_u32 v197, v35, 7, s101
    s_mov_b64 exec, 0
    s_cmp_eq_u32 s91, 0
    s_cbranch_scc1 L_pad_q_0
    s_cmp_eq_u32 s91, 1
    s_cbranch_scc1 L_pad_q_1
    s_cmp_eq_u32 s91, 2
    s_cbranch_scc1 L_pad_q_2
    s_cmp_eq_u32 s91, 3
    s_cbranch_scc1 L_pad_q_3
L_walked_q:
    s_mov_b64 exec, -1
    s_waitcnt vmcnt(9)
    s_barrier
    ds_read_b128 a[0:3], v200 offset:0
    ds_read_b128 a[64:67], v200 offset:2048
    ds_read_b64_tr_b16 v[144:145], v187 offset:0
    ds_read_b64_tr_b16 v[146:147], v187 offset:896
    s_add_u32 m0, s12, 49408
    s_waitcnt lgkmcnt(0)
    v_mfma_f32_16x16x32_bf16 v[0:3], v[144:147], a[0:3], 0
    ds_read_b128 a[128:131], v202 offset:0
    ds_read_b128 a[192:195], v202 offset:2048
    v_mfma_f32_16x16x32_bf16 v[4:7], v[144:147], a[64:67], 0
    buffer_load_dwordx4 v180, s[36:39], s21 offen lds
    s_lshl_b32 s101, s91, 10
    s_waitcnt lgkmcnt(1)
    v_mfma_f32_16x16x32_bf16 v[16:19], v[144:147], a[128:131], 0
    ds_read_b64_tr_b16 v[148:149], v187 offset:14464
    ds_read_b64_tr_b16 v[150:151], v187 offset:15360
    s_waitcnt lgkmcnt(2)
    v_mfma_f32_16x16x32_bf16 v[20:23], v[144:147], a[192:195], 0
    buffer_load_dwordx4 v181, s[36:39], s21 offen offset:1024 lds
    s_add_u32 s101, s101, 149504
    s_waitcnt lgkmcnt(0)
    v_mfma_f32_16x16x32_bf16 v[8:11], v[148:151], a[0:3], 0
    ds_read_b64_tr_b16 v[152:153], v187 offset:32
    ds_read_b64_tr_b16 v[154:155], v187 offset:928
    v_mfma_f32_16x16x32_bf16 v[12:15], v[148:151], a[64:67], 0
    buffer_load_dwordx4 v182, s[36:39], s21 offen offset:2048 lds
    v_lshrrev_b32 v114, 5, v255
    v_mfma_f32_16x16x32_bf16 v[24:27], v[148:151], a[128:131], 0
    ds_read_b64_tr_b16 v[156:157], v187 offset:14496
    ds_read_b64_tr_b16 v[158:159], v187 offset:15392
    v_mfma_f32_16x16x32_bf16 v[28:31], v[148:151], a[192:195], 0
    s_add_u32 m0, s97, 90624
    s_nop 0
    buffer_load_dwordx4 v226, s[28:31], s6 offen lds
    s_waitcnt lgkmcnt(2)
    v_mfma_f32_16x16x32_bf16 v[32:35], v[152:155], a[0:3], 0
    ds_read_b64_tr_b16 v[160:161], v187 offset:64
    ds_read_b64_tr_b16 v[162:163], v187 offset:960
    v_mfma_f32_16x16x32_bf16 v[36:39], v[152:155], a[64:67], 0
    buffer_load_dwordx4 v227, s[28:31], s6 offen offset:1024 lds
    v_bfe_u32 v115, v255, 2, 2
    v_mfma_f32_16x16x32_bf16 v[48:51], v[152:155], a[128:131], 0
    ds_read_b64_tr_b16 v[164:165], v187 offset:14528
    ds_read_b64_tr_b16 v[166:167], v187 offset:15424
    v_mfma_f32_16x16x32_bf16 v[52:55], v[152:155], a[192:195], 0
    buffer_load_dwordx4 v228, s[28:31], s6 offen offset:2048 lds
    v_lshl_add_u32 v113, v114, 3, v115
    s_waitcnt lgkmcnt(4)
    v_mfma_f32_16x16x32_bf16 v[40:43], v[156:159], a[0:3], 0
    ds_read_b64_tr_b16 v[144:145], v188 offset:192
    ds_read_b64_tr_b16 v[146:147], v188 offset:1088
    v_mfma_f32_16x16x32_bf16 v[44:47], v[156:159], a[64:67], 0
    buffer_load_dwordx4 v229, s[28:31], s6 offen offset:3072 lds
    v_lshl_add_u32 v112, v113, 5, s101
    v_mfma_f32_16x16x32_bf16 v[56:59], v[156:159], a[128:131], 0
    ds_read_b64_tr_b16 v[148:149], v188 offset:14656
    ds_read_b64_tr_b16 v[150:151], v188 offset:15552
    v_mfma_f32_16x16x32_bf16 v[60:63], v[156:159], a[192:195], 0
    s_add_u32 m0, s12, 90624
    s_nop 0
    buffer_load_dwordx4 v176, s[36:39], s22 offen lds
    s_waitcnt lgkmcnt(6)
    v_mfma_f32_16x16x32_bf16 v[64:67], v[160:163], a[0:3], 0
    ds_read_b128 a[4:7], v201 offset:0
    ds_read_b128 a[68:71], v201 offset:2048
    v_mfma_f32_16x16x32_bf16 v[68:71], v[160:163], a[64:67], 0
    buffer_load_dwordx4 v177, s[36:39], s22 offen offset:1024 lds
    v_bfe_u32 v118, v255, 4, 1
    v_mfma_f32_16x16x32_bf16 v[80:83], v[160:163], a[128:131], 0
    ds_read_b64_tr_b16 v[152:153], v187 offset:3584
    ds_read_b64_tr_b16 v[154:155], v187 offset:4480
    v_mfma_f32_16x16x32_bf16 v[84:87], v[160:163], a[192:195], 0
    buffer_load_dwordx4 v178, s[36:39], s22 offen offset:2048 lds
    v_and_b32 v120, 3, v255
    s_waitcnt lgkmcnt(8)
    v_mfma_f32_16x16x32_bf16 v[72:75], v[164:167], a[0:3], 0
    ds_read_b128 a[132:135], v203 offset:0
    ds_read_b128 a[196:199], v203 offset:2048
    v_mfma_f32_16x16x32_bf16 v[76:79], v[164:167], a[64:67], 0
    buffer_load_dwordx4 v179, s[36:39], s22 offen offset:3072 lds
    v_lshrrev_b32 v119, 1, v120
    v_mfma_f32_16x16x32_bf16 v[88:91], v[164:167], a[128:131], 0
    ds_read_b64_tr_b16 v[156:157], v187 offset:18048
    ds_read_b64_tr_b16 v[158:159], v187 offset:18944
    v_mfma_f32_16x16x32_bf16 v[92:95], v[164:167], a[192:195], 0
    s_add_u32 m0, s12, 94720
    s_nop 0
    buffer_load_dwordx4 v180, s[36:39], s22 offen lds
    s_waitcnt lgkmcnt(8)
    v_mfma_f32_16x16x32_bf16 v[96:99], v[144:147], a[0:3], 0
    ds_read_b64_tr_b16 v[160:161], v187 offset:3616
    ds_read_b64_tr_b16 v[162:163], v187 offset:4512
    v_mfma_f32_16x16x32_bf16 v[100:103], v[144:147], a[64:67], 0
    buffer_load_dwordx4 v181, s[36:39], s22 offen offset:1024 lds
    v_lshl_add_u32 v117, v118, 1, v119
    v_mfma_f32_16x16x32_bf16 v[104:107], v[148:151], a[0:3], 0
    ds_read_b64_tr_b16 v[164:165], v187 offset:18080
    ds_read_b64_tr_b16 v[166:167], v187 offset:18976
    v_mfma_f32_16x16x32_bf16 v[108:111], v[148:151], a[64:67], 0
    buffer_load_dwordx4 v182, s[36:39], s22 offen offset:2048 lds
    v_lshlrev_b32 v116, 3, v117
    s_waitcnt lgkmcnt(8)
    v_mfma_f32_16x16x32_bf16 v[0:3], v[152:155], a[4:7], v[0:3]
    ds_read_b64_tr_b16 v[144:145], v187 offset:3648
    ds_read_b64_tr_b16 v[146:147], v187 offset:4544
    v_mfma_f32_16x16x32_bf16 v[4:7], v[152:155], a[68:71], v[4:7]
    v_add_u32 v194, v112, v116
    v_bfe_u32 v121, v255, 2, 1
    s_waitcnt lgkmcnt(8)
    v_mfma_f32_16x16x32_bf16 v[16:19], v[152:155], a[132:135], v[16:19]
    ds_read_b64_tr_b16 v[148:149], v187 offset:18112
    ds_read_b64_tr_b16 v[150:151], v187 offset:19008
    v_mfma_f32_16x16x32_bf16 v[20:23], v[152:155], a[196:199], v[20:23]
    v_lshlrev_b32 v195, 15, v121
    v_lshl_or_b32 v195, v195, 16, v195
    s_waitcnt lgkmcnt(8)
    v_mfma_f32_16x16x32_bf16 v[8:11], v[156:159], a[4:7], v[8:11]
    ds_read_b64_tr_b16 v[152:153], v188 offset:3776
    ds_read_b64_tr_b16 v[154:155], v188 offset:4672
    v_mfma_f32_16x16x32_bf16 v[12:15], v[156:159], a[68:71], v[12:15]
    s_mov_b32 s72, 0x3fb8aa3b
    s_lshl_b32 s101, s95, 7
    v_mfma_f32_16x16x32_bf16 v[24:27], v[156:159], a[132:135], v[24:27]
    v_mfma_f32_16x16x32_bf16 v[28:31], v[156:159], a[196:199], v[28:31]
    ds_read_b64_tr_b16 v[156:157], v188 offset:18240
    ds_read_b64_tr_b16 v[158:159], v188 offset:19136
    v_lshrrev_b32 v124, 3, v255
    v_mul_u32_u24 v123, 0xc00, v124
    s_waitcnt lgkmcnt(8)
    v_mfma_f32_16x16x32_bf16 v[32:35], v[160:163], a[4:7], v[32:35]
    v_add_u32 v200, 0xb100, v200
    v_add_u32 v201, 0xb100, v201
    v_mfma_f32_16x16x32_bf16 v[36:39], v[160:163], a[68:71], v[36:39]
    v_add_u32 v202, 0xb100, v202
    v_add_u32 v122, s101, v123
    v_mfma_f32_16x16x32_bf16 v[48:51], v[160:163], a[132:135], v[48:51]
    v_add_u32 v203, 0xb100, v203
    v_add_u32 v187, 0xb100, v187
    v_mfma_f32_16x16x32_bf16 v[52:55], v[160:163], a[196:199], v[52:55]
    v_add_u32 v188, 0xb100, v188
    v_and_b32 v128, 7, v255
    v_mfma_f32_16x16x32_bf16 v[40:43], v[164:167], a[4:7], v[40:43]
    v_lshrrev_b32 v127, 1, v128
    v_xor_b32 v126, v127, v118
    v_mfma_f32_16x16x32_bf16 v[44:47], v[164:167], a[68:71], v[44:47]
    v_and_b32 v130, 1, v255
    v_lshlrev_b32 v129, 4, v130
    v_mfma_f32_16x16x32_bf16 v[56:59], v[164:167], a[132:135], v[56:59]
    v_lshl_add_u32 v125, v126, 5, v129
    v_add_u32 v183, v122, v125
    v_mfma_f32_16x16x32_bf16 v[60:63], v[164:167], a[196:199], v[60:63]
    v_add_u32 v132, 0x5c00, v123
    v_add_u32 v131, s101, v132
    s_waitcnt lgkmcnt(0)
    v_mfma_f32_16x16x32_bf16 v[64:67], v[144:147], a[4:7], v[64:67]
    v_xor_b32 v134, 2, v126
    v_lshl_add_u32 v133, v134, 5, v129
    v_mfma_f32_16x16x32_bf16 v[68:71], v[144:147], a[68:71], v[68:71]
    v_add_u32 v184, v131, v133
    v_add_u32 v136, 0xb800, v123
    v_mfma_f32_16x16x32_bf16 v[80:83], v[144:147], a[132:135], v[80:83]
    v_add_u32 v135, s101, v136
    v_add_u32 v185, v135, v125
    v_mfma_f32_16x16x32_bf16 v[84:87], v[144:147], a[196:199], v[84:87]
    v_add_u32 v138, 0x11400, v123
    v_add_u32 v137, s101, v138
    v_mfma_f32_16x16x32_bf16 v[72:75], v[148:151], a[4:7], v[72:75]
    v_add_u32 v186, v137, v133
    s_lshl_b32 s101, s93, 1
    v_mfma_f32_16x16x32_bf16 v[76:79], v[148:151], a[68:71], v[76:79]
    v_lshrrev_b32 v141, 4, v255
    v_lshl_add_u32 v140, v141, 3, v115
    v_mfma_f32_16x16x32_bf16 v[88:91], v[148:151], a[132:135], v[88:91]
    v_mfma_f32_16x16x32_bf16 v[92:95], v[148:151], a[196:199], v[92:95]
    s_waitcnt vmcnt(11)
    s_barrier
    ds_read_b128 a[8:11], v200 offset:0
    ds_read_b128 a[72:75], v200 offset:2048
    v_mfma_f32_16x16x32_bf16 v[96:99], v[152:155], a[4:7], v[96:99]
    ds_read_b64_tr_b16 v[160:161], v187 offset:0
    ds_read_b64_tr_b16 v[162:163], v187 offset:896
    v_mfma_f32_16x16x32_bf16 v[100:103], v[152:155], a[68:71], v[100:103]
    s_add_u32 m0, s97, 0
    s_nop 0
    buffer_load_dwordx4 v226, s[28:31], s7 offen lds
    v_mfma_f32_16x16x32_bf16 v[104:107], v[156:159], a[4:7], v[104:107]
    ds_read_b128 a[136:139], v202 offset:0
    ds_read_b128 a[200:203], v202 offset:2048
    v_mfma_f32_16x16x32_bf16 v[108:111], v[156:159], a[68:71], v[108:111]
    v_lshlrev_b32 v142, 3, v120
    v_lshl_add_u32 v139, v140, 7, v142
    s_waitcnt lgkmcnt(2)
    v_mfma_f32_16x16x32_bf16 v[0:3], v[160:163], a[8:11], v[0:3]
    ds_read_b64_tr_b16 v[164:165], v187 offset:14464
    ds_read_b64_tr_b16 v[166:167], v187 offset:15360
    v_mfma_f32_16x16x32_bf16 v[4:7], v[160:163], a[72:75], v[4:7]
    buffer_load_dwordx4 v227, s[28:31], s7 offen offset:1024 lds
    v_lshrrev_b32 v210, 1, v115
    s_waitcnt lgkmcnt(3)
    v_mfma_f32_16x16x32_bf16 v[16:19], v[160:163], a[136:139], v[16:19]
    ds_read_b64_tr_b16 v[144:145], v187 offset:32
    ds_read_b64_tr_b16 v[146:147], v187 offset:928
    s_waitcnt lgkmcnt(4)
    v_mfma_f32_16x16x32_bf16 v[20:23], v[160:163], a[200:203], v[20:23]
    v_lshl_add_u32 v209, v118, 1, v210
    v_xor_b32 v208, s101, v209
    s_waitcnt lgkmcnt(2)
    v_mfma_f32_16x16x32_bf16 v[8:11], v[164:167], a[8:11], v[8:11]
    ds_read_b64_tr_b16 v[148:149], v187 offset:14496
    ds_read_b64_tr_b16 v[150:151], v187 offset:15392
    v_mfma_f32_16x16x32_bf16 v[12:15], v[164:167], a[72:75], v[12:15]
    v_lshlrev_b32 v143, 5, v208
    v_add_u32 v191, v139, v143
    v_mfma_f32_16x16x32_bf16 v[24:27], v[164:167], a[136:139], v[24:27]
    ds_read_b64_tr_b16 v[152:153], v187 offset:64
    ds_read_b64_tr_b16 v[154:155], v187 offset:960
    v_mfma_f32_16x16x32_bf16 v[28:31], v[164:167], a[200:203], v[28:31]
    buffer_load_dwordx4 v228, s[28:31], s7 offen offset:2048 lds
    v_xor_b32 v192, 32, v191
    s_waitcnt lgkmcnt(4)
    v_mfma_f32_16x16x32_bf16 v[32:35], v[144:147], a[8:11], v[32:35]
    ds_read_b64_tr_b16 v[156:157], v187 offset:14528
    ds_read_b64_tr_b16 v[158:159], v187 offset:15424
    v_mfma_f32_16x16x32_bf16 v[36:39], v[144:147], a[72:75], v[36:39]
    v_add_u32 v189, 98304, v191
    v_add_u32 v190, 98304, v192
    v_mfma_f32_16x16x32_bf16 v[48:51], v[144:147], a[136:139], v[48:51]
    ds_read_b64_tr_b16 v[160:161], v188 offset:192
    ds_read_b64_tr_b16 v[162:163], v188 offset:1088
    v_mfma_f32_16x16x32_bf16 v[52:55], v[144:147], a[200:203], v[52:55]
    buffer_load_dwordx4 v229, s[28:31], s7 offen offset:3072 lds
    s_lshl_b32 s14, s91, 13
    s_waitcnt lgkmcnt(6)
    v_mfma_f32_16x16x32_bf16 v[40:43], v[148:151], a[8:11], v[40:43]
    ds_read_b64_tr_b16 v[164:165], v188 offset:14656
    ds_read_b64_tr_b16 v[166:167], v188 offset:15552
    v_mfma_f32_16x16x32_bf16 v[44:47], v[148:151], a[72:75], v[44:47]
    s_add_u32 s71, s96, s91
    s_add_u32 s73, s71, 4
    v_mfma_f32_16x16x32_bf16 v[56:59], v[148:151], a[136:139], v[56:59]
    ds_read_b128 a[12:15], v201 offset:0
    ds_read_b128 a[76:79], v201 offset:2048
    v_mfma_f32_16x16x32_bf16 v[60:63], v[148:151], a[200:203], v[60:63]
    s_add_u32 m0, s12, 0
    s_and_b32 s71, s71, 7
    s_waitcnt lgkmcnt(8)
    v_mfma_f32_16x16x32_bf16 v[64:67], v[152:155], a[8:11], v[64:67]
    ds_read_b64_tr_b16 v[144:145], v187 offset:3584
    ds_read_b64_tr_b16 v[146:147], v187 offset:4480
    v_mfma_f32_16x16x32_bf16 v[68:71], v[152:155], a[72:75], v[68:71]
    buffer_load_dwordx4 v176, s[36:39], s23 offen lds
    s_and_b32 s73, s73, 7
    v_mfma_f32_16x16x32_bf16 v[80:83], v[152:155], a[136:139], v[80:83]
    ds_read_b128 a[140:143], v203 offset:0
    ds_read_b128 a[204:207], v203 offset:2048
    v_mfma_f32_16x16x32_bf16 v[84:87], v[152:155], a[200:203], v[84:87]
    s_mul_i32 s71, s71, 196608
    s_mul_i32 s73, s73, 196608
    s_waitcnt lgkmcnt(8)
    v_mfma_f32_16x16x32_bf16 v[72:75], v[156:159], a[8:11], v[72:75]
    ds_read_b64_tr_b16 v[148:149], v187 offset:18048
    ds_read_b64_tr_b16 v[150:151], v187 offset:18944
    v_mfma_f32_16x16x32_bf16 v[76:79], v[156:159], a[72:75], v[76:79]
    buffer_load_dwordx4 v177, s[36:39], s23 offen offset:1024 lds
    s_mul_i32 s101, s91, 1536
    v_mfma_f32_16x16x32_bf16 v[88:91], v[156:159], a[136:139], v[88:91]
    ds_read_b64_tr_b16 v[152:153], v187 offset:3616
    ds_read_b64_tr_b16 v[154:155], v187 offset:4512
    v_mfma_f32_16x16x32_bf16 v[92:95], v[156:159], a[200:203], v[92:95]
    s_add_u32 s101, s101, 157696
    v_lshl_add_u32 v230, v255, 3, s101
    v_mfma_f32_16x16x32_bf16 v[96:99], v[160:163], a[8:11], v[96:99]
    ds_read_b64_tr_b16 v[156:157], v187 offset:18080
    ds_read_b64_tr_b16 v[158:159], v187 offset:18976
    v_mfma_f32_16x16x32_bf16 v[100:103], v[160:163], a[72:75], v[100:103]
    s_mul_i32 s101, s93, 3072
    s_add_u32 s101, s101, 157696
    s_waitcnt lgkmcnt(8)
    v_mfma_f32_16x16x32_bf16 v[104:107], v[164:167], a[8:11], v[104:107]
    ds_read_b64_tr_b16 v[160:161], v187 offset:3648
    ds_read_b64_tr_b16 v[162:163], v187 offset:4544
    v_mfma_f32_16x16x32_bf16 v[108:111], v[164:167], a[72:75], v[108:111]
    buffer_load_dwordx4 v178, s[36:39], s23 offen offset:2048 lds
    v_and_b32 v216, 31, v255
    v_mfma_f32_16x16x32_bf16 v[0:3], v[144:147], a[12:15], v[0:3]
    ds_read_b64_tr_b16 v[164:165], v187 offset:18112
    ds_read_b64_tr_b16 v[166:167], v187 offset:19008
    v_mfma_f32_16x16x32_bf16 v[4:7], v[144:147], a[76:79], v[4:7]
    v_and_b32 v215, 19, v216
    v_and_b32 v218, 4, v216
    s_waitcnt lgkmcnt(8)
    v_mfma_f32_16x16x32_bf16 v[16:19], v[144:147], a[140:143], v[16:19]
    v_mfma_f32_16x16x32_bf16 v[20:23], v[144:147], a[204:207], v[20:23]
    ds_read_b64_tr_b16 v[144:145], v188 offset:3776
    ds_read_b64_tr_b16 v[146:147], v188 offset:4672
    buffer_load_dwordx4 v179, s[36:39], s23 offen offset:3072 lds
    v_lshlrev_b32 v217, 1, v218
    v_mfma_f32_16x16x32_bf16 v[8:11], v[148:151], a[12:15], v[8:11]
    v_add_u32 v214, v215, v217
    v_lshrrev_b32 v220, 1, v216
    v_mfma_f32_16x16x32_bf16 v[12:15], v[148:151], a[76:79], v[12:15]
    v_and_b32 v219, 4, v220
    v_add_u32 v213, v214, v219
    v_mfma_f32_16x16x32_bf16 v[24:27], v[148:151], a[140:143], v[24:27]
    v_mfma_f32_16x16x32_bf16 v[28:31], v[148:151], a[204:207], v[28:31]
    ds_read_b64_tr_b16 v[148:149], v188 offset:18240
    ds_read_b64_tr_b16 v[150:151], v188 offset:19136
    s_add_u32 m0, s12, 4096
    v_min_u32 v212, 16, v213
    s_waitcnt lgkmcnt(6)
    v_mfma_f32_16x16x32_bf16 v[32:35], v[152:155], a[12:15], v[32:35]
    v_add_u32 v200, 0xb100, v200
    v_add_u32 v201, 0xb100, v201
    v_mfma_f32_16x16x32_bf16 v[36:39], v[152:155], a[76:79], v[36:39]
    v_add_u32 v202, 0xb100, v202
    buffer_load_dwordx4 v180, s[36:39], s23 offen lds
    v_mfma_f32_16x16x32_bf16 v[48:51], v[152:155], a[140:143], v[48:51]
    v_add_u32 v203, 0xb100, v203
    v_add_u32 v187, 0xb100, v187
    v_mfma_f32_16x16x32_bf16 v[52:55], v[152:155], a[204:207], v[52:55]
    v_add_u32 v188, 0xb100, v188
    v_lshl_add_u32 v211, v212, 6, s101
    v_mfma_f32_16x16x32_bf16 v[40:43], v[156:159], a[12:15], v[40:43]
    buffer_load_dwordx4 v181, s[36:39], s23 offen offset:1024 lds
    v_lshlrev_b32 v221, 5, v114
    v_mfma_f32_16x16x32_bf16 v[44:47], v[156:159], a[76:79], v[44:47]
    v_add_u32 v231, v211, v221
    s_lshl_b32 s101, s94, 2
    v_mfma_f32_16x16x32_bf16 v[56:59], v[156:159], a[140:143], v[56:59]
    s_lshl_b32 s3, s92, 1
    s_add_u32 s101, s101, s3
    v_mfma_f32_16x16x32_bf16 v[60:63], v[156:159], a[204:207], v[60:63]
    s_add_u32 s101, s101, s93
    s_xor_b32 s87, s101, 1
    v_mfma_f32_16x16x32_bf16 v[64:67], v[160:163], a[12:15], v[64:67]
    s_mul_i32 s86, s101, 88064
    s_mul_i32 s87, s87, 88064
    v_mfma_f32_16x16x32_bf16 v[68:71], v[160:163], a[76:79], v[68:71]
    s_lshl_b32 s3, s13, 10
    s_add_u32 s86, s86, s3
    v_mfma_f32_16x16x32_bf16 v[80:83], v[160:163], a[140:143], v[80:83]
    buffer_load_dwordx4 v182, s[36:39], s23 offen offset:2048 lds
    s_add_u32 s87, s87, s3
    v_mfma_f32_16x16x32_bf16 v[84:87], v[160:163], a[204:207], v[84:87]
    s_mul_i32 s3, s93, 3072
    s_add_u32 s68, s86, s3
    s_waitcnt lgkmcnt(0)
    v_mfma_f32_16x16x32_bf16 v[72:75], v[164:167], a[12:15], v[72:75]
    s_add_u32 s69, s87, s3
    s_add_u32 s70, s86, 6144
    v_mfma_f32_16x16x32_bf16 v[76:79], v[164:167], a[76:79], v[76:79]
    s_lshl_b32 s101, s94, 1
    s_add_u32 s101, s101, s92
    v_mfma_f32_16x16x32_bf16 v[88:91], v[164:167], a[140:143], v[88:91]
    v_mfma_f32_16x16x32_bf16 v[92:95], v[164:167], a[204:207], v[92:95]
    s_waitcnt vmcnt(11)
    s_barrier
    ds_read_b64_tr_b16 v[168:169], v194 offset:0
    ds_read_b64_tr_b16 v[170:171], v194 offset:128
    ds_read_b64_tr_b16 v[172:173], v194 offset:512
    ds_read_b64_tr_b16 v[174:175], v194 offset:640
    ds_read_b128 a[16:19], v200 offset:0
    ds_read_b128 a[80:83], v200 offset:2048
    v_mfma_f32_16x16x32_bf16 v[96:99], v[144:147], a[12:15], v[96:99]
    ds_read_b64_tr_b16 v[152:153], v187 offset:0
    ds_read_b64_tr_b16 v[154:155], v187 offset:896
    v_mfma_f32_16x16x32_bf16 v[100:103], v[144:147], a[76:79], v[100:103]
    s_add_u32 m0, s97, 45312
    s_nop 0
    buffer_load_dwordx4 v226, s[28:31], s8 offen lds
    v_mfma_f32_16x16x32_bf16 v[104:107], v[148:151], a[12:15], v[104:107]
    ds_read_b128 a[144:147], v202 offset:0
    ds_read_b128 a[208:211], v202 offset:2048
    v_mfma_f32_16x16x32_bf16 v[108:111], v[148:151], a[76:79], v[108:111]
    s_lshl_b32 s101, s101, 12
    s_lshl_b32 s3, s95, 8
    s_waitcnt lgkmcnt(2)
    v_mfma_f32_16x16x32_bf16 v[0:3], v[152:155], a[16:19], v[0:3]
    ds_read_b64_tr_b16 v[156:157], v187 offset:14464
    ds_read_b64_tr_b16 v[158:159], v187 offset:15360
    v_mfma_f32_16x16x32_bf16 v[4:7], v[152:155], a[80:83], v[4:7]
    buffer_load_dwordx4 v227, s[28:31], s8 offen offset:1024 lds
    s_add_u32 s101, s101, s3
    s_waitcnt lgkmcnt(3)
    v_mfma_f32_16x16x32_bf16 v[16:19], v[152:155], a[144:147], v[16:19]
    ds_read_b64_tr_b16 v[160:161], v187 offset:32
    ds_read_b64_tr_b16 v[162:163], v187 offset:928
    s_waitcnt lgkmcnt(4)
    v_mfma_f32_16x16x32_bf16 v[20:23], v[152:155], a[208:211], v[20:23]
    s_lshl_b32 s3, s93, 7
    s_add_u32 s101, s101, s3
    s_waitcnt lgkmcnt(2)
    v_mfma_f32_16x16x32_bf16 v[8:11], v[156:159], a[16:19], v[8:11]
    ds_read_b64_tr_b16 v[164:165], v187 offset:14496
    ds_read_b64_tr_b16 v[166:167], v187 offset:15392
    v_mfma_f32_16x16x32_bf16 v[12:15], v[156:159], a[80:83], v[12:15]
    s_add_u32 s75, s101, 7817216
    s_mul_i32 s101, s99, 7
    v_mfma_f32_16x16x32_bf16 v[24:27], v[156:159], a[144:147], v[24:27]
    ds_read_b64_tr_b16 v[144:145], v187 offset:64
    ds_read_b64_tr_b16 v[146:147], v187 offset:960
    v_mfma_f32_16x16x32_bf16 v[28:31], v[156:159], a[208:211], v[28:31]
    buffer_load_dwordx4 v228, s[28:31], s8 offen offset:2048 lds
    s_lshr_b32 s101, s101, 3
    s_waitcnt lgkmcnt(4)
    v_mfma_f32_16x16x32_bf16 v[32:35], v[160:163], a[16:19], v[32:35]
    ds_read_b64_tr_b16 v[148:149], v187 offset:14528
    ds_read_b64_tr_b16 v[150:151], v187 offset:15424
    v_mfma_f32_16x16x32_bf16 v[36:39], v[160:163], a[80:83], v[36:39]
    s_mul_i32 s3, s100, 7
    s_lshr_b32 s3, s3, 2
    v_mfma_f32_16x16x32_bf16 v[48:51], v[160:163], a[144:147], v[48:51]
    ds_read_b64_tr_b16 v[152:153], v188 offset:192
    ds_read_b64_tr_b16 v[154:155], v188 offset:1088
    v_mfma_f32_16x16x32_bf16 v[52:55], v[160:163], a[208:211], v[52:55]
    buffer_load_dwordx4 v229, s[28:31], s8 offen offset:3072 lds
    s_add_u32 s90, s101, s3
    s_waitcnt lgkmcnt(6)
    v_mfma_f32_16x16x32_bf16 v[40:43], v[164:167], a[16:19], v[40:43]
    ds_read_b64_tr_b16 v[156:157], v188 offset:14656
    ds_read_b64_tr_b16 v[158:159], v188 offset:15552
    v_mfma_f32_16x16x32_bf16 v[44:47], v[164:167], a[80:83], v[44:47]
    s_sub_u32 s101, s90, 7
    s_min_u32 s90, s90, s101
    v_mfma_f32_16x16x32_bf16 v[56:59], v[164:167], a[144:147], v[56:59]
    ds_read_b128 a[20:23], v201 offset:0
    ds_read_b128 a[84:87], v201 offset:2048
    v_mfma_f32_16x16x32_bf16 v[60:63], v[164:167], a[208:211], v[60:63]
    s_add_u32 m0, s12, 45312
    s_mul_i32 s3, s91, 7
    s_waitcnt lgkmcnt(8)
    v_mfma_f32_16x16x32_bf16 v[64:67], v[144:147], a[16:19], v[64:67]
    ds_read_b64_tr_b16 v[160:161], v187 offset:3584
    ds_read_b64_tr_b16 v[162:163], v187 offset:4480
    v_mfma_f32_16x16x32_bf16 v[68:71], v[144:147], a[80:83], v[68:71]
    buffer_load_dwordx4 v176, s[36:39], s24 offen lds
    s_add_u32 s3, s3, 16
    v_mfma_f32_16x16x32_bf16 v[80:83], v[144:147], a[144:147], v[80:83]
    ds_read_b128 a[148:151], v203 offset:0
    ds_read_b128 a[212:215], v203 offset:2048
    v_mfma_f32_16x16x32_bf16 v[84:87], v[144:147], a[208:211], v[84:87]
    s_add_u32 s76, s90, 0
    s_sub_u32 s101, s76, 7
    s_waitcnt lgkmcnt(8)
    v_mfma_f32_16x16x32_bf16 v[72:75], v[148:151], a[16:19], v[72:75]
    ds_read_b64_tr_b16 v[164:165], v187 offset:18048
    ds_read_b64_tr_b16 v[166:167], v187 offset:18944
    v_mfma_f32_16x16x32_bf16 v[76:79], v[148:151], a[80:83], v[76:79]
    buffer_load_dwordx4 v177, s[36:39], s24 offen offset:1024 lds
    s_min_u32 s76, s76, s101
    v_mfma_f32_16x16x32_bf16 v[88:91], v[148:151], a[144:147], v[88:91]
    ds_read_b64_tr_b16 v[144:145], v187 offset:3616
    ds_read_b64_tr_b16 v[146:147], v187 offset:4512
    v_mfma_f32_16x16x32_bf16 v[92:95], v[148:151], a[208:211], v[92:95]
    s_add_u32 s76, s76, s3
    s_lshl_b32 s76, s76, 15
    v_mfma_f32_16x16x32_bf16 v[96:99], v[152:155], a[16:19], v[96:99]
    ds_read_b64_tr_b16 v[148:149], v187 offset:18080
    ds_read_b64_tr_b16 v[150:151], v187 offset:18976
    v_mfma_f32_16x16x32_bf16 v[100:103], v[152:155], a[80:83], v[100:103]
    s_add_u32 s77, s90, 1
    s_sub_u32 s101, s77, 7
    s_waitcnt lgkmcnt(8)
    v_mfma_f32_16x16x32_bf16 v[104:107], v[156:159], a[16:19], v[104:107]
    ds_read_b64_tr_b16 v[152:153], v187 offset:3648
    ds_read_b64_tr_b16 v[154:155], v187 offset:4544
    v_mfma_f32_16x16x32_bf16 v[108:111], v[156:159], a[80:83], v[108:111]
    buffer_load_dwordx4 v178, s[36:39], s24 offen offset:2048 lds
    s_min_u32 s77, s77, s101
    v_mfma_f32_16x16x32_bf16 v[0:3], v[160:163], a[20:23], v[0:3]
    ds_read_b64_tr_b16 v[156:157], v187 offset:18112
    ds_read_b64_tr_b16 v[158:159], v187 offset:19008
    v_mfma_f32_16x16x32_bf16 v[4:7], v[160:163], a[84:87], v[4:7]
    s_add_u32 s77, s77, s3
    s_lshl_b32 s77, s77, 15
    s_waitcnt lgkmcnt(8)
    v_mfma_f32_16x16x32_bf16 v[16:19], v[160:163], a[148:151], v[16:19]
    v_mfma_f32_16x16x32_bf16 v[20:23], v[160:163], a[212:215], v[20:23]
    ds_read_b64_tr_b16 v[160:161], v188 offset:3776
    ds_read_b64_tr_b16 v[162:163], v188 offset:4672
    buffer_load_dwordx4 v179, s[36:39], s24 offen offset:3072 lds
    s_add_u32 s78, s90, 2
    v_mfma_f32_16x16x32_bf16 v[8:11], v[164:167], a[20:23], v[8:11]
    s_sub_u32 s101, s78, 7
    s_min_u32 s78, s78, s101
    v_mfma_f32_16x16x32_bf16 v[12:15], v[164:167], a[84:87], v[12:15]
    s_add_u32 s78, s78, s3
    s_lshl_b32 s78, s78, 15
    v_mfma_f32_16x16x32_bf16 v[24:27], v[164:167], a[148:151], v[24:27]
    v_mfma_f32_16x16x32_bf16 v[28:31], v[164:167], a[212:215], v[28:31]
    ds_read_b64_tr_b16 v[164:165], v188 offset:18240
    ds_read_b64_tr_b16 v[166:167], v188 offset:19136
    s_add_u32 m0, s12, 49408
    s_add_u32 s79, s90, 3
    s_waitcnt lgkmcnt(6)
    v_mfma_f32_16x16x32_bf16 v[32:35], v[144:147], a[20:23], v[32:35]
    v_add_u32 v200, 0xfffe9e00, v200
    v_add_u32 v201, 0xfffe9e00, v201
    v_mfma_f32_16x16x32_bf16 v[36:39], v[144:147], a[84:87], v[36:39]
    v_add_u32 v202, 0xfffe9e00, v202
    buffer_load_dwordx4 v180, s[36:39], s24 offen lds
    v_mfma_f32_16x16x32_bf16 v[48:51], v[144:147], a[148:151], v[48:51]
    v_add_u32 v203, 0xfffe9e00, v203
    v_add_u32 v187, 0xfffe9e00, v187
    v_mfma_f32_16x16x32_bf16 v[52:55], v[144:147], a[212:215], v[52:55]
    v_add_u32 v188, 0xfffe9e00, v188
    s_sub_u32 s101, s79, 7
    v_mfma_f32_16x16x32_bf16 v[40:43], v[148:151], a[20:23], v[40:43]
    buffer_load_dwordx4 v181, s[36:39], s24 offen offset:1024 lds
    s_min_u32 s79, s79, s101
    v_mfma_f32_16x16x32_bf16 v[44:47], v[148:151], a[84:87], v[44:47]
    s_add_u32 s79, s79, s3
L_pad_q_0:
    s_cbranch_execz L_walked_q
    s_lshl_b32 s79, s79, 15
    v_mfma_f32_16x16x32_bf16 v[56:59], v[148:151], a[148:151], v[56:59]
    s_add_u32 s80, s90, 4
    s_sub_u32 s101, s80, 7
    v_mfma_f32_16x16x32_bf16 v[60:63], v[148:151], a[212:215], v[60:63]
    s_min_u32 s80, s80, s101
    s_add_u32 s80, s80, s3
    v_mfma_f32_16x16x32_bf16 v[64:67], v[152:155], a[20:23], v[64:67]
    s_lshl_b32 s80, s80, 15
    s_add_u32 s81, s90, 5
    v_mfma_f32_16x16x32_bf16 v[68:71], v[152:155], a[84:87], v[68:71]
    s_sub_u32 s101, s81, 7
    s_min_u32 s81, s81, s101
    v_mfma_f32_16x16x32_bf16 v[80:83], v[152:155], a[148:151], v[80:83]
    buffer_load_dwordx4 v182, s[36:39], s24 offen offset:2048 lds
    s_add_u32 s81, s81, s3
    v_mfma_f32_16x16x32_bf16 v[84:87], v[152:155], a[212:215], v[84:87]
    s_lshl_b32 s81, s81, 15
    s_add_u32 s82, s90, 6
    s_waitcnt lgkmcnt(0)
    v_mfma_f32_16x16x32_bf16 v[72:75], v[156:159], a[20:23], v[72:75]
    s_sub_u32 s101, s82, 7
    s_min_u32 s82, s82, s101
    v_mfma_f32_16x16x32_bf16 v[76:79], v[156:159], a[84:87], v[76:79]
    s_add_u32 s82, s82, s3
    s_lshl_b32 s82, s82, 15
    v_mfma_f32_16x16x32_bf16 v[88:91], v[156:159], a[148:151], v[88:91]
    v_mfma_f32_16x16x32_bf16 v[92:95], v[156:159], a[212:215], v[92:95]
    s_waitcnt vmcnt(11)
    s_barrier
    buffer_load_dword v196, v196, s[48:51], 0 offen
    buffer_load_dword v197, v197, s[52:55], 0 offen
    ds_read_b128 a[24:27], v200 offset:0
    ds_read_b128 a[88:91], v200 offset:2048
    v_mfma_f32_16x16x32_bf16 v[96:99], v[160:163], a[20:23], v[96:99]
    ds_read_b64_tr_b16 v[144:145], v187 offset:0
    ds_read_b64_tr_b16 v[146:147], v187 offset:896
    v_mfma_f32_16x16x32_bf16 v[100:103], v[160:163], a[84:87], v[100:103]
    s_add_u32 m0, s97, 90624
    s_nop 0
    buffer_load_dwordx4 v226, s[28:31], s9 offen lds
    v_mfma_f32_16x16x32_bf16 v[104:107], v[164:167], a[20:23], v[104:107]
    ds_read_b128 a[152:155], v202 offset:0
    ds_read_b128 a[216:219], v202 offset:2048
    v_mfma_f32_16x16x32_bf16 v[108:111], v[164:167], a[84:87], v[108:111]
    s_lshr_b32 s101, s99, 1
    s_add_u32 s101, s101, s100
    s_waitcnt lgkmcnt(2)
    v_mfma_f32_16x16x32_bf16 v[0:3], v[144:147], a[24:27], v[0:3]
    ds_read_b64_tr_b16 v[148:149], v187 offset:14464
    ds_read_b64_tr_b16 v[150:151], v187 offset:15360
    v_mfma_f32_16x16x32_bf16 v[4:7], v[144:147], a[88:91], v[4:7]
    buffer_load_dwordx4 v227, s[28:31], s9 offen offset:1024 lds
    s_lshl_b32 s3, s91, 2
    s_waitcnt lgkmcnt(3)
    v_mfma_f32_16x16x32_bf16 v[16:19], v[144:147], a[152:155], v[16:19]
    ds_read_b64_tr_b16 v[152:153], v187 offset:32
    ds_read_b64_tr_b16 v[154:155], v187 offset:928
    s_waitcnt lgkmcnt(4)
    v_mfma_f32_16x16x32_bf16 v[20:23], v[144:147], a[216:219], v[20:23]
    s_add_u32 s87, s101, 0
    s_and_b32 s87, s87, 3
    s_waitcnt lgkmcnt(2)
    v_mfma_f32_16x16x32_bf16 v[8:11], v[148:151], a[24:27], v[8:11]
    ds_read_b64_tr_b16 v[156:157], v187 offset:14496
    ds_read_b64_tr_b16 v[158:159], v187 offset:15392
    v_mfma_f32_16x16x32_bf16 v[12:15], v[148:151], a[88:91], v[12:15]
    s_add_u32 s87, s87, s3
    s_lshl_b32 s87, s87, 15
    v_mfma_f32_16x16x32_bf16 v[24:27], v[148:151], a[152:155], v[24:27]
    ds_read_b64_tr_b16 v[160:161], v187 offset:64
    ds_read_b64_tr_b16 v[162:163], v187 offset:960
    v_mfma_f32_16x16x32_bf16 v[28:31], v[148:151], a[216:219], v[28:31]
    buffer_load_dwordx4 v228, s[28:31], s9 offen offset:2048 lds
    s_mov_b32 s83, s87
    s_waitcnt lgkmcnt(4)
    v_mfma_f32_16x16x32_bf16 v[32:35], v[152:155], a[24:27], v[32:35]
    ds_read_b64_tr_b16 v[164:165], v187 offset:14528
    ds_read_b64_tr_b16 v[166:167], v187 offset:15424
    v_mfma_f32_16x16x32_bf16 v[36:39], v[152:155], a[88:91], v[36:39]
    s_add_u32 s88, s101, 1
    s_and_b32 s88, s88, 3
    v_mfma_f32_16x16x32_bf16 v[48:51], v[152:155], a[152:155], v[48:51]
    ds_read_b64_tr_b16 v[144:145], v188 offset:192
    ds_read_b64_tr_b16 v[146:147], v188 offset:1088
    v_mfma_f32_16x16x32_bf16 v[52:55], v[152:155], a[216:219], v[52:55]
    buffer_load_dwordx4 v229, s[28:31], s9 offen offset:3072 lds
    s_add_u32 s88, s88, s3
    s_waitcnt lgkmcnt(6)
    v_mfma_f32_16x16x32_bf16 v[40:43], v[156:159], a[24:27], v[40:43]
    ds_read_b64_tr_b16 v[148:149], v188 offset:14656
    ds_read_b64_tr_b16 v[150:151], v188 offset:15552
    v_mfma_f32_16x16x32_bf16 v[44:47], v[156:159], a[88:91], v[44:47]
    s_lshl_b32 s88, s88, 15
    s_mov_b32 s84, s88
    v_mfma_f32_16x16x32_bf16 v[56:59], v[156:159], a[152:155], v[56:59]
    ds_read_b128 a[28:31], v201 offset:0
    ds_read_b128 a[92:95], v201 offset:2048
    v_mfma_f32_16x16x32_bf16 v[60:63], v[156:159], a[216:219], v[60:63]
    s_add_u32 m0, s12, 90624
    s_add_u32 s89, s101, 2
    s_waitcnt lgkmcnt(8)
    v_mfma_f32_16x16x32_bf16 v[64:67], v[160:163], a[24:27], v[64:67]
    ds_read_b64_tr_b16 v[152:153], v187 offset:3584
    ds_read_b64_tr_b16 v[154:155], v187 offset:4480
    v_mfma_f32_16x16x32_bf16 v[68:71], v[160:163], a[88:91], v[68:71]
    buffer_load_dwordx4 v176, s[36:39], s25 offen lds
    s_and_b32 s89, s89, 3
    v_mfma_f32_16x16x32_bf16 v[80:83], v[160:163], a[152:155], v[80:83]
    ds_read_b128 a[156:159], v203 offset:0
    ds_read_b128 a[220:223], v203 offset:2048
    v_mfma_f32_16x16x32_bf16 v[84:87], v[160:163], a[216:219], v[84:87]
    s_add_u32 s89, s89, s3
    s_lshl_b32 s89, s89, 15
    s_waitcnt lgkmcnt(8)
    v_mfma_f32_16x16x32_bf16 v[72:75], v[164:167], a[24:27], v[72:75]
    ds_read_b64_tr_b16 v[156:157], v187 offset:18048
    ds_read_b64_tr_b16 v[158:159], v187 offset:18944
    v_mfma_f32_16x16x32_bf16 v[76:79], v[164:167], a[88:91], v[76:79]
    buffer_load_dwordx4 v177, s[36:39], s25 offen offset:1024 lds
    s_mov_b32 s85, s89
    v_mfma_f32_16x16x32_bf16 v[88:91], v[164:167], a[152:155], v[88:91]
    ds_read_b64_tr_b16 v[160:161], v187 offset:3616
    ds_read_b64_tr_b16 v[162:163], v187 offset:4512
    v_mfma_f32_16x16x32_bf16 v[92:95], v[164:167], a[216:219], v[92:95]
    s_add_u32 s90, s101, 3
    s_and_b32 s90, s90, 3
    v_mfma_f32_16x16x32_bf16 v[96:99], v[144:147], a[24:27], v[96:99]
    ds_read_b64_tr_b16 v[164:165], v187 offset:18080
    ds_read_b64_tr_b16 v[166:167], v187 offset:18976
    v_mfma_f32_16x16x32_bf16 v[100:103], v[144:147], a[88:91], v[100:103]
    s_add_u32 s90, s90, s3
    s_lshl_b32 s90, s90, 15
    s_waitcnt lgkmcnt(8)
    v_mfma_f32_16x16x32_bf16 v[104:107], v[148:151], a[24:27], v[104:107]
    ds_read_b64_tr_b16 v[144:145], v187 offset:3648
    ds_read_b64_tr_b16 v[146:147], v187 offset:4544
    v_mfma_f32_16x16x32_bf16 v[108:111], v[148:151], a[88:91], v[108:111]
    buffer_load_dwordx4 v178, s[36:39], s25 offen offset:2048 lds
    s_mov_b32 s86, s90
    v_mfma_f32_16x16x32_bf16 v[0:3], v[152:155], a[28:31], v[0:3]
    ds_read_b64_tr_b16 v[148:149], v187 offset:18112
    ds_read_b64_tr_b16 v[150:151], v187 offset:19008
    v_mfma_f32_16x16x32_bf16 v[4:7], v[152:155], a[92:95], v[4:7]
    s_lshl_b32 s101, s99, 7
    v_lshrrev_b32 v113, 3, v255
    s_waitcnt lgkmcnt(8)
    v_mfma_f32_16x16x32_bf16 v[16:19], v[152:155], a[156:159], v[16:19]
    v_mfma_f32_16x16x32_bf16 v[20:23], v[152:155], a[220:223], v[20:23]
    ds_read_b64_tr_b16 v[152:153], v188 offset:3776
    ds_read_b64_tr_b16 v[154:155], v188 offset:4672
    buffer_load_dwordx4 v179, s[36:39], s25 offen offset:3072 lds
    v_lshl_add_u32 v112, v113, 10, s101
    v_mfma_f32_16x16x32_bf16 v[8:11], v[156:159], a[28:31], v[8:11]
    v_and_b32 v117, 7, v255
    v_lshrrev_b32 v116, 1, v117
    v_mfma_f32_16x16x32_bf16 v[12:15], v[156:159], a[92:95], v[12:15]
    v_bfe_u32 v118, v255, 4, 1
    v_xor_b32 v115, v116, v118
    v_mfma_f32_16x16x32_bf16 v[24:27], v[156:159], a[156:159], v[24:27]
    v_mfma_f32_16x16x32_bf16 v[28:31], v[156:159], a[220:223], v[28:31]
    ds_read_b64_tr_b16 v[156:157], v188 offset:18240
    ds_read_b64_tr_b16 v[158:159], v188 offset:19136
    s_add_u32 m0, s12, 94720
    v_and_b32 v120, 1, v255
    s_waitcnt lgkmcnt(6)
    v_mfma_f32_16x16x32_bf16 v[32:35], v[160:163], a[28:31], v[32:35]
    v_add_u32 v200, 0xb100, v200
    v_add_u32 v201, 0xb100, v201
    v_mfma_f32_16x16x32_bf16 v[36:39], v[160:163], a[92:95], v[36:39]
    v_add_u32 v202, 0xb100, v202
    buffer_load_dwordx4 v180, s[36:39], s25 offen lds
    v_mfma_f32_16x16x32_bf16 v[48:51], v[160:163], a[156:159], v[48:51]
    v_add_u32 v203, 0xb100, v203
    v_add_u32 v187, 0xb100, v187
    v_mfma_f32_16x16x32_bf16 v[52:55], v[160:163], a[220:223], v[52:55]
    v_add_u32 v188, 0xb100, v188
    v_lshlrev_b32 v119, 4, v120
    v_mfma_f32_16x16x32_bf16 v[40:43], v[164:167], a[28:31], v[40:43]
    v_xor_b32 v168, v168, v195
    v_xor_b32 v169, v169, v195
    v_mfma_f32_16x16x32_bf16 v[44:47], v[164:167], a[92:95], v[44:47]
    v_xor_b32 v170, v170, v195
    buffer_load_dwordx4 v181, s[36:39], s25 offen offset:1024 lds
    v_mfma_f32_16x16x32_bf16 v[56:59], v[164:167], a[156:159], v[56:59]
    v_xor_b32 v171, v171, v195
    v_xor_b32 v172, v172, v195
    v_mfma_f32_16x16x32_bf16 v[60:63], v[164:167], a[220:223], v[60:63]
    v_xor_b32 v173, v173, v195
    v_lshl_add_u32 v114, v115, 5, v119
    v_mfma_f32_16x16x32_bf16 v[64:67], v[144:147], a[28:31], v[64:67]
    v_xor_b32 v174, v174, v195
    v_xor_b32 v175, v175, v195
    v_mfma_f32_16x16x32_bf16 v[68:71], v[144:147], a[92:95], v[68:71]
    v_add_u32 v251, v112, v114
    v_lshlrev_b32 v123, 10, v113
    v_mfma_f32_16x16x32_bf16 v[80:83], v[144:147], a[156:159], v[80:83]
    buffer_load_dwordx4 v182, s[36:39], s25 offen offset:2048 lds
    v_add_u32 v122, 0x1c00, v123
    v_mfma_f32_16x16x32_bf16 v[84:87], v[144:147], a[220:223], v[84:87]
    v_add_u32 v121, s101, v122
    v_xor_b32 v125, 2, v115
    s_waitcnt lgkmcnt(0)
    v_mfma_f32_16x16x32_bf16 v[72:75], v[148:151], a[28:31], v[72:75]
    v_lshl_add_u32 v124, v125, 5, v119
    v_add_u32 v252, v121, v124
    v_mfma_f32_16x16x32_bf16 v[76:79], v[148:151], a[92:95], v[76:79]
    v_add_u32 v127, 0x3800, v123
    v_add_u32 v126, s101, v127
    v_mfma_f32_16x16x32_bf16 v[88:91], v[148:151], a[156:159], v[88:91]
    v_mfma_f32_16x16x32_bf16 v[92:95], v[148:151], a[220:223], v[92:95]
    s_waitcnt vmcnt(13)
    s_barrier
    ds_read_b128 a[32:35], v200 offset:0
    ds_read_b128 a[96:99], v200 offset:2048
    v_mfma_f32_16x16x32_bf16 v[96:99], v[152:155], a[28:31], v[96:99]
    ds_read_b64_tr_b16 v[160:161], v187 offset:0
    ds_read_b64_tr_b16 v[162:163], v187 offset:896
    v_mfma_f32_16x16x32_bf16 v[100:103], v[152:155], a[92:95], v[100:103]
    s_add_u32 m0, s97, 0
    s_nop 0
    buffer_load_dwordx4 v226, s[28:31], s10 offen lds
    v_mfma_f32_16x16x32_bf16 v[104:107], v[156:159], a[28:31], v[104:107]
    ds_read_b128 a[160:163], v202 offset:0
    ds_read_b128 a[224:227], v202 offset:2048
    v_mfma_f32_16x16x32_bf16 v[108:111], v[156:159], a[92:95], v[108:111]
    v_add_u32 v253, v126, v114
    v_add_u32 v129, 0x5400, v123
    s_waitcnt lgkmcnt(2)
    v_mfma_f32_16x16x32_bf16 v[0:3], v[160:163], a[32:35], v[0:3]
    ds_read_b64_tr_b16 v[164:165], v187 offset:14464
    ds_read_b64_tr_b16 v[166:167], v187 offset:15360
    v_mfma_f32_16x16x32_bf16 v[4:7], v[160:163], a[96:99], v[4:7]
    buffer_load_dwordx4 v227, s[28:31], s10 offen offset:1024 lds
    v_add_u32 v128, s101, v129
    s_waitcnt lgkmcnt(3)
    v_mfma_f32_16x16x32_bf16 v[16:19], v[160:163], a[160:163], v[16:19]
    ds_read_b64_tr_b16 v[144:145], v187 offset:32
    ds_read_b64_tr_b16 v[146:147], v187 offset:928
    s_waitcnt lgkmcnt(4)
    v_mfma_f32_16x16x32_bf16 v[20:23], v[160:163], a[224:227], v[20:23]
    v_add_u32 v254, v128, v124
    v_lshrrev_b32 v132, 4, v255
    s_waitcnt lgkmcnt(2)
    v_mfma_f32_16x16x32_bf16 v[8:11], v[164:167], a[32:35], v[8:11]
    ds_read_b64_tr_b16 v[148:149], v187 offset:14496
    ds_read_b64_tr_b16 v[150:151], v187 offset:15392
    v_mfma_f32_16x16x32_bf16 v[12:15], v[164:167], a[96:99], v[12:15]
    v_bfe_u32 v133, v255, 2, 2
    v_lshl_add_u32 v131, v132, 3, v133
    v_mfma_f32_16x16x32_bf16 v[24:27], v[164:167], a[160:163], v[24:27]
    ds_read_b64_tr_b16 v[152:153], v187 offset:64
    ds_read_b64_tr_b16 v[154:155], v187 offset:960
    v_mfma_f32_16x16x32_bf16 v[28:31], v[164:167], a[224:227], v[28:31]
    buffer_load_dwordx4 v228, s[28:31], s10 offen offset:2048 lds
    v_and_b32 v135, 3, v255
    s_waitcnt lgkmcnt(4)
    v_mfma_f32_16x16x32_bf16 v[32:35], v[144:147], a[32:35], v[32:35]
    ds_read_b64_tr_b16 v[156:157], v187 offset:14528
    ds_read_b64_tr_b16 v[158:159], v187 offset:15424
    v_mfma_f32_16x16x32_bf16 v[36:39], v[144:147], a[96:99], v[36:39]
    v_lshl_add_u32 v134, v135, 3, s97
    v_lshl_add_u32 v130, v131, 7, v134
    v_mfma_f32_16x16x32_bf16 v[48:51], v[144:147], a[160:163], v[48:51]
    ds_read_b64_tr_b16 v[160:161], v188 offset:192
    ds_read_b64_tr_b16 v[162:163], v188 offset:1088
    v_mfma_f32_16x16x32_bf16 v[52:55], v[144:147], a[224:227], v[52:55]
    buffer_load_dwordx4 v229, s[28:31], s10 offen offset:3072 lds
    v_lshrrev_b32 v138, 1, v133
    s_waitcnt lgkmcnt(6)
    v_mfma_f32_16x16x32_bf16 v[40:43], v[148:151], a[32:35], v[40:43]
    ds_read_b64_tr_b16 v[164:165], v188 offset:14656
    ds_read_b64_tr_b16 v[166:167], v188 offset:15552
    v_mfma_f32_16x16x32_bf16 v[44:47], v[148:151], a[96:99], v[44:47]
    v_lshl_add_u32 v137, v118, 1, v138
    v_lshlrev_b32 v136, 5, v137
    v_mfma_f32_16x16x32_bf16 v[56:59], v[148:151], a[160:163], v[56:59]
    ds_read_b128 a[36:39], v201 offset:0
    ds_read_b128 a[100:103], v201 offset:2048
    v_mfma_f32_16x16x32_bf16 v[60:63], v[148:151], a[224:227], v[60:63]
    s_add_u32 m0, s12, 0
    v_add_u32 v245, v130, v136
    s_waitcnt lgkmcnt(8)
    v_mfma_f32_16x16x32_bf16 v[64:67], v[152:155], a[32:35], v[64:67]
    ds_read_b64_tr_b16 v[144:145], v187 offset:3584
    ds_read_b64_tr_b16 v[146:147], v187 offset:4480
    v_mfma_f32_16x16x32_bf16 v[68:71], v[152:155], a[96:99], v[68:71]
    buffer_load_dwordx4 v176, s[36:39], s26 offen lds
    v_xor_b32 v246, 32, v245
    v_mfma_f32_16x16x32_bf16 v[80:83], v[152:155], a[160:163], v[80:83]
    ds_read_b128 a[164:167], v203 offset:0
    ds_read_b128 a[228:231], v203 offset:2048
    v_mfma_f32_16x16x32_bf16 v[84:87], v[152:155], a[224:227], v[84:87]
    v_xor_b32 v247, 64, v245
    v_xor_b32 v248, 96, v245
    s_waitcnt lgkmcnt(8)
    v_mfma_f32_16x16x32_bf16 v[72:75], v[156:159], a[32:35], v[72:75]
    ds_read_b64_tr_b16 v[148:149], v187 offset:18048
    ds_read_b64_tr_b16 v[150:151], v187 offset:18944
    v_mfma_f32_16x16x32_bf16 v[76:79], v[156:159], a[96:99], v[76:79]
    buffer_load_dwordx4 v177, s[36:39], s26 offen offset:1024 lds
    v_and_b32 v139, 15, v255
    v_mfma_f32_16x16x32_bf16 v[88:91], v[156:159], a[160:163], v[88:91]
    ds_read_b64_tr_b16 v[152:153], v187 offset:3616
    ds_read_b64_tr_b16 v[154:155], v187 offset:4512
    v_mfma_f32_16x16x32_bf16 v[92:95], v[156:159], a[224:227], v[92:95]
    v_lshlrev_b32 v236, 2, v139
    v_lshlrev_b32 v235, 7, v139
    v_mfma_f32_16x16x32_bf16 v[96:99], v[160:163], a[32:35], v[96:99]
    ds_read_b64_tr_b16 v[156:157], v187 offset:18080
    ds_read_b64_tr_b16 v[158:159], v187 offset:18976
    v_mfma_f32_16x16x32_bf16 v[100:103], v[160:163], a[96:99], v[100:103]
    v_lshlrev_b32 v140, 4, v139
    v_lshl_add_u32 v234, v132, 9, v140
    s_waitcnt lgkmcnt(8)
    v_mfma_f32_16x16x32_bf16 v[104:107], v[164:167], a[32:35], v[104:107]
    ds_read_b64_tr_b16 v[160:161], v187 offset:3648
    ds_read_b64_tr_b16 v[162:163], v187 offset:4544
    v_mfma_f32_16x16x32_bf16 v[108:111], v[164:167], a[96:99], v[108:111]
    buffer_load_dwordx4 v178, s[36:39], s26 offen offset:2048 lds
    s_lshl_b32 s101, s93, 14
    v_mfma_f32_16x16x32_bf16 v[0:3], v[144:147], a[36:39], v[0:3]
    ds_read_b64_tr_b16 v[164:165], v187 offset:18112
    ds_read_b64_tr_b16 v[166:167], v187 offset:19008
    v_mfma_f32_16x16x32_bf16 v[4:7], v[144:147], a[100:103], v[4:7]
    s_lshl_b32 s3, s92, 11
    s_add_u32 s101, s101, s3
    s_waitcnt lgkmcnt(8)
    v_mfma_f32_16x16x32_bf16 v[16:19], v[144:147], a[164:167], v[16:19]
    v_mfma_f32_16x16x32_bf16 v[20:23], v[144:147], a[228:231], v[20:23]
    ds_read_b64_tr_b16 v[144:145], v188 offset:3776
    ds_read_b64_tr_b16 v[146:147], v188 offset:4672
    buffer_load_dwordx4 v179, s[36:39], s26 offen offset:3072 lds
    v_lshl_add_u32 v141, v113, 8, s101
    v_mfma_f32_16x16x32_bf16 v[8:11], v[148:151], a[36:39], v[8:11]
    v_lshlrev_b32 v209, 1, v117
    v_and_b32 v208, 8, v209
    v_mfma_f32_16x16x32_bf16 v[12:15], v[148:151], a[100:103], v[12:15]
    v_and_b32 v211, 7, v209
    v_xor_b32 v210, v211, v113
    v_mfma_f32_16x16x32_bf16 v[24:27], v[148:151], a[164:167], v[24:27]
    v_mfma_f32_16x16x32_bf16 v[28:31], v[148:151], a[228:231], v[28:31]
    ds_read_b64_tr_b16 v[148:149], v188 offset:18240
    ds_read_b64_tr_b16 v[150:151], v188 offset:19136
    s_add_u32 m0, s12, 4096
    v_add_u32 v143, v208, v210
    s_waitcnt lgkmcnt(6)
    v_mfma_f32_16x16x32_bf16 v[32:35], v[152:155], a[36:39], v[32:35]
    v_add_u32 v200, 0xb100, v200
    v_add_u32 v201, 0xb100, v201
    v_mfma_f32_16x16x32_bf16 v[36:39], v[152:155], a[100:103], v[36:39]
    v_add_u32 v202, 0xb100, v202
    buffer_load_dwordx4 v180, s[36:39], s26 offen lds
    v_mfma_f32_16x16x32_bf16 v[48:51], v[152:155], a[164:167], v[48:51]
    v_add_u32 v203, 0xb100, v203
    v_add_u32 v187, 0xb100, v187
    v_mfma_f32_16x16x32_bf16 v[52:55], v[152:155], a[228:231], v[52:55]
    v_add_u32 v188, 0xb100, v188
    v_lshlrev_b32 v142, 4, v143
    v_mfma_f32_16x16x32_bf16 v[40:43], v[156:159], a[36:39], v[40:43]
    buffer_load_dwordx4 v181, s[36:39], s26 offen offset:1024 lds
    v_add_u32 v224, v141, v142
    v_mfma_f32_16x16x32_bf16 v[44:47], v[156:159], a[100:103], v[44:47]
    v_lshl_add_u32 v212, v113, 8, s101
    v_add_u32 v216, 1, v209
    v_mfma_f32_16x16x32_bf16 v[56:59], v[156:159], a[164:167], v[56:59]
    v_and_b32 v215, 8, v216
    v_and_b32 v218, 7, v216
    v_mfma_f32_16x16x32_bf16 v[60:63], v[156:159], a[228:231], v[60:63]
    v_xor_b32 v217, v218, v113
    v_add_u32 v214, v215, v217
    v_mfma_f32_16x16x32_bf16 v[64:67], v[160:163], a[36:39], v[64:67]
    v_lshlrev_b32 v213, 4, v214
    v_add_u32 v225, v212, v213
    v_mfma_f32_16x16x32_bf16 v[68:71], v[160:163], a[100:103], v[68:71]
    v_mfma_f32_16x16x32_bf16 v[80:83], v[160:163], a[164:167], v[80:83]
    buffer_load_dwordx4 v182, s[36:39], s26 offen offset:2048 lds
    v_mfma_f32_16x16x32_bf16 v[84:87], v[160:163], a[228:231], v[84:87]
    s_waitcnt lgkmcnt(0)
    v_mfma_f32_16x16x32_bf16 v[72:75], v[164:167], a[36:39], v[72:75]
    v_mfma_f32_16x16x32_bf16 v[76:79], v[164:167], a[100:103], v[76:79]
    v_mfma_f32_16x16x32_bf16 v[88:91], v[164:167], a[164:167], v[88:91]
    v_mfma_f32_16x16x32_bf16 v[92:95], v[164:167], a[228:231], v[92:95]
    s_waitcnt vmcnt(11)
    s_barrier
    v_mov_b32 v240, 0
    buffer_load_dword v243, v240, s[44:47], 0 offen sc1
    ds_read_b128 a[40:43], v200 offset:0
    ds_read_b128 a[104:107], v200 offset:2048
    v_mfma_f32_16x16x32_bf16 v[96:99], v[144:147], a[36:39], v[96:99]
    ds_read_b64_tr_b16 v[152:153], v187 offset:0
    ds_read_b64_tr_b16 v[154:155], v187 offset:896
    v_mfma_f32_16x16x32_bf16 v[100:103], v[144:147], a[100:103], v[100:103]
    s_add_u32 m0, s97, 45312
    s_nop 0
    buffer_load_dwordx4 v226, s[28:31], s11 offen lds
    v_mfma_f32_16x16x32_bf16 v[104:107], v[148:151], a[36:39], v[104:107]
    ds_read_b128 a[168:171], v202 offset:0
    ds_read_b128 a[232:235], v202 offset:2048
    v_mfma_f32_16x16x32_bf16 v[108:111], v[148:151], a[100:103], v[108:111]
    s_waitcnt lgkmcnt(2)
    v_mfma_f32_16x16x32_bf16 v[0:3], v[152:155], a[40:43], v[0:3]
    ds_read_b64_tr_b16 v[156:157], v187 offset:14464
    ds_read_b64_tr_b16 v[158:159], v187 offset:15360
    v_mfma_f32_16x16x32_bf16 v[4:7], v[152:155], a[104:107], v[4:7]
    buffer_load_dwordx4 v227, s[28:31], s11 offen offset:1024 lds
    s_waitcnt lgkmcnt(3)
    v_mfma_f32_16x16x32_bf16 v[16:19], v[152:155], a[168:171], v[16:19]
    ds_read_b64_tr_b16 v[160:161], v187 offset:32
    ds_read_b64_tr_b16 v[162:163], v187 offset:928
    s_waitcnt lgkmcnt(4)
    v_mfma_f32_16x16x32_bf16 v[20:23], v[152:155], a[232:235], v[20:23]
    s_waitcnt lgkmcnt(2)
    v_mfma_f32_16x16x32_bf16 v[8:11], v[156:159], a[40:43], v[8:11]
    ds_read_b64_tr_b16 v[164:165], v187 offset:14496
    ds_read_b64_tr_b16 v[166:167], v187 offset:15392
    v_mfma_f32_16x16x32_bf16 v[12:15], v[156:159], a[104:107], v[12:15]
    v_mfma_f32_16x16x32_bf16 v[24:27], v[156:159], a[168:171], v[24:27]
    ds_read_b64_tr_b16 v[144:145], v187 offset:64
    ds_read_b64_tr_b16 v[146:147], v187 offset:960
    v_mfma_f32_16x16x32_bf16 v[28:31], v[156:159], a[232:235], v[28:31]
    buffer_load_dwordx4 v228, s[28:31], s11 offen offset:2048 lds
    s_waitcnt lgkmcnt(4)
    v_mfma_f32_16x16x32_bf16 v[32:35], v[160:163], a[40:43], v[32:35]
    ds_read_b64_tr_b16 v[148:149], v187 offset:14528
    ds_read_b64_tr_b16 v[150:151], v187 offset:15424
    v_mfma_f32_16x16x32_bf16 v[36:39], v[160:163], a[104:107], v[36:39]
    v_mfma_f32_16x16x32_bf16 v[48:51], v[160:163], a[168:171], v[48:51]
    ds_read_b64_tr_b16 v[152:153], v188 offset:192
    ds_read_b64_tr_b16 v[154:155], v188 offset:1088
    v_mfma_f32_16x16x32_bf16 v[52:55], v[160:163], a[232:235], v[52:55]
    buffer_load_dwordx4 v229, s[28:31], s11 offen offset:3072 lds
    s_waitcnt lgkmcnt(6)
    v_mfma_f32_16x16x32_bf16 v[40:43], v[164:167], a[40:43], v[40:43]
    ds_read_b64_tr_b16 v[156:157], v188 offset:14656
    ds_read_b64_tr_b16 v[158:159], v188 offset:15552
    v_mfma_f32_16x16x32_bf16 v[44:47], v[164:167], a[104:107], v[44:47]
    v_mfma_f32_16x16x32_bf16 v[56:59], v[164:167], a[168:171], v[56:59]
    ds_read_b128 a[44:47], v201 offset:0
    ds_read_b128 a[108:111], v201 offset:2048
    v_mfma_f32_16x16x32_bf16 v[60:63], v[164:167], a[232:235], v[60:63]
    s_add_u32 m0, s12, 45312
    s_waitcnt lgkmcnt(8)
    v_mfma_f32_16x16x32_bf16 v[64:67], v[144:147], a[40:43], v[64:67]
    ds_read_b64_tr_b16 v[160:161], v187 offset:3584
    ds_read_b64_tr_b16 v[162:163], v187 offset:4480
    v_mfma_f32_16x16x32_bf16 v[68:71], v[144:147], a[104:107], v[68:71]
    buffer_load_dwordx4 v176, s[36:39], s27 offen lds
    v_mfma_f32_16x16x32_bf16 v[80:83], v[144:147], a[168:171], v[80:83]
    ds_read_b128 a[172:175], v203 offset:0
    ds_read_b128 a[236:239], v203 offset:2048
    v_mfma_f32_16x16x32_bf16 v[84:87], v[144:147], a[232:235], v[84:87]
    s_waitcnt lgkmcnt(9)
    v_mfma_f32_16x16x32_bf16 v[72:75], v[148:151], a[40:43], v[72:75]
    ds_read_b64_tr_b16 v[164:165], v187 offset:18048
    ds_read_b64_tr_b16 v[166:167], v187 offset:18944
    v_mfma_f32_16x16x32_bf16 v[76:79], v[148:151], a[104:107], v[76:79]
    buffer_load_dwordx4 v177, s[36:39], s27 offen offset:1024 lds
    v_mfma_f32_16x16x32_bf16 v[88:91], v[148:151], a[168:171], v[88:91]
    ds_read_b64_tr_b16 v[144:145], v187 offset:3616
    ds_read_b64_tr_b16 v[146:147], v187 offset:4512
    v_mfma_f32_16x16x32_bf16 v[92:95], v[148:151], a[232:235], v[92:95]
    s_waitcnt lgkmcnt(9)
    v_mfma_f32_16x16x32_bf16 v[96:99], v[152:155], a[40:43], v[96:99]
    ds_read_b64_tr_b16 v[148:149], v187 offset:18080
    ds_read_b64_tr_b16 v[150:151], v187 offset:18976
    v_mfma_f32_16x16x32_bf16 v[100:103], v[152:155], a[104:107], v[100:103]
    v_mfma_f32_16x16x32_bf16 v[104:107], v[156:159], a[40:43], v[104:107]
    ds_read_b64_tr_b16 v[152:153], v187 offset:3648
    ds_read_b64_tr_b16 v[154:155], v187 offset:4544
    v_mfma_f32_16x16x32_bf16 v[108:111], v[156:159], a[104:107], v[108:111]
    buffer_load_dwordx4 v178, s[36:39], s27 offen offset:2048 lds
    s_waitcnt lgkmcnt(8)
    v_mfma_f32_16x16x32_bf16 v[0:3], v[160:163], a[44:47], v[0:3]
    ds_read_b64_tr_b16 v[156:157], v187 offset:18112
    ds_read_b64_tr_b16 v[158:159], v187 offset:19008
    v_mfma_f32_16x16x32_bf16 v[4:7], v[160:163], a[108:111], v[4:7]
    v_mfma_f32_16x16x32_bf16 v[16:19], v[160:163], a[172:175], v[16:19]
    v_mfma_f32_16x16x32_bf16 v[20:23], v[160:163], a[236:239], v[20:23]
    ds_read_b64_tr_b16 v[160:161], v188 offset:3776
    ds_read_b64_tr_b16 v[162:163], v188 offset:4672
    buffer_load_dwordx4 v179, s[36:39], s27 offen offset:3072 lds
    s_waitcnt lgkmcnt(8)
    v_mfma_f32_16x16x32_bf16 v[8:11], v[164:167], a[44:47], v[8:11]
    v_mfma_f32_16x16x32_bf16 v[12:15], v[164:167], a[108:111], v[12:15]
    v_mfma_f32_16x16x32_bf16 v[24:27], v[164:167], a[172:175], v[24:27]
    v_mfma_f32_16x16x32_bf16 v[28:31], v[164:167], a[236:239], v[28:31]
    ds_read_b64_tr_b16 v[164:165], v188 offset:18240
    ds_read_b64_tr_b16 v[166:167], v188 offset:19136
    s_add_u32 m0, s12, 49408
    v_mfma_f32_16x16x32_bf16 v[32:35], v[144:147], a[44:47], v[32:35]
    v_add_u32 v200, 0xfffe9e00, v200
    v_add_u32 v201, 0xfffe9e00, v201
    v_mfma_f32_16x16x32_bf16 v[36:39], v[144:147], a[108:111], v[36:39]
    v_add_u32 v202, 0xfffe9e00, v202
    buffer_load_dwordx4 v180, s[36:39], s27 offen lds
    v_mfma_f32_16x16x32_bf16 v[48:51], v[144:147], a[172:175], v[48:51]
    v_add_u32 v203, 0xfffe9e00, v203
    v_add_u32 v187, 0xfffe9e00, v187
    v_mfma_f32_16x16x32_bf16 v[52:55], v[144:147], a[236:239], v[52:55]
    v_add_u32 v188, 0xfffe9e00, v188
    s_waitcnt lgkmcnt(3)
    v_mfma_f32_16x16x32_bf16 v[40:43], v[148:151], a[44:47], v[40:43]
    buffer_load_dwordx4 v181, s[36:39], s27 offen offset:1024 lds
    v_mfma_f32_16x16x32_bf16 v[44:47], v[148:151], a[108:111], v[44:47]
    v_mfma_f32_16x16x32_bf16 v[56:59], v[148:151], a[172:175], v[56:59]
    v_mfma_f32_16x16x32_bf16 v[60:63], v[148:151], a[236:239], v[60:63]
    v_mfma_f32_16x16x32_bf16 v[64:67], v[152:155], a[44:47], v[64:67]
    v_mfma_f32_16x16x32_bf16 v[68:71], v[152:155], a[108:111], v[68:71]
    v_mfma_f32_16x16x32_bf16 v[80:83], v[152:155], a[172:175], v[80:83]
    buffer_load_dwordx4 v182, s[36:39], s27 offen offset:2048 lds
    v_mfma_f32_16x16x32_bf16 v[84:87], v[152:155], a[236:239], v[84:87]
    v_mfma_f32_16x16x32_bf16 v[72:75], v[156:159], a[44:47], v[72:75]
    v_mfma_f32_16x16x32_bf16 v[76:79], v[156:159], a[108:111], v[76:79]
    v_mfma_f32_16x16x32_bf16 v[88:91], v[156:159], a[172:175], v[88:91]
    v_mfma_f32_16x16x32_bf16 v[92:95], v[156:159], a[236:239], v[92:95]
    s_waitcnt lgkmcnt(0)
    s_waitcnt vmcnt(12)
    s_barrier
    ds_read_b128 a[48:51], v200 offset:0
    ds_read_b128 a[112:115], v200 offset:2048
    v_mfma_f32_16x16x32_bf16 v[96:99], v[160:163], a[44:47], v[96:99]
    ds_read_b64_tr_b16 v[144:145], v187 offset:0
    ds_read_b64_tr_b16 v[146:147], v187 offset:896
    v_mfma_f32_16x16x32_bf16 v[100:103], v[160:163], a[108:111], v[100:103]
    s_add_u32 m0, s14, 98304
    s_nop 0
    buffer_load_dwordx4 v183, s[32:35], s71 offen lds
    v_mfma_f32_16x16x32_bf16 v[104:107], v[164:167], a[44:47], v[104:107]
    ds_read_b128 a[176:179], v202 offset:0
    ds_read_b128 a[240:243], v202 offset:2048
    v_mfma_f32_16x16x32_bf16 v[108:111], v[164:167], a[108:111], v[108:111]
    s_waitcnt lgkmcnt(2)
    v_mfma_f32_16x16x32_bf16 v[0:3], v[144:147], a[48:51], v[0:3]
    ds_read_b64_tr_b16 v[148:149], v187 offset:14464
    ds_read_b64_tr_b16 v[150:151], v187 offset:15360
    v_mfma_f32_16x16x32_bf16 v[4:7], v[144:147], a[112:115], v[4:7]
    buffer_load_dwordx4 v184, s[32:35], s71 offen offset:1024 lds
    s_waitcnt lgkmcnt(3)
    v_mfma_f32_16x16x32_bf16 v[16:19], v[144:147], a[176:179], v[16:19]
    ds_read_b64_tr_b16 v[152:153], v187 offset:32
    ds_read_b64_tr_b16 v[154:155], v187 offset:928
    s_waitcnt lgkmcnt(4)
    v_mfma_f32_16x16x32_bf16 v[20:23], v[144:147], a[240:243], v[20:23]
    s_waitcnt lgkmcnt(2)
    v_mfma_f32_16x16x32_bf16 v[8:11], v[148:151], a[48:51], v[8:11]
    ds_read_b64_tr_b16 v[156:157], v187 offset:14496
    ds_read_b64_tr_b16 v[158:159], v187 offset:15392
    v_mfma_f32_16x16x32_bf16 v[12:15], v[148:151], a[112:115], v[12:15]
    v_mfma_f32_16x16x32_bf16 v[24:27], v[148:151], a[176:179], v[24:27]
    ds_read_b64_tr_b16 v[160:161], v187 offset:64
    ds_read_b64_tr_b16 v[162:163], v187 offset:960
    v_mfma_f32_16x16x32_bf16 v[28:31], v[148:151], a[240:243], v[28:31]
    buffer_load_dwordx4 v185, s[32:35], s71 offen offset:2048 lds
    s_waitcnt lgkmcnt(4)
    v_mfma_f32_16x16x32_bf16 v[32:35], v[152:155], a[48:51], v[32:35]
    ds_read_b64_tr_b16 v[164:165], v187 offset:14528
    ds_read_b64_tr_b16 v[166:167], v187 offset:15424
    v_mfma_f32_16x16x32_bf16 v[36:39], v[152:155], a[112:115], v[36:39]
    v_mfma_f32_16x16x32_bf16 v[48:51], v[152:155], a[176:179], v[48:51]
    ds_read_b64_tr_b16 v[144:145], v188 offset:192
    ds_read_b64_tr_b16 v[146:147], v188 offset:1088
    v_mfma_f32_16x16x32_bf16 v[52:55], v[152:155], a[240:243], v[52:55]
    buffer_load_dwordx4 v186, s[32:35], s71 offen offset:3072 lds
    s_waitcnt lgkmcnt(6)
    v_mfma_f32_16x16x32_bf16 v[40:43], v[156:159], a[48:51], v[40:43]
    ds_read_b64_tr_b16 v[148:149], v188 offset:14656
    ds_read_b64_tr_b16 v[150:151], v188 offset:15552
    v_mfma_f32_16x16x32_bf16 v[44:47], v[156:159], a[112:115], v[44:47]
    v_mfma_f32_16x16x32_bf16 v[56:59], v[156:159], a[176:179], v[56:59]
    ds_read_b128 a[52:55], v201 offset:0
    ds_read_b128 a[116:119], v201 offset:2048
    v_mfma_f32_16x16x32_bf16 v[60:63], v[156:159], a[240:243], v[60:63]
    s_add_u32 s71, s71, 98304
    s_add_u32 m0, s14, 102400
    s_waitcnt lgkmcnt(8)
    v_mfma_f32_16x16x32_bf16 v[64:67], v[160:163], a[48:51], v[64:67]
    ds_read_b64_tr_b16 v[152:153], v187 offset:3584
    ds_read_b64_tr_b16 v[154:155], v187 offset:4480
    v_mfma_f32_16x16x32_bf16 v[68:71], v[160:163], a[112:115], v[68:71]
    buffer_load_dwordx4 v183, s[32:35], s71 offen lds
    v_mfma_f32_16x16x32_bf16 v[80:83], v[160:163], a[176:179], v[80:83]
    ds_read_b128 a[180:183], v203 offset:0
    ds_read_b128 a[244:247], v203 offset:2048
    v_mfma_f32_16x16x32_bf16 v[84:87], v[160:163], a[240:243], v[84:87]
    s_waitcnt lgkmcnt(8)
    v_mfma_f32_16x16x32_bf16 v[72:75], v[164:167], a[48:51], v[72:75]
    ds_read_b64_tr_b16 v[156:157], v187 offset:18048
L_pad_q_1:
    s_cbranch_execz L_walked_q
    ds_read_b64_tr_b16 v[158:159], v187 offset:18944
    v_mfma_f32_16x16x32_bf16 v[76:79], v[164:167], a[112:115], v[76:79]
    buffer_load_dwordx4 v184, s[32:35], s71 offen offset:1024 lds
    v_mfma_f32_16x16x32_bf16 v[88:91], v[164:167], a[176:179], v[88:91]
    ds_read_b64_tr_b16 v[160:161], v187 offset:3616
    ds_read_b64_tr_b16 v[162:163], v187 offset:4512
    v_mfma_f32_16x16x32_bf16 v[92:95], v[164:167], a[240:243], v[92:95]
    v_mfma_f32_16x16x32_bf16 v[96:99], v[144:147], a[48:51], v[96:99]
    ds_read_b64_tr_b16 v[164:165], v187 offset:18080
    ds_read_b64_tr_b16 v[166:167], v187 offset:18976
    v_mfma_f32_16x16x32_bf16 v[100:103], v[144:147], a[112:115], v[100:103]
    s_waitcnt lgkmcnt(9)
    v_mfma_f32_16x16x32_bf16 v[104:107], v[148:151], a[48:51], v[104:107]
    ds_read_b64_tr_b16 v[144:145], v187 offset:3648
    ds_read_b64_tr_b16 v[146:147], v187 offset:4544
    v_mfma_f32_16x16x32_bf16 v[108:111], v[148:151], a[112:115], v[108:111]
    buffer_load_dwordx4 v185, s[32:35], s71 offen offset:2048 lds
    s_waitcnt lgkmcnt(8)
    v_mfma_f32_16x16x32_bf16 v[0:3], v[152:155], a[52:55], v[0:3]
    ds_read_b64_tr_b16 v[148:149], v187 offset:18112
    ds_read_b64_tr_b16 v[150:151], v187 offset:19008
    v_mfma_f32_16x16x32_bf16 v[4:7], v[152:155], a[116:119], v[4:7]
    v_mfma_f32_16x16x32_bf16 v[16:19], v[152:155], a[180:183], v[16:19]
    v_mfma_f32_16x16x32_bf16 v[20:23], v[152:155], a[244:247], v[20:23]
    ds_read_b64_tr_b16 v[152:153], v188 offset:3776
    ds_read_b64_tr_b16 v[154:155], v188 offset:4672
    buffer_load_dwordx4 v186, s[32:35], s71 offen offset:3072 lds
    s_waitcnt lgkmcnt(8)
    v_mfma_f32_16x16x32_bf16 v[8:11], v[156:159], a[52:55], v[8:11]
    v_mfma_f32_16x16x32_bf16 v[12:15], v[156:159], a[116:119], v[12:15]
    v_mfma_f32_16x16x32_bf16 v[24:27], v[156:159], a[180:183], v[24:27]
    v_mfma_f32_16x16x32_bf16 v[28:31], v[156:159], a[244:247], v[28:31]
    ds_read_b64_tr_b16 v[156:157], v188 offset:18240
    ds_read_b64_tr_b16 v[158:159], v188 offset:19136
    s_add_u32 m0, s97, 131072
    v_mfma_f32_16x16x32_bf16 v[32:35], v[160:163], a[52:55], v[32:35]
    v_add_u32 v200, 0xb100, v200
    v_add_u32 v201, 0xb100, v201
    v_mfma_f32_16x16x32_bf16 v[36:39], v[160:163], a[116:119], v[36:39]
    v_add_u32 v202, 0xb100, v202
    buffer_load_dwordx4 v251, s[48:51], s76 offen lds
    v_mfma_f32_16x16x32_bf16 v[48:51], v[160:163], a[180:183], v[48:51]
    v_add_u32 v203, 0xb100, v203
    v_add_u32 v187, 0xb100, v187
    v_mfma_f32_16x16x32_bf16 v[52:55], v[160:163], a[244:247], v[52:55]
    v_add_u32 v188, 0xb100, v188
    s_waitcnt lgkmcnt(3)
    v_mfma_f32_16x16x32_bf16 v[40:43], v[164:167], a[52:55], v[40:43]
    buffer_load_dwordx4 v252, s[48:51], s76 offen offset:1024 lds
    v_mfma_f32_16x16x32_bf16 v[44:47], v[164:167], a[116:119], v[44:47]
    v_mfma_f32_16x16x32_bf16 v[56:59], v[164:167], a[180:183], v[56:59]
    v_mfma_f32_16x16x32_bf16 v[60:63], v[164:167], a[244:247], v[60:63]
    v_mfma_f32_16x16x32_bf16 v[64:67], v[144:147], a[52:55], v[64:67]
    v_mfma_f32_16x16x32_bf16 v[68:71], v[144:147], a[116:119], v[68:71]
    v_mfma_f32_16x16x32_bf16 v[80:83], v[144:147], a[180:183], v[80:83]
    buffer_load_dwordx4 v253, s[48:51], s76 offen offset:2048 lds
    v_mfma_f32_16x16x32_bf16 v[84:87], v[144:147], a[244:247], v[84:87]
    v_mfma_f32_16x16x32_bf16 v[72:75], v[148:151], a[52:55], v[72:75]
    v_mfma_f32_16x16x32_bf16 v[76:79], v[148:151], a[116:119], v[76:79]
    v_mfma_f32_16x16x32_bf16 v[88:91], v[148:151], a[180:183], v[88:91]
    v_mfma_f32_16x16x32_bf16 v[92:95], v[148:151], a[244:247], v[92:95]
    s_waitcnt lgkmcnt(0)
    s_waitcnt vmcnt(11)
    s_barrier
    v_cmp_eq_u32 vcc, 0, v243
    s_mov_b32 s101, 65536
    s_nop 3
    s_cbranch_vccz L_ok1
L_spin1:
    buffer_load_dword v243, v240, s[44:47], 0 offen sc1
    s_sub_u32 s101, s101, 1
    s_cmp_eq_u32 s101, 0
    s_cbranch_scc1 L_ok1
    s_waitcnt vmcnt(0)
    v_cmp_eq_u32 vcc, 0, v243
    s_nop 4
    s_cbranch_vccnz L_spin1
L_ok1:
    ds_read_b128 a[56:59], v200 offset:0
    ds_read_b128 a[120:123], v200 offset:2048
    buffer_load_dwordx4 v254, s[48:51], s76 offen offset:3072 lds
    v_mfma_f32_16x16x32_bf16 v[96:99], v[152:155], a[52:55], v[96:99]
    ds_read_b64_tr_b16 v[160:161], v187 offset:0
    ds_read_b64_tr_b16 v[162:163], v187 offset:896
    v_mfma_f32_16x16x32_bf16 v[100:103], v[152:155], a[116:119], v[100:103]
    v_mfma_f32_16x16x32_bf16 v[104:107], v[156:159], a[52:55], v[104:107]
    ds_read_b128 a[184:187], v202 offset:0
    ds_read_b128 a[248:251], v202 offset:2048
    v_mfma_f32_16x16x32_bf16 v[108:111], v[156:159], a[116:119], v[108:111]
    s_add_u32 m0, s14, 0
    s_waitcnt lgkmcnt(2)
    v_mfma_f32_16x16x32_bf16 v[0:3], v[160:163], a[56:59], v[0:3]
    ds_read_b64_tr_b16 v[164:165], v187 offset:14464
    ds_read_b64_tr_b16 v[166:167], v187 offset:15360
    v_mfma_f32_16x16x32_bf16 v[4:7], v[160:163], a[120:123], v[4:7]
    buffer_load_dwordx4 v183, s[32:35], s73 offen lds
    s_waitcnt lgkmcnt(3)
    v_mfma_f32_16x16x32_bf16 v[16:19], v[160:163], a[184:187], v[16:19]
    ds_read_b128 a[60:63], v201 offset:0
    ds_read_b128 a[124:127], v201 offset:2048
    s_waitcnt lgkmcnt(4)
    v_mfma_f32_16x16x32_bf16 v[20:23], v[160:163], a[248:251], v[20:23]
    s_waitcnt lgkmcnt(2)
    v_mfma_f32_16x16x32_bf16 v[8:11], v[164:167], a[56:59], v[8:11]
    ds_read_b64_tr_b16 v[144:145], v187 offset:3584
    ds_read_b64_tr_b16 v[146:147], v187 offset:4480
    v_mfma_f32_16x16x32_bf16 v[12:15], v[164:167], a[120:123], v[12:15]
    buffer_load_dwordx4 v184, s[32:35], s73 offen offset:1024 lds
    v_mfma_f32_16x16x32_bf16 v[24:27], v[164:167], a[184:187], v[24:27]
    ds_read_b128 a[188:191], v203 offset:0
    ds_read_b128 a[252:255], v203 offset:2048
    v_mfma_f32_16x16x32_bf16 v[28:31], v[164:167], a[248:251], v[28:31]
    s_waitcnt lgkmcnt(2)
    v_mfma_f32_16x16x32_bf16 v[0:3], v[144:147], a[60:63], v[0:3]
    ds_read_b64_tr_b16 v[148:149], v187 offset:18048
    ds_read_b64_tr_b16 v[150:151], v187 offset:18944
    v_mfma_f32_16x16x32_bf16 v[4:7], v[144:147], a[124:127], v[4:7]
    s_waitcnt lgkmcnt(3)
    v_mfma_f32_16x16x32_bf16 v[16:19], v[144:147], a[188:191], v[16:19]
    ds_read_b64_tr_b16 v[152:153], v188 offset:192
    ds_read_b64_tr_b16 v[154:155], v188 offset:1088
    s_waitcnt lgkmcnt(4)
    v_mfma_f32_16x16x32_bf16 v[20:23], v[144:147], a[252:255], v[20:23]
    buffer_load_dwordx4 v185, s[32:35], s73 offen offset:2048 lds
    s_waitcnt lgkmcnt(2)
    v_mfma_f32_16x16x32_bf16 v[8:11], v[148:151], a[60:63], v[8:11]
    ds_read_b64_tr_b16 v[156:157], v188 offset:14656
    ds_read_b64_tr_b16 v[158:159], v188 offset:15552
    v_mfma_f32_16x16x32_bf16 v[12:15], v[148:151], a[124:127], v[12:15]
    v_mfma_f32_16x16x32_bf16 v[24:27], v[148:151], a[188:191], v[24:27]
    ds_read_b64_tr_b16 v[160:161], v188 offset:3776
    ds_read_b64_tr_b16 v[162:163], v188 offset:4672
    v_mfma_f32_16x16x32_bf16 v[28:31], v[148:151], a[252:255], v[28:31]
    buffer_load_dwordx4 v186, s[32:35], s73 offen offset:3072 lds
    s_waitcnt lgkmcnt(4)
    v_mfma_f32_16x16x32_bf16 v[96:99], v[152:155], a[56:59], v[96:99]
    ds_read_b64_tr_b16 v[164:165], v188 offset:18240
    ds_read_b64_tr_b16 v[166:167], v188 offset:19136
    v_mfma_f32_16x16x32_bf16 v[100:103], v[152:155], a[120:123], v[100:103]
    s_waitcnt lgkmcnt(4)
    v_mfma_f32_16x16x32_bf16 v[104:107], v[156:159], a[56:59], v[104:107]
    ds_read_b64_tr_b16 v[144:145], v187 offset:32
    ds_read_b64_tr_b16 v[146:147], v187 offset:928
    v_mfma_f32_16x16x32_bf16 v[108:111], v[156:159], a[120:123], v[108:111]
    s_add_u32 s73, s73, 98304
    s_add_u32 m0, s14, 4096
    s_waitcnt lgkmcnt(4)
    v_mfma_f32_16x16x32_bf16 v[96:99], v[160:163], a[60:63], v[96:99]
    ds_read_b64_tr_b16 v[148:149], v187 offset:14496
    ds_read_b64_tr_b16 v[150:151], v187 offset:15392
    v_mfma_f32_16x16x32_bf16 v[100:103], v[160:163], a[124:127], v[100:103]
    buffer_load_dwordx4 v183, s[32:35], s73 offen lds
    v_mul_f32 v0, v0, v8
    s_waitcnt lgkmcnt(4)
    v_mfma_f32_16x16x32_bf16 v[104:107], v[164:167], a[60:63], v[104:107]
    ds_read_b64_tr_b16 v[152:153], v187 offset:3616
    ds_read_b64_tr_b16 v[154:155], v187 offset:4512
    v_mfma_f32_16x16x32_bf16 v[108:111], v[164:167], a[124:127], v[108:111]
    v_mul_f32 v1, v1, v9
    v_mul_f32 v2, v2, v10
    s_waitcnt lgkmcnt(4)
    v_mfma_f32_16x16x32_bf16 v[32:35], v[144:147], a[56:59], v[32:35]
    ds_read_b64_tr_b16 v[156:157], v187 offset:18080
    ds_read_b64_tr_b16 v[158:159], v187 offset:18976
    v_mfma_f32_16x16x32_bf16 v[36:39], v[144:147], a[120:123], v[36:39]
    buffer_load_dwordx4 v184, s[32:35], s73 offen offset:1024 lds
    v_mul_f32 v3, v3, v11
    v_mfma_f32_16x16x32_bf16 v[48:51], v[144:147], a[184:187], v[48:51]
    ds_read_b64_tr_b16 v[160:161], v187 offset:64
    ds_read_b64_tr_b16 v[162:163], v187 offset:960
    v_mfma_f32_16x16x32_bf16 v[52:55], v[144:147], a[248:251], v[52:55]
    v_mul_f32 v4, v4, v12
    v_mul_f32 v5, v5, v13
    s_waitcnt lgkmcnt(6)
    v_mfma_f32_16x16x32_bf16 v[40:43], v[148:151], a[56:59], v[40:43]
    ds_read_b64_tr_b16 v[164:165], v187 offset:14528
    ds_read_b64_tr_b16 v[166:167], v187 offset:15424
    v_mfma_f32_16x16x32_bf16 v[44:47], v[148:151], a[120:123], v[44:47]
    v_mul_f32 v6, v6, v14
    v_mul_f32 v7, v7, v15
    v_mfma_f32_16x16x32_bf16 v[56:59], v[148:151], a[184:187], v[56:59]
    ds_read_b64_tr_b16 v[144:145], v187 offset:3648
    ds_read_b64_tr_b16 v[146:147], v187 offset:4544
    v_mfma_f32_16x16x32_bf16 v[60:63], v[148:151], a[248:251], v[60:63]
    buffer_load_dwordx4 v185, s[32:35], s73 offen offset:2048 lds
    v_cvt_pk_bf16_f32 v8, v0, v1
    s_waitcnt lgkmcnt(8)
    v_mfma_f32_16x16x32_bf16 v[32:35], v[152:155], a[60:63], v[32:35]
    ds_read_b64_tr_b16 v[148:149], v187 offset:18112
    ds_read_b64_tr_b16 v[150:151], v187 offset:19008
    v_mfma_f32_16x16x32_bf16 v[36:39], v[152:155], a[124:127], v[36:39]
    v_cvt_pk_bf16_f32 v9, v2, v3
    v_cvt_pk_bf16_f32 v10, v4, v5
    v_mfma_f32_16x16x32_bf16 v[48:51], v[152:155], a[188:191], v[48:51]
    buffer_load_dwordx4 v186, s[32:35], s73 offen offset:3072 lds
    v_cvt_pk_bf16_f32 v11, v6, v7
    v_mfma_f32_16x16x32_bf16 v[52:55], v[152:155], a[252:255], v[52:55]
    v_permlane16_swap_b32 v8, v10
    v_permlane16_swap_b32 v9, v11
    s_waitcnt lgkmcnt(6)
    v_mfma_f32_16x16x32_bf16 v[40:43], v[156:159], a[60:63], v[40:43]
    buffer_store_dwordx4 v[8:11], v244, s[40:43], s68 offen sc1
    v_mul_f32 v16, v16, v24
    v_mfma_f32_16x16x32_bf16 v[44:47], v[156:159], a[124:127], v[44:47]
    v_mul_f32 v17, v17, v25
    v_mul_f32 v18, v18, v26
    v_mfma_f32_16x16x32_bf16 v[56:59], v[156:159], a[188:191], v[56:59]
    v_mul_f32 v19, v19, v27
    v_mul_f32 v20, v20, v28
    v_mfma_f32_16x16x32_bf16 v[60:63], v[156:159], a[252:255], v[60:63]
    v_mul_f32 v21, v21, v29
    v_mul_f32 v22, v22, v30
    v_mfma_f32_16x16x32_bf16 v[64:67], v[160:163], a[56:59], v[64:67]
    v_mul_f32 v23, v23, v31
    v_cvt_pk_bf16_f32 v24, v16, v17
    v_mfma_f32_16x16x32_bf16 v[68:71], v[160:163], a[120:123], v[68:71]
    v_cvt_pk_bf16_f32 v25, v18, v19
    v_cvt_pk_bf16_f32 v26, v20, v21
    v_mfma_f32_16x16x32_bf16 v[80:83], v[160:163], a[184:187], v[80:83]
    v_cvt_pk_bf16_f32 v27, v22, v23
    v_permlane16_swap_b32 v24, v26
    v_mfma_f32_16x16x32_bf16 v[84:87], v[160:163], a[248:251], v[84:87]
    v_permlane16_swap_b32 v25, v27
    buffer_store_dwordx4 v[24:27], v244, s[40:43], s69 offen sc1
    s_waitcnt lgkmcnt(0)
    v_mfma_f32_16x16x32_bf16 v[72:75], v[164:167], a[56:59], v[72:75]
    v_mul_f32 v96, v96, v104
    v_mul_f32 v97, v97, v105
    v_mfma_f32_16x16x32_bf16 v[76:79], v[164:167], a[120:123], v[76:79]
    v_mul_f32 v98, v98, v106
    v_mul_f32 v99, v99, v107
    v_mfma_f32_16x16x32_bf16 v[88:91], v[164:167], a[184:187], v[88:91]
    v_mul_f32 v100, v100, v108
    v_mul_f32 v101, v101, v109
    v_mfma_f32_16x16x32_bf16 v[92:95], v[164:167], a[248:251], v[92:95]
    v_mul_f32 v102, v102, v110
    v_mul_f32 v103, v103, v111
    v_mfma_f32_16x16x32_bf16 v[64:67], v[144:147], a[60:63], v[64:67]
    v_cvt_pk_bf16_f32 v104, v96, v97
    v_cvt_pk_bf16_f32 v105, v98, v99
    v_mfma_f32_16x16x32_bf16 v[68:71], v[144:147], a[124:127], v[68:71]
    v_cvt_pk_bf16_f32 v106, v100, v101
    v_cvt_pk_bf16_f32 v107, v102, v103
    v_mfma_f32_16x16x32_bf16 v[80:83], v[144:147], a[188:191], v[80:83]
    v_mfma_f32_16x16x32_bf16 v[84:87], v[144:147], a[252:255], v[84:87]
    s_waitcnt vmcnt(14)
    s_barrier
    ds_read_b64_tr_b16 v[152:153], v189 offset:0
    ds_read_b64_tr_b16 v[154:155], v189 offset:512
    v_mfma_f32_16x16x32_bf16 v[72:75], v[148:151], a[60:63], v[72:75]
    ds_read_b64_tr_b16 v[156:157], v190 offset:0
    ds_read_b64_tr_b16 v[158:159], v190 offset:512
    v_mfma_f32_16x16x32_bf16 v[76:79], v[148:151], a[124:127], v[76:79]
    s_add_u32 m0, s97, 32768
    s_nop 0
    buffer_load_dwordx4 v251, s[48:51], s77 offen lds
    v_mfma_f32_16x16x32_bf16 v[88:91], v[148:151], a[188:191], v[88:91]
    ds_read_b64_tr_b16 v[160:161], v189 offset:4096
    ds_read_b64_tr_b16 v[162:163], v189 offset:4608
    v_mfma_f32_16x16x32_bf16 v[92:95], v[148:151], a[252:255], v[92:95]
    v_permlane16_swap_b32 v104, v106
    v_permlane16_swap_b32 v105, v107
    s_waitcnt lgkmcnt(4)
    v_mfma_f32_16x16x32_bf16 v[112:115], v[152:155], a[0:3], 0
    ds_read_b64_tr_b16 v[164:165], v190 offset:4096
    ds_read_b64_tr_b16 v[166:167], v190 offset:4608
    v_mfma_f32_16x16x32_bf16 v[116:119], v[152:155], a[64:67], 0
    buffer_load_dwordx4 v252, s[48:51], s77 offen offset:1024 lds
    buffer_store_dwordx4 v[104:107], v244, s[40:43], s70 offen sc1
    v_mfma_f32_16x16x32_bf16 v[120:123], v[152:155], a[128:131], 0
    ds_read_b64_tr_b16 v[144:145], v189 offset:8192
    ds_read_b64_tr_b16 v[146:147], v189 offset:8704
    v_mfma_f32_16x16x32_bf16 v[124:127], v[152:155], a[192:195], 0
    v_mul_f32 v32, v32, v40
    v_mul_f32 v33, v33, v41
    s_waitcnt lgkmcnt(6)
    v_mfma_f32_16x16x32_bf16 v[128:131], v[156:159], a[0:3], 0
    ds_read_b64_tr_b16 v[148:149], v190 offset:8192
    ds_read_b64_tr_b16 v[150:151], v190 offset:8704
    v_mfma_f32_16x16x32_bf16 v[132:135], v[156:159], a[64:67], 0
    buffer_load_dwordx4 v253, s[48:51], s77 offen offset:2048 lds
    v_mul_f32 v34, v34, v42
    v_mfma_f32_16x16x32_bf16 v[136:139], v[156:159], a[128:131], 0
    ds_read_b64_tr_b16 v[152:153], v189 offset:12288
    ds_read_b64_tr_b16 v[154:155], v189 offset:12800
    v_mfma_f32_16x16x32_bf16 v[140:143], v[156:159], a[192:195], 0
    v_mul_f32 v35, v35, v43
    v_mul_f32 v36, v36, v44
    s_waitcnt lgkmcnt(8)
    v_mfma_f32_16x16x32_bf16 v[112:115], v[160:163], a[4:7], v[112:115]
    ds_read_b64_tr_b16 v[156:157], v190 offset:12288
    ds_read_b64_tr_b16 v[158:159], v190 offset:12800
    v_mfma_f32_16x16x32_bf16 v[116:119], v[160:163], a[68:71], v[116:119]
    buffer_load_dwordx4 v254, s[48:51], s77 offen offset:3072 lds
    v_mul_f32 v37, v37, v45
    v_mfma_f32_16x16x32_bf16 v[120:123], v[160:163], a[132:135], v[120:123]
    v_mfma_f32_16x16x32_bf16 v[124:127], v[160:163], a[196:199], v[124:127]
    ds_read_b64_tr_b16 v[160:161], v189 offset:16384
    ds_read_b64_tr_b16 v[162:163], v189 offset:16896
    s_add_u32 m0, s97, 49152
    v_mul_f32 v38, v38, v46
    s_waitcnt lgkmcnt(8)
    v_mfma_f32_16x16x32_bf16 v[128:131], v[164:167], a[4:7], v[128:131]
    buffer_load_dwordx4 v251, s[48:51], s83 offen lds
    v_mul_f32 v39, v39, v47
    v_mfma_f32_16x16x32_bf16 v[132:135], v[164:167], a[68:71], v[132:135]
    v_cvt_pk_bf16_f32 v40, v32, v33
    v_cvt_pk_bf16_f32 v41, v34, v35
    v_mfma_f32_16x16x32_bf16 v[136:139], v[164:167], a[132:135], v[136:139]
    v_mfma_f32_16x16x32_bf16 v[140:143], v[164:167], a[196:199], v[140:143]
    ds_read_b64_tr_b16 v[164:165], v190 offset:16384
    ds_read_b64_tr_b16 v[166:167], v190 offset:16896
    v_cvt_pk_bf16_f32 v42, v36, v37
    v_cvt_pk_bf16_f32 v43, v38, v39
    v_mfma_f32_16x16x32_bf16 v[112:115], v[144:147], a[8:11], v[112:115]
    buffer_load_dwordx4 v252, s[48:51], s83 offen offset:1024 lds
    v_permlane16_swap_b32 v40, v42
    v_mfma_f32_16x16x32_bf16 v[116:119], v[144:147], a[72:75], v[116:119]
    v_permlane16_swap_b32 v41, v43
    buffer_store_dwordx4 v[40:43], v244, s[40:43], s68 offen offset:1024 sc1
    v_mfma_f32_16x16x32_bf16 v[120:123], v[144:147], a[136:139], v[120:123]
    v_mfma_f32_16x16x32_bf16 v[124:127], v[144:147], a[200:203], v[124:127]
    ds_read_b64_tr_b16 v[144:145], v189 offset:20480
    ds_read_b64_tr_b16 v[146:147], v189 offset:20992
    v_mul_f32 v48, v48, v56
    v_mul_f32 v49, v49, v57
    s_waitcnt lgkmcnt(4)
    v_mfma_f32_16x16x32_bf16 v[128:131], v[148:151], a[8:11], v[128:131]
    buffer_load_dwordx4 v253, s[48:51], s83 offen offset:2048 lds
    v_mul_f32 v50, v50, v58
    v_mfma_f32_16x16x32_bf16 v[132:135], v[148:151], a[72:75], v[132:135]
    v_mul_f32 v51, v51, v59
    v_mul_f32 v52, v52, v60
    v_mfma_f32_16x16x32_bf16 v[136:139], v[148:151], a[136:139], v[136:139]
    v_mfma_f32_16x16x32_bf16 v[140:143], v[148:151], a[200:203], v[140:143]
    ds_read_b64_tr_b16 v[148:149], v190 offset:20480
    ds_read_b64_tr_b16 v[150:151], v190 offset:20992
    v_mul_f32 v53, v53, v61
    v_mul_f32 v54, v54, v62
    v_mfma_f32_16x16x32_bf16 v[112:115], v[152:155], a[12:15], v[112:115]
    buffer_load_dwordx4 v254, s[48:51], s83 offen offset:3072 lds
    v_mul_f32 v55, v55, v63
    v_mfma_f32_16x16x32_bf16 v[116:119], v[152:155], a[76:79], v[116:119]
    v_cvt_pk_bf16_f32 v56, v48, v49
    v_cvt_pk_bf16_f32 v57, v50, v51
    v_mfma_f32_16x16x32_bf16 v[120:123], v[152:155], a[140:143], v[120:123]
    v_mfma_f32_16x16x32_bf16 v[124:127], v[152:155], a[204:207], v[124:127]
    ds_read_b64_tr_b16 v[152:153], v189 offset:24576
    ds_read_b64_tr_b16 v[154:155], v189 offset:25088
    s_add_u32 m0, s97, 65536
    v_cvt_pk_bf16_f32 v58, v52, v53
    v_mfma_f32_16x16x32_bf16 v[128:131], v[156:159], a[12:15], v[128:131]
    buffer_load_dwordx4 v251, s[52:55], s87 offen lds
    v_cvt_pk_bf16_f32 v59, v54, v55
    v_mfma_f32_16x16x32_bf16 v[132:135], v[156:159], a[76:79], v[132:135]
    v_permlane16_swap_b32 v56, v58
    v_permlane16_swap_b32 v57, v59
    v_mfma_f32_16x16x32_bf16 v[136:139], v[156:159], a[140:143], v[136:139]
    v_mfma_f32_16x16x32_bf16 v[140:143], v[156:159], a[204:207], v[140:143]
    ds_read_b64_tr_b16 v[156:157], v190 offset:24576
    ds_read_b64_tr_b16 v[158:159], v190 offset:25088
    buffer_store_dwordx4 v[56:59], v244, s[40:43], s69 offen offset:1024 sc1
    v_mul_f32 v64, v64, v72
    v_mul_f32 v65, v65, v73
    v_mfma_f32_16x16x32_bf16 v[112:115], v[160:163], a[16:19], v[112:115]
    buffer_load_dwordx4 v252, s[52:55], s87 offen offset:1024 lds
    v_mul_f32 v66, v66, v74
    v_mfma_f32_16x16x32_bf16 v[116:119], v[160:163], a[80:83], v[116:119]
    v_mul_f32 v67, v67, v75
    v_mul_f32 v68, v68, v76
    v_mul_f32 v69, v69, v77
    v_mfma_f32_16x16x32_bf16 v[120:123], v[160:163], a[144:147], v[120:123]
    v_mfma_f32_16x16x32_bf16 v[124:127], v[160:163], a[208:211], v[124:127]
    ds_read_b64_tr_b16 v[160:161], v189 offset:28672
    ds_read_b64_tr_b16 v[162:163], v189 offset:29184
    v_mul_f32 v70, v70, v78
    v_mul_f32 v71, v71, v79
    v_cvt_pk_bf16_f32 v72, v64, v65
    s_waitcnt lgkmcnt(4)
    v_mfma_f32_16x16x32_bf16 v[128:131], v[164:167], a[16:19], v[128:131]
    buffer_load_dwordx4 v253, s[52:55], s87 offen offset:2048 lds
    v_cvt_pk_bf16_f32 v73, v66, v67
    v_mfma_f32_16x16x32_bf16 v[132:135], v[164:167], a[80:83], v[132:135]
    v_cvt_pk_bf16_f32 v74, v68, v69
    v_cvt_pk_bf16_f32 v75, v70, v71
    s_nop 0
    v_permlane16_swap_b32 v72, v74
    v_mfma_f32_16x16x32_bf16 v[136:139], v[164:167], a[144:147], v[136:139]
    v_mfma_f32_16x16x32_bf16 v[140:143], v[164:167], a[208:211], v[140:143]
    ds_read_b64_tr_b16 v[164:165], v190 offset:28672
    ds_read_b64_tr_b16 v[166:167], v190 offset:29184
    v_permlane16_swap_b32 v73, v75
    buffer_store_dwordx4 v[72:75], v244, s[40:43], s68 offen offset:2048 sc1
    v_mul_f32 v80, v80, v88
    v_mfma_f32_16x16x32_bf16 v[112:115], v[144:147], a[20:23], v[112:115]
    buffer_load_dwordx4 v254, s[52:55], s87 offen offset:3072 lds
    v_mul_f32 v81, v81, v89
    v_mfma_f32_16x16x32_bf16 v[116:119], v[144:147], a[84:87], v[116:119]
    v_mul_f32 v82, v82, v90
    v_mul_f32 v83, v83, v91
    v_mul_f32 v84, v84, v92
    v_mfma_f32_16x16x32_bf16 v[120:123], v[144:147], a[148:151], v[120:123]
    s_add_u32 m0, s97, 81920
    v_mul_f32 v85, v85, v93
    v_mfma_f32_16x16x32_bf16 v[124:127], v[144:147], a[212:215], v[124:127]
    v_mul_f32 v86, v86, v94
    v_mul_f32 v87, v87, v95
    v_cvt_pk_bf16_f32 v88, v80, v81
    v_mfma_f32_16x16x32_bf16 v[128:131], v[148:151], a[20:23], v[128:131]
    buffer_load_dwordx4 v251, s[48:51], s78 offen lds
    v_cvt_pk_bf16_f32 v89, v82, v83
    v_mfma_f32_16x16x32_bf16 v[132:135], v[148:151], a[84:87], v[132:135]
    v_cvt_pk_bf16_f32 v90, v84, v85
    v_cvt_pk_bf16_f32 v91, v86, v87
    s_nop 0
    v_permlane16_swap_b32 v88, v90
    v_mfma_f32_16x16x32_bf16 v[136:139], v[148:151], a[148:151], v[136:139]
    v_permlane16_swap_b32 v89, v91
    buffer_store_dwordx4 v[88:91], v244, s[40:43], s69 offen offset:2048 sc1
    v_mfma_f32_16x16x32_bf16 v[140:143], v[148:151], a[212:215], v[140:143]
    s_lshr_b32 s4, s76, 4
    s_lshr_b32 s5, s77, 4
    s_lshr_b32 s6, s78, 4
    v_mfma_f32_16x16x32_bf16 v[112:115], v[152:155], a[24:27], v[112:115]
    buffer_load_dwordx4 v252, s[48:51], s78 offen offset:1024 lds
    s_lshr_b32 s7, s79, 4
    v_mfma_f32_16x16x32_bf16 v[116:119], v[152:155], a[88:91], v[116:119]
    s_lshr_b32 s8, s80, 4
    s_lshr_b32 s9, s81, 4
    s_lshr_b32 s10, s82, 4
    v_mfma_f32_16x16x32_bf16 v[120:123], v[152:155], a[152:155], v[120:123]
    s_lshr_b32 s11, s83, 4
    s_lshr_b32 s12, s84, 4
    v_mfma_f32_16x16x32_bf16 v[124:127], v[152:155], a[216:219], v[124:127]
    s_lshr_b32 s13, s85, 4
    s_lshr_b32 s14, s86, 4
    s_lshl_b32 s19, s98, 16
    s_waitcnt lgkmcnt(0)
    v_mfma_f32_16x16x32_bf16 v[128:131], v[156:159], a[24:27], v[128:131]
    buffer_load_dwordx4 v253, s[48:51], s78 offen offset:2048 lds
    s_add_u32 s19, s19, 5636096
    v_mfma_f32_16x16x32_bf16 v[132:135], v[156:159], a[88:91], v[132:135]
    s_lshr_b32 s15, s87, 4
    s_add_u32 s15, s15, s19
    s_lshr_b32 s16, s88, 4
    v_mfma_f32_16x16x32_bf16 v[136:139], v[156:159], a[152:155], v[136:139]
    s_add_u32 s16, s16, s19
    s_lshr_b32 s17, s89, 4
    v_mfma_f32_16x16x32_bf16 v[140:143], v[156:159], a[216:219], v[140:143]
    s_add_u32 s17, s17, s19
    s_lshr_b32 s18, s90, 4
    s_add_u32 s18, s18, s19
    v_mfma_f32_16x16x32_bf16 v[112:115], v[160:163], a[28:31], v[112:115]
    buffer_load_dwordx4 v254, s[48:51], s78 offen offset:3072 lds
    s_lshl_b32 s19, s98, 12
    v_mfma_f32_16x16x32_bf16 v[116:119], v[160:163], a[92:95], v[116:119]
    s_add_u32 s19, s19, 7815168
    s_lshl_b32 s20, s98, 11
    s_add_u32 s20, s20, 8011776
    v_mfma_f32_16x16x32_bf16 v[120:123], v[160:163], a[156:159], v[120:123]
    v_mfma_f32_16x16x32_bf16 v[124:127], v[160:163], a[220:223], v[124:127]
    s_waitcnt vmcnt(23)
    s_barrier
    ds_read_b64_tr_b16 v[144:145], v191 offset:0
    ds_read_b64_tr_b16 v[146:147], v191 offset:512
    s_lshl_b32 s21, s98, 8
    v_mfma_f32_16x16x32_bf16 v[128:131], v[164:167], a[28:31], v[128:131]
    ds_read_b64_tr_b16 v[148:149], v192 offset:0
    ds_read_b64_tr_b16 v[150:151], v192 offset:512
    v_mfma_f32_16x16x32_bf16 v[132:135], v[164:167], a[92:95], v[132:135]
    s_add_u32 m0, s97, 98304
    s_nop 0
    buffer_load_dwordx4 v251, s[48:51], s79 offen lds
    s_add_u32 s21, s21, 7733248
    v_mfma_f32_16x16x32_bf16 v[136:139], v[164:167], a[156:159], v[136:139]
    ds_read_b64_tr_b16 v[152:153], v191 offset:4096
    ds_read_b64_tr_b16 v[154:155], v191 offset:4608
    v_mfma_f32_16x16x32_bf16 v[140:143], v[164:167], a[220:223], v[140:143]
    s_lshl_b32 s23, s95, 2
    s_add_u32 s23, s23, s91
    s_lshl_b32 s22, s23, 11
    s_waitcnt lgkmcnt(4)
    v_mfma_f32_16x16x32_bf16 v[112:115], v[144:147], a[32:35], v[112:115]
    ds_read_b64_tr_b16 v[156:157], v192 offset:4096
    ds_read_b64_tr_b16 v[158:159], v192 offset:4608
    v_mfma_f32_16x16x32_bf16 v[116:119], v[144:147], a[96:99], v[116:119]
    buffer_load_dwordx4 v252, s[48:51], s79 offen offset:1024 lds
    s_add_u32 s22, s22, 7946240
    s_mul_i32 s23, s23, 2176
    v_mfma_f32_16x16x32_bf16 v[120:123], v[144:147], a[160:163], v[120:123]
    ds_read_b64_tr_b16 v[160:161], v191 offset:8192
    ds_read_b64_tr_b16 v[162:163], v191 offset:8704
    v_mfma_f32_16x16x32_bf16 v[124:127], v[144:147], a[224:227], v[124:127]
    s_add_u32 s23, s23, 7741440
    s_lshl_b32 s24, s94, 2
    s_lshl_b32 s25, s92, 1
    s_waitcnt lgkmcnt(6)
    v_mfma_f32_16x16x32_bf16 v[128:131], v[148:151], a[32:35], v[128:131]
    ds_read_b64_tr_b16 v[164:165], v192 offset:8192
    ds_read_b64_tr_b16 v[166:167], v192 offset:8704
    v_mfma_f32_16x16x32_bf16 v[132:135], v[148:151], a[96:99], v[132:135]
    buffer_load_dwordx4 v253, s[48:51], s79 offen offset:2048 lds
    s_add_u32 s24, s24, s25
    s_add_u32 s24, s24, s93
    v_mfma_f32_16x16x32_bf16 v[136:139], v[148:151], a[160:163], v[136:139]
    ds_read_b64_tr_b16 v[144:145], v191 offset:12288
    ds_read_b64_tr_b16 v[146:147], v191 offset:12800
    v_mfma_f32_16x16x32_bf16 v[140:143], v[148:151], a[224:227], v[140:143]
    s_lshl_b32 s24, s24, 15
    s_lshl_b32 s25, s95, 12
    s_add_u32 s24, s24, s25
    s_waitcnt lgkmcnt(8)
    v_mfma_f32_16x16x32_bf16 v[112:115], v[152:155], a[36:39], v[112:115]
    ds_read_b64_tr_b16 v[148:149], v192 offset:12288
    ds_read_b64_tr_b16 v[150:151], v192 offset:12800
    v_mfma_f32_16x16x32_bf16 v[116:119], v[152:155], a[100:103], v[116:119]
    buffer_load_dwordx4 v254, s[48:51], s79 offen offset:3072 lds
    s_lshl_b32 s25, s93, 11
    s_add_u32 s24, s24, s25
    v_mfma_f32_16x16x32_bf16 v[120:123], v[152:155], a[164:167], v[120:123]
    v_mfma_f32_16x16x32_bf16 v[124:127], v[152:155], a[228:231], v[124:127]
    ds_read_b64_tr_b16 v[152:153], v191 offset:16384
    ds_read_b64_tr_b16 v[154:155], v191 offset:16896
    s_add_u32 m0, s97, 114688
    s_xor_b32 s25, s24, 0x8000
    s_add_u32 s24, s24, 5636096
    s_waitcnt lgkmcnt(6)
    v_mfma_f32_16x16x32_bf16 v[128:131], v[156:159], a[36:39], v[128:131]
    buffer_load_dwordx4 v251, s[48:51], s80 offen lds
    s_add_u32 s25, s25, 5636096
    v_mfma_f32_16x16x32_bf16 v[132:135], v[156:159], a[100:103], v[132:135]
    s_lshl_b32 s26, s94, 1
    s_add_u32 s26, s26, s92
    s_lshl_b32 s26, s26, 3
    v_mfma_f32_16x16x32_bf16 v[136:139], v[156:159], a[164:167], v[136:139]
    v_mfma_f32_16x16x32_bf16 v[140:143], v[156:159], a[228:231], v[140:143]
    ds_read_b64_tr_b16 v[156:157], v192 offset:16384
    ds_read_b64_tr_b16 v[158:159], v192 offset:16896
    s_add_u32 s26, s26, s95
    s_lshl_b32 s26, s26, 1
    s_add_u32 s26, s26, s93
    v_mfma_f32_16x16x32_bf16 v[112:115], v[160:163], a[40:43], v[112:115]
    buffer_load_dwordx4 v252, s[48:51], s80 offen offset:1024 lds
    s_lshl_b32 s26, s26, 7
    v_mfma_f32_16x16x32_bf16 v[116:119], v[160:163], a[104:107], v[116:119]
    s_add_u32 s26, s26, 8011776
    v_mfma_f32_16x16x32_bf16 v[120:123], v[160:163], a[168:171], v[120:123]
    v_mfma_f32_16x16x32_bf16 v[124:127], v[160:163], a[232:235], v[124:127]
    ds_read_b64_tr_b16 v[160:161], v191 offset:20480
    ds_read_b64_tr_b16 v[162:163], v191 offset:20992
    v_mfma_f32_16x16x32_bf16 v[128:131], v[164:167], a[40:43], v[128:131]
    buffer_load_dwordx4 v253, s[48:51], s80 offen offset:2048 lds
    s_waitcnt vmcnt(10)
    v_mfma_f32_16x16x32_bf16 v[132:135], v[164:167], a[104:107], v[132:135]
    buffer_store_dword v243, v237, s[40:43], s75 offen sc1
    v_mfma_f32_16x16x32_bf16 v[136:139], v[164:167], a[168:171], v[136:139]
    v_mfma_f32_16x16x32_bf16 v[140:143], v[164:167], a[232:235], v[140:143]
    ds_read_b64_tr_b16 v[164:165], v192 offset:20480
    ds_read_b64_tr_b16 v[166:167], v192 offset:20992
    s_waitcnt lgkmcnt(4)
    v_mfma_f32_16x16x32_bf16 v[112:115], v[144:147], a[44:47], v[112:115]
    buffer_load_dwordx4 v254, s[48:51], s80 offen offset:3072 lds
    v_mfma_f32_16x16x32_bf16 v[116:119], v[144:147], a[108:111], v[116:119]
    v_mfma_f32_16x16x32_bf16 v[120:123], v[144:147], a[172:175], v[120:123]
    v_mfma_f32_16x16x32_bf16 v[124:127], v[144:147], a[236:239], v[124:127]
    ds_read_b64_tr_b16 v[144:145], v191 offset:24576
    ds_read_b64_tr_b16 v[146:147], v191 offset:25088
    v_mfma_f32_16x16x32_bf16 v[128:131], v[148:151], a[44:47], v[128:131]
    v_mfma_f32_16x16x32_bf16 v[132:135], v[148:151], a[108:111], v[132:135]
    v_mfma_f32_16x16x32_bf16 v[136:139], v[148:151], a[172:175], v[136:139]
    v_mfma_f32_16x16x32_bf16 v[140:143], v[148:151], a[236:239], v[140:143]
    ds_read_b64_tr_b16 v[148:149], v192 offset:24576
    ds_read_b64_tr_b16 v[150:151], v192 offset:25088
    v_mfma_f32_16x16x32_bf16 v[112:115], v[152:155], a[48:51], v[112:115]
    v_mfma_f32_16x16x32_bf16 v[116:119], v[152:155], a[112:115], v[116:119]
    v_mfma_f32_16x16x32_bf16 v[120:123], v[152:155], a[176:179], v[120:123]
    v_mfma_f32_16x16x32_bf16 v[124:127], v[152:155], a[240:243], v[124:127]
    ds_read_b64_tr_b16 v[152:153], v191 offset:28672
    ds_read_b64_tr_b16 v[154:155], v191 offset:29184
    v_mfma_f32_16x16x32_bf16 v[128:131], v[156:159], a[48:51], v[128:131]
    v_add_u32 v245, 0x20000, v245
    v_add_u32 v246, 0x20000, v246
    v_mfma_f32_16x16x32_bf16 v[132:135], v[156:159], a[112:115], v[132:135]
    v_add_u32 v247, 0x20000, v247
    v_add_u32 v248, 0x20000, v248
    v_mfma_f32_16x16x32_bf16 v[136:139], v[156:159], a[176:179], v[136:139]
    v_mfma_f32_16x16x32_bf16 v[140:143], v[156:159], a[240:243], v[140:143]
    ds_read_b64_tr_b16 v[156:157], v192 offset:28672
    ds_read_b64_tr_b16 v[158:159], v192 offset:29184
    ds_read_b64_tr_b16 a[0:1], v245 offset:0
    ds_read_b64_tr_b16 a[2:3], v245 offset:512
    ds_read_b64_tr_b16 a[64:65], v246 offset:0
    s_waitcnt lgkmcnt(7)
    v_mfma_f32_16x16x32_bf16 v[112:115], v[160:163], a[52:55], v[112:115]
    ds_read_b64_tr_b16 a[66:67], v246 offset:512
    ds_read_b64_tr_b16 a[128:129], v247 offset:0
    v_mfma_f32_16x16x32_bf16 v[116:119], v[160:163], a[116:119], v[116:119]
    ds_read_b64_tr_b16 a[130:131], v247 offset:512
L_pad_q_2:
    s_cbranch_execz L_walked_q
    ds_read_b64_tr_b16 a[192:193], v248 offset:0
    ds_read_b64_tr_b16 a[194:195], v248 offset:512
    v_mfma_f32_16x16x32_bf16 v[120:123], v[160:163], a[180:183], v[120:123]
    s_waitcnt lgkmcnt(0)
    s_add_u32 m0, s97, 131072
    v_mfma_f32_16x16x32_bf16 v[124:127], v[160:163], a[244:247], v[124:127]
    buffer_load_dwordx4 v251, s[48:51], s81 offen lds
    buffer_load_dwordx4 v252, s[48:51], s81 offen offset:1024 lds
    buffer_load_dwordx4 v253, s[48:51], s81 offen offset:2048 lds
    v_mfma_f32_16x16x32_bf16 v[128:131], v[164:167], a[52:55], v[128:131]
    buffer_load_dwordx4 v254, s[48:51], s81 offen offset:3072 lds
    v_add_u32 v245, 0xfffe0000, v245
    v_mfma_f32_16x16x32_bf16 v[132:135], v[164:167], a[116:119], v[132:135]
    v_add_u32 v246, 0xfffe0000, v246
    v_add_u32 v247, 0xfffe0000, v247
    v_add_u32 v248, 0xfffe0000, v248
    v_mfma_f32_16x16x32_bf16 v[136:139], v[164:167], a[180:183], v[136:139]
    ds_read_b64_tr_b16 a[4:5], v245 offset:32768
    v_mfma_f32_16x16x32_bf16 v[140:143], v[164:167], a[244:247], v[140:143]
    ds_read_b64_tr_b16 a[6:7], v245 offset:33280
    ds_read_b64_tr_b16 a[68:69], v246 offset:32768
    ds_read_b64_tr_b16 a[70:71], v246 offset:33280
    v_mfma_f32_16x16x32_bf16 v[112:115], v[144:147], a[56:59], v[112:115]
    ds_read_b64_tr_b16 a[132:133], v247 offset:32768
    ds_read_b64_tr_b16 a[134:135], v247 offset:33280
    v_mfma_f32_16x16x32_bf16 v[116:119], v[144:147], a[120:123], v[116:119]
    ds_read_b64_tr_b16 a[196:197], v248 offset:32768
    ds_read_b64_tr_b16 a[198:199], v248 offset:33280
    v_mfma_f32_16x16x32_bf16 v[120:123], v[144:147], a[184:187], v[120:123]
    v_mfma_f32_16x16x32_bf16 v[124:127], v[144:147], a[248:251], v[124:127]
    v_mfma_f32_16x16x32_bf16 v[128:131], v[148:151], a[56:59], v[128:131]
    v_mfma_f32_16x16x32_bf16 v[132:135], v[148:151], a[120:123], v[132:135]
    v_mfma_f32_16x16x32_bf16 v[136:139], v[148:151], a[184:187], v[136:139]
    v_mfma_f32_16x16x32_bf16 v[140:143], v[148:151], a[248:251], v[140:143]
    v_mfma_f32_16x16x32_bf16 v[112:115], v[152:155], a[60:63], v[112:115]
    v_mfma_f32_16x16x32_bf16 v[116:119], v[152:155], a[124:127], v[116:119]
    v_mfma_f32_16x16x32_bf16 v[120:123], v[152:155], a[188:191], v[120:123]
    v_mfma_f32_16x16x32_bf16 v[124:127], v[152:155], a[252:255], v[124:127]
    s_waitcnt lgkmcnt(0)
    s_barrier
    v_mfma_f32_16x16x32_bf16 v[128:131], v[156:159], a[60:63], v[128:131]
    v_mfma_f32_16x16x32_bf16 v[132:135], v[156:159], a[124:127], v[132:135]
    v_mfma_f32_16x16x32_bf16 v[136:139], v[156:159], a[188:191], v[136:139]
    v_mfma_f32_16x16x32_bf16 v[140:143], v[156:159], a[252:255], v[140:143]
    v_cvt_pk_bf16_f32 v32, v112, v113
    s_add_u32 m0, s97, 0
    s_nop 0
    buffer_load_dwordx4 v251, s[48:51], s82 offen lds
    v_cvt_pk_bf16_f32 v33, v114, v115
    v_cvt_pk_bf16_f32 v34, v116, v117
    v_cvt_pk_bf16_f32 v35, v118, v119
    v_cvt_pk_bf16_f32 v36, v120, v121
    v_cvt_pk_bf16_f32 v37, v122, v123
    v_cvt_pk_bf16_f32 v38, v124, v125
    v_cvt_pk_bf16_f32 v39, v126, v127
    v_permlane16_swap_b32 v32, v34
    v_permlane16_swap_b32 v33, v35
    v_permlane16_swap_b32 v36, v38
    v_permlane16_swap_b32 v37, v39
    v_mfma_f32_32x32x16_bf16 v[0:15], v[168:171], v[32:35], 0
    s_nop 0
    v_mfma_f32_32x32x16_bf16 v[16:31], v[168:171], v[36:39], 0
    buffer_load_dwordx4 v252, s[48:51], s82 offen offset:1024 lds
    s_nop 8
    v_max3_f32 v40, v0, v1, v2
    v_max3_f32 v42, v3, v4, v5
    v_max3_f32 v40, v40, v6, v7
    v_max3_f32 v42, v42, v8, v9
    v_max3_f32 v40, v40, v10, v11
    v_max3_f32 v42, v42, v12, v13
    v_max3_f32 v40, v40, v14, v15
    v_max_f32 v40, v40, v42
    v_mul_f32 v40, s72, v40
    v_pk_fma_f32 v[0:1], v[0:1], s[72:73], v[40:41] op_sel_hi:[1,0,0] neg_lo:[0,0,1] neg_hi:[0,0,1]
    v_pk_fma_f32 v[2:3], v[2:3], s[72:73], v[40:41] op_sel_hi:[1,0,0] neg_lo:[0,0,1] neg_hi:[0,0,1]
    v_pk_fma_f32 v[4:5], v[4:5], s[72:73], v[40:41] op_sel_hi:[1,0,0] neg_lo:[0,0,1] neg_hi:[0,0,1]
    v_cvt_pk_bf16_f32 v32, v128, v129
    v_cvt_pk_bf16_f32 v33, v130, v131
    v_cvt_pk_bf16_f32 v34, v132, v133
    buffer_load_dwordx4 v253, s[48:51], s82 offen offset:2048 lds
    v_cvt_pk_bf16_f32 v35, v134, v135
    v_pk_fma_f32 v[6:7], v[6:7], s[72:73], v[40:41] op_sel_hi:[1,0,0] neg_lo:[0,0,1] neg_hi:[0,0,1]
    v_pk_fma_f32 v[8:9], v[8:9], s[72:73], v[40:41] op_sel_hi:[1,0,0] neg_lo:[0,0,1] neg_hi:[0,0,1]
    v_pk_fma_f32 v[10:11], v[10:11], s[72:73], v[40:41] op_sel_hi:[1,0,0] neg_lo:[0,0,1] neg_hi:[0,0,1]
    v_pk_fma_f32 v[12:13], v[12:13], s[72:73], v[40:41] op_sel_hi:[1,0,0] neg_lo:[0,0,1] neg_hi:[0,0,1]
    v_pk_fma_f32 v[14:15], v[14:15], s[72:73], v[40:41] op_sel_hi:[1,0,0] neg_lo:[0,0,1] neg_hi:[0,0,1]
    v_exp_f32 v0, v0
    v_exp_f32 v1, v1
    v_exp_f32 v2, v2
    v_permlane16_swap_b32 v32, v34
    v_permlane16_swap_b32 v33, v35
    v_exp_f32 v3, v3
    buffer_load_dwordx4 v254, s[48:51], s82 offen offset:3072 lds
    s_add_u32 m0, s97, 16384
    v_exp_f32 v4, v4
    v_exp_f32 v5, v5
    v_pk_add_f32 v[42:43], v[0:1], v[2:3]
    v_exp_f32 v6, v6
    v_exp_f32 v7, v7
    v_pk_add_f32 v[42:43], v[42:43], v[4:5]
    v_exp_f32 v8, v8
    v_exp_f32 v9, v9
    buffer_load_dwordx4 v251, s[48:51], s84 offen lds
    v_pk_add_f32 v[42:43], v[42:43], v[6:7]
    v_exp_f32 v10, v10
    v_exp_f32 v11, v11
    v_pk_add_f32 v[42:43], v[42:43], v[8:9]
    v_exp_f32 v12, v12
    v_exp_f32 v13, v13
    v_pk_add_f32 v[42:43], v[42:43], v[10:11]
    v_exp_f32 v14, v14
    v_exp_f32 v15, v15
    buffer_load_dwordx4 v252, s[48:51], s84 offen offset:1024 lds
    v_pk_add_f32 v[42:43], v[42:43], v[12:13]
    v_pk_add_f32 v[42:43], v[42:43], v[14:15]
    v_add_f32 v42, v42, v43
    v_rcp_f32 v42, v42
    s_nop 0
    v_pk_mul_f32 v[0:1], v[0:1], v[42:43] op_sel_hi:[1,0]
    v_cvt_pk_bf16_f32 v112, v0, v1
    v_pk_mul_f32 v[2:3], v[2:3], v[42:43] op_sel_hi:[1,0]
    v_cvt_pk_bf16_f32 v113, v2, v3
    v_pk_mul_f32 v[4:5], v[4:5], v[42:43] op_sel_hi:[1,0]
    v_cvt_pk_bf16_f32 v114, v4, v5
    v_pk_mul_f32 v[6:7], v[6:7], v[42:43] op_sel_hi:[1,0]
    v_cvt_pk_bf16_f32 v115, v6, v7
    v_pk_mul_f32 v[8:9], v[8:9], v[42:43] op_sel_hi:[1,0]
    v_cvt_pk_bf16_f32 v116, v8, v9
    buffer_load_dwordx4 v253, s[48:51], s84 offen offset:2048 lds
    v_pk_mul_f32 v[10:11], v[10:11], v[42:43] op_sel_hi:[1,0]
    v_cvt_pk_bf16_f32 v117, v10, v11
    v_pk_mul_f32 v[12:13], v[12:13], v[42:43] op_sel_hi:[1,0]
    v_cvt_pk_bf16_f32 v118, v12, v13
    v_pk_mul_f32 v[14:15], v[14:15], v[42:43] op_sel_hi:[1,0]
    v_cvt_pk_bf16_f32 v119, v14, v15
    v_mfma_f32_32x32x16_bf16 v[0:15], v[172:175], v[32:35], 0
    buffer_load_dword v241, v235, s[40:43], s22 offen sc1
    v_max3_f32 v40, v16, v17, v18
    buffer_load_dwordx4 v254, s[48:51], s84 offen offset:3072 lds
    v_max3_f32 v42, v19, v20, v21
    ds_read_b64_tr_b16 a[28:29], v245 offset:49152
    v_max3_f32 v40, v40, v22, v23
    ds_read_b64_tr_b16 a[30:31], v245 offset:49664
    ds_read_b64_tr_b16 a[92:93], v246 offset:49152
    v_max3_f32 v42, v42, v24, v25
    ds_read_b64_tr_b16 a[94:95], v246 offset:49664
    ds_read_b64_tr_b16 a[156:157], v247 offset:49152
    v_max3_f32 v40, v40, v26, v27
    ds_read_b64_tr_b16 a[158:159], v247 offset:49664
    ds_read_b64_tr_b16 a[220:221], v248 offset:49152
    v_max3_f32 v42, v42, v28, v29
    ds_read_b64_tr_b16 a[222:223], v248 offset:49664
    s_add_u32 m0, s97, 32768
    v_max3_f32 v40, v40, v30, v31
    buffer_load_dwordx4 v251, s[48:51], s85 offen lds
    v_max_f32 v40, v40, v42
    v_mul_f32 v40, s72, v40
    v_pk_fma_f32 v[16:17], v[16:17], s[72:73], v[40:41] op_sel_hi:[1,0,0] neg_lo:[0,0,1] neg_hi:[0,0,1]
    v_pk_fma_f32 v[18:19], v[18:19], s[72:73], v[40:41] op_sel_hi:[1,0,0] neg_lo:[0,0,1] neg_hi:[0,0,1]
    v_pk_fma_f32 v[20:21], v[20:21], s[72:73], v[40:41] op_sel_hi:[1,0,0] neg_lo:[0,0,1] neg_hi:[0,0,1]
    v_cvt_pk_bf16_f32 v36, v136, v137
    v_cvt_pk_bf16_f32 v37, v138, v139
    v_cvt_pk_bf16_f32 v38, v140, v141
    v_cvt_pk_bf16_f32 v39, v142, v143
    v_pk_fma_f32 v[22:23], v[22:23], s[72:73], v[40:41] op_sel_hi:[1,0,0] neg_lo:[0,0,1] neg_hi:[0,0,1]
    v_pk_fma_f32 v[24:25], v[24:25], s[72:73], v[40:41] op_sel_hi:[1,0,0] neg_lo:[0,0,1] neg_hi:[0,0,1]
    v_pk_fma_f32 v[26:27], v[26:27], s[72:73], v[40:41] op_sel_hi:[1,0,0] neg_lo:[0,0,1] neg_hi:[0,0,1]
    v_pk_fma_f32 v[28:29], v[28:29], s[72:73], v[40:41] op_sel_hi:[1,0,0] neg_lo:[0,0,1] neg_hi:[0,0,1]
    v_pk_fma_f32 v[30:31], v[30:31], s[72:73], v[40:41] op_sel_hi:[1,0,0] neg_lo:[0,0,1] neg_hi:[0,0,1]
    v_exp_f32 v16, v16
    buffer_load_dwordx4 v252, s[48:51], s85 offen offset:1024 lds
    v_exp_f32 v17, v17
    v_exp_f32 v18, v18
    v_permlane16_swap_b32 v36, v38
    v_permlane16_swap_b32 v37, v39
    v_exp_f32 v19, v19
    v_exp_f32 v20, v20
    v_exp_f32 v21, v21
    v_pk_add_f32 v[42:43], v[16:17], v[18:19]
    v_exp_f32 v22, v22
    buffer_load_dwordx4 v253, s[48:51], s85 offen offset:2048 lds
    v_exp_f32 v23, v23
    v_pk_add_f32 v[42:43], v[42:43], v[20:21]
    v_exp_f32 v24, v24
    v_exp_f32 v25, v25
    v_pk_add_f32 v[42:43], v[42:43], v[22:23]
    v_exp_f32 v26, v26
    v_exp_f32 v27, v27
    v_pk_add_f32 v[42:43], v[42:43], v[24:25]
    v_exp_f32 v28, v28
    buffer_load_dwordx4 v254, s[48:51], s85 offen offset:3072 lds
    s_waitcnt lgkmcnt(0)
    v_exp_f32 v29, v29
    v_add_u32 v245, 0x10000, v245
    v_add_u32 v246, 0x10000, v246
    v_pk_add_f32 v[42:43], v[42:43], v[26:27]
    v_add_u32 v247, 0x10000, v247
    v_add_u32 v248, 0x10000, v248
    v_exp_f32 v30, v30
    ds_read_b64_tr_b16 a[44:45], v245 offset:0
    v_exp_f32 v31, v31
    ds_read_b64_tr_b16 a[46:47], v245 offset:512
    ds_read_b64_tr_b16 a[108:109], v246 offset:0
    v_pk_add_f32 v[42:43], v[42:43], v[28:29]
    ds_read_b64_tr_b16 a[110:111], v246 offset:512
    ds_read_b64_tr_b16 a[172:173], v247 offset:0
    v_pk_add_f32 v[42:43], v[42:43], v[30:31]
    ds_read_b64_tr_b16 a[174:175], v247 offset:512
    ds_read_b64_tr_b16 a[236:237], v248 offset:0
    v_add_f32 v42, v42, v43
    ds_read_b64_tr_b16 a[238:239], v248 offset:512
    s_add_u32 m0, s97, 49152
    v_rcp_f32 v42, v42
    buffer_load_dwordx4 v251, s[48:51], s86 offen lds
    v_pk_mul_f32 v[16:17], v[16:17], v[42:43] op_sel_hi:[1,0]
    v_cvt_pk_bf16_f32 v120, v16, v17
    v_pk_mul_f32 v[18:19], v[18:19], v[42:43] op_sel_hi:[1,0]
    v_cvt_pk_bf16_f32 v121, v18, v19
    v_pk_mul_f32 v[20:21], v[20:21], v[42:43] op_sel_hi:[1,0]
    v_cvt_pk_bf16_f32 v122, v20, v21
    v_pk_mul_f32 v[22:23], v[22:23], v[42:43] op_sel_hi:[1,0]
    v_cvt_pk_bf16_f32 v123, v22, v23
    v_pk_mul_f32 v[24:25], v[24:25], v[42:43] op_sel_hi:[1,0]
    v_cvt_pk_bf16_f32 v124, v24, v25
    v_pk_mul_f32 v[26:27], v[26:27], v[42:43] op_sel_hi:[1,0]
    v_cvt_pk_bf16_f32 v125, v26, v27
    v_pk_mul_f32 v[28:29], v[28:29], v[42:43] op_sel_hi:[1,0]
    v_cvt_pk_bf16_f32 v126, v28, v29
    v_pk_mul_f32 v[30:31], v[30:31], v[42:43] op_sel_hi:[1,0]
    buffer_load_dwordx4 v252, s[48:51], s86 offen offset:1024 lds
    v_cvt_pk_bf16_f32 v127, v30, v31
    v_mfma_f32_32x32x16_bf16 v[16:31], v[172:175], v[36:39], 0
    s_waitcnt vmcnt(7)
    v_cmp_ne_u32 vcc, v243, v241
    s_mov_b32 s101, 65536
    s_nop 3
    s_cbranch_vccz L_ok2
L_spin2:
    buffer_load_dword v241, v235, s[40:43], s22 offen sc1
    s_sub_u32 s101, s101, 1
    s_cmp_eq_u32 s101, 0
    s_cbranch_scc1 L_ok2
    s_waitcnt vmcnt(0)
    v_cmp_ne_u32 vcc, v243, v241
    s_nop 4
    s_cbranch_vccnz L_spin2
L_ok2:
    buffer_load_dwordx4 v[44:47], v244, s[40:43], s23 offen sc1
    buffer_load_dwordx4 v[48:51], v244, s[40:43], s23 offen offset:1024 sc1
    buffer_load_dwordx4 v[52:55], v244, s[40:43], s23 offen offset:2048 sc1
    v_max3_f32 v40, v0, v1, v2
    buffer_load_dwordx4 v253, s[48:51], s86 offen offset:2048 lds
    v_max3_f32 v42, v3, v4, v5
    v_max3_f32 v40, v40, v6, v7
    v_max3_f32 v42, v42, v8, v9
    v_max3_f32 v40, v40, v10, v11
    v_max3_f32 v42, v42, v12, v13
    v_max3_f32 v40, v40, v14, v15
    v_max_f32 v40, v40, v42
    v_mul_f32 v40, s72, v40
    v_pk_fma_f32 v[0:1], v[0:1], s[72:73], v[40:41] op_sel_hi:[1,0,0] neg_lo:[0,0,1] neg_hi:[0,0,1]
    v_pk_fma_f32 v[2:3], v[2:3], s[72:73], v[40:41] op_sel_hi:[1,0,0] neg_lo:[0,0,1] neg_hi:[0,0,1]
    v_pk_fma_f32 v[4:5], v[4:5], s[72:73], v[40:41] op_sel_hi:[1,0,0] neg_lo:[0,0,1] neg_hi:[0,0,1]
    v_pk_fma_f32 v[6:7], v[6:7], s[72:73], v[40:41] op_sel_hi:[1,0,0] neg_lo:[0,0,1] neg_hi:[0,0,1]
    v_pk_fma_f32 v[8:9], v[8:9], s[72:73], v[40:41] op_sel_hi:[1,0,0] neg_lo:[0,0,1] neg_hi:[0,0,1]
    v_pk_fma_f32 v[10:11], v[10:11], s[72:73], v[40:41] op_sel_hi:[1,0,0] neg_lo:[0,0,1] neg_hi:[0,0,1]
    v_pk_fma_f32 v[12:13], v[12:13], s[72:73], v[40:41] op_sel_hi:[1,0,0] neg_lo:[0,0,1] neg_hi:[0,0,1]
    buffer_load_dwordx4 v254, s[48:51], s86 offen offset:3072 lds
    s_waitcnt lgkmcnt(0)
    v_pk_fma_f32 v[14:15], v[14:15], s[72:73], v[40:41] op_sel_hi:[1,0,0] neg_lo:[0,0,1] neg_hi:[0,0,1]
    ds_read_b64_tr_b16 a[8:9], v245 offset:16384
    v_exp_f32 v0, v0
    ds_read_b64_tr_b16 a[10:11], v245 offset:16896
    ds_read_b64_tr_b16 a[72:73], v246 offset:16384
    v_exp_f32 v1, v1
    ds_read_b64_tr_b16 a[74:75], v246 offset:16896
    ds_read_b64_tr_b16 a[136:137], v247 offset:16384
    v_exp_f32 v2, v2
    ds_read_b64_tr_b16 a[138:139], v247 offset:16896
    ds_read_b64_tr_b16 a[200:201], v248 offset:16384
    v_exp_f32 v3, v3
    ds_read_b64_tr_b16 a[202:203], v248 offset:16896
    s_add_u32 m0, s97, 65536
    v_exp_f32 v4, v4
    buffer_load_dwordx4 v251, s[52:55], s88 offen lds
    v_exp_f32 v5, v5
    v_pk_add_f32 v[42:43], v[0:1], v[2:3]
    v_exp_f32 v6, v6
    v_exp_f32 v7, v7
    v_pk_add_f32 v[42:43], v[42:43], v[4:5]
    v_exp_f32 v8, v8
    v_exp_f32 v9, v9
    v_pk_add_f32 v[42:43], v[42:43], v[6:7]
    v_exp_f32 v10, v10
    buffer_load_dwordx4 v252, s[52:55], s88 offen offset:1024 lds
    v_exp_f32 v11, v11
    v_pk_add_f32 v[42:43], v[42:43], v[8:9]
    v_exp_f32 v12, v12
    v_exp_f32 v13, v13
    v_pk_add_f32 v[42:43], v[42:43], v[10:11]
    v_exp_f32 v14, v14
    v_exp_f32 v15, v15
    v_pk_add_f32 v[42:43], v[42:43], v[12:13]
    v_pk_add_f32 v[42:43], v[42:43], v[14:15]
    v_add_f32 v42, v42, v43
    buffer_load_dwordx4 v253, s[52:55], s88 offen offset:2048 lds
    v_rcp_f32 v42, v42
    s_nop 0
    v_pk_mul_f32 v[0:1], v[0:1], v[42:43] op_sel_hi:[1,0]
    v_cvt_pk_bf16_f32 v96, v0, v1
    v_pk_mul_f32 v[2:3], v[2:3], v[42:43] op_sel_hi:[1,0]
    v_cvt_pk_bf16_f32 v97, v2, v3
    v_pk_mul_f32 v[4:5], v[4:5], v[42:43] op_sel_hi:[1,0]
    v_cvt_pk_bf16_f32 v98, v4, v5
    v_pk_mul_f32 v[6:7], v[6:7], v[42:43] op_sel_hi:[1,0]
    v_cvt_pk_bf16_f32 v99, v6, v7
    v_pk_mul_f32 v[8:9], v[8:9], v[42:43] op_sel_hi:[1,0]
    v_cvt_pk_bf16_f32 v100, v8, v9
    v_pk_mul_f32 v[10:11], v[10:11], v[42:43] op_sel_hi:[1,0]
    v_cvt_pk_bf16_f32 v101, v10, v11
    v_pk_mul_f32 v[12:13], v[12:13], v[42:43] op_sel_hi:[1,0]
    buffer_load_dwordx4 v254, s[52:55], s88 offen offset:3072 lds
    s_waitcnt lgkmcnt(0)
    v_cvt_pk_bf16_f32 v102, v12, v13
    ds_read_b64_tr_b16 a[12:13], v245 offset:32768
    v_pk_mul_f32 v[14:15], v[14:15], v[42:43] op_sel_hi:[1,0]
    ds_read_b64_tr_b16 a[14:15], v245 offset:33280
    ds_read_b64_tr_b16 a[76:77], v246 offset:32768
    v_cvt_pk_bf16_f32 v103, v14, v15
    ds_read_b64_tr_b16 a[78:79], v246 offset:33280
    ds_read_b64_tr_b16 a[140:141], v247 offset:32768
    s_waitcnt vmcnt(8)
    v_cvt_pk_bf16_f32 v44, v44, v45
    v_cvt_pk_bf16_f32 v45, v46, v47
    ds_write_b64 v230, v[44:45] offset:0
    s_waitcnt vmcnt(7)
    v_cvt_pk_bf16_f32 v48, v48, v49
    v_cvt_pk_bf16_f32 v49, v50, v51
    ds_write_b64 v230, v[48:49] offset:512
    s_waitcnt vmcnt(6)
    v_cvt_pk_bf16_f32 v52, v52, v53
    v_cvt_pk_bf16_f32 v53, v54, v55
    ds_write_b64 v230, v[52:53] offset:1024
    s_waitcnt lgkmcnt(0)
    s_barrier
    ds_read_b128 v[56:59], v231 offset:0
    ds_read_b128 v[60:63], v231 offset:16
    ds_read_b128 v[64:67], v231 offset:1536
    ds_read_b128 v[68:71], v231 offset:1552
    buffer_load_dword v239, v235, s[40:43], s19 offen offset:2048 sc1
    v_max3_f32 v40, v16, v17, v18
    ds_read_b64_tr_b16 a[142:143], v247 offset:33280
    ds_read_b64_tr_b16 a[204:205], v248 offset:32768
    v_max3_f32 v42, v19, v20, v21
    ds_read_b64_tr_b16 a[206:207], v248 offset:33280
    s_add_u32 m0, s97, 81920
    v_max3_f32 v40, v40, v22, v23
    buffer_load_dwordx4 v251, s[52:55], s89 offen lds
    v_max3_f32 v42, v42, v24, v25
    v_max3_f32 v40, v40, v26, v27
    v_max3_f32 v42, v42, v28, v29
    v_max3_f32 v40, v40, v30, v31
    v_max_f32 v40, v40, v42
    v_mul_f32 v40, s72, v40
    v_pk_fma_f32 v[16:17], v[16:17], s[72:73], v[40:41] op_sel_hi:[1,0,0] neg_lo:[0,0,1] neg_hi:[0,0,1]
    v_pk_fma_f32 v[18:19], v[18:19], s[72:73], v[40:41] op_sel_hi:[1,0,0] neg_lo:[0,0,1] neg_hi:[0,0,1]
    v_pk_fma_f32 v[20:21], v[20:21], s[72:73], v[40:41] op_sel_hi:[1,0,0] neg_lo:[0,0,1] neg_hi:[0,0,1]
    v_pk_fma_f32 v[22:23], v[22:23], s[72:73], v[40:41] op_sel_hi:[1,0,0] neg_lo:[0,0,1] neg_hi:[0,0,1]
    v_pk_fma_f32 v[24:25], v[24:25], s[72:73], v[40:41] op_sel_hi:[1,0,0] neg_lo:[0,0,1] neg_hi:[0,0,1]
    v_pk_fma_f32 v[26:27], v[26:27], s[72:73], v[40:41] op_sel_hi:[1,0,0] neg_lo:[0,0,1] neg_hi:[0,0,1]
    v_pk_fma_f32 v[28:29], v[28:29], s[72:73], v[40:41] op_sel_hi:[1,0,0] neg_lo:[0,0,1] neg_hi:[0,0,1]
    v_pk_fma_f32 v[30:31], v[30:31], s[72:73], v[40:41] op_sel_hi:[1,0,0] neg_lo:[0,0,1] neg_hi:[0,0,1]
    v_exp_f32 v16, v16
    buffer_load_dwordx4 v252, s[52:55], s89 offen offset:1024 lds
    v_exp_f32 v17, v17
    v_exp_f32 v18, v18
    v_exp_f32 v19, v19
    v_exp_f32 v20, v20
    v_exp_f32 v21, v21
    v_pk_add_f32 v[42:43], v[16:17], v[18:19]
    v_exp_f32 v22, v22
    v_exp_f32 v23, v23
    buffer_load_dwordx4 v253, s[52:55], s89 offen offset:2048 lds
    v_pk_add_f32 v[42:43], v[42:43], v[20:21]
    v_exp_f32 v24, v24
    v_exp_f32 v25, v25
    v_pk_add_f32 v[42:43], v[42:43], v[22:23]
    v_exp_f32 v26, v26
    v_exp_f32 v27, v27
    v_pk_add_f32 v[42:43], v[42:43], v[24:25]
    v_exp_f32 v28, v28
    v_exp_f32 v29, v29
    buffer_load_dwordx4 v254, s[52:55], s89 offen offset:3072 lds
    s_waitcnt lgkmcnt(0)
    v_pk_add_f32 v[42:43], v[42:43], v[26:27]
    s_add_u32 m0, s97, 98304
    v_exp_f32 v30, v30
    v_exp_f32 v31, v31
    v_pk_add_f32 v[42:43], v[42:43], v[28:29]
    v_pk_add_f32 v[42:43], v[42:43], v[30:31]
    v_add_f32 v42, v42, v43
    v_rcp_f32 v42, v42
    s_nop 0
    v_pk_mul_f32 v[16:17], v[16:17], v[42:43] op_sel_hi:[1,0]
    v_cvt_pk_bf16_f32 v104, v16, v17
    v_pk_mul_f32 v[18:19], v[18:19], v[42:43] op_sel_hi:[1,0]
    buffer_load_dwordx4 v251, s[52:55], s90 offen lds
    v_cvt_pk_bf16_f32 v105, v18, v19
    v_pk_mul_f32 v[20:21], v[20:21], v[42:43] op_sel_hi:[1,0]
    v_cvt_pk_bf16_f32 v106, v20, v21
    v_pk_mul_f32 v[22:23], v[22:23], v[42:43] op_sel_hi:[1,0]
    v_cvt_pk_bf16_f32 v107, v22, v23
    v_pk_mul_f32 v[24:25], v[24:25], v[42:43] op_sel_hi:[1,0]
    v_cvt_pk_bf16_f32 v108, v24, v25
    v_pk_mul_f32 v[26:27], v[26:27], v[42:43] op_sel_hi:[1,0]
    v_cvt_pk_bf16_f32 v109, v26, v27
    v_pk_mul_f32 v[28:29], v[28:29], v[42:43] op_sel_hi:[1,0]
    v_cvt_pk_bf16_f32 v110, v28, v29
    v_pk_mul_f32 v[30:31], v[30:31], v[42:43] op_sel_hi:[1,0]
    v_cvt_pk_bf16_f32 v111, v30, v31
    v_mfma_f32_32x32x16_bf16 v[0:15], v[56:59], v[112:115], 0
    buffer_load_dwordx4 v252, s[52:55], s90 offen offset:1024 lds
    v_mfma_f32_32x32x16_bf16 v[0:15], v[60:63], v[116:119], v[0:15]
    v_mfma_f32_32x32x16_bf16 v[72:87], v[56:59], v[120:123], 0
    v_mfma_f32_32x32x16_bf16 v[72:87], v[60:63], v[124:127], v[72:87]
    v_mfma_f32_32x32x16_bf16 v[32:47], v[64:67], v[96:99], 0
    v_mfma_f32_32x32x16_bf16 v[32:47], v[68:71], v[100:103], v[32:47]
    v_mfma_f32_32x32x16_bf16 v[16:31], v[64:67], v[104:107], 0
    v_mfma_f32_32x32x16_bf16 v[16:31], v[68:71], v[108:111], v[16:31]
    s_nop 5
    v_add_f32 v8, 0x358637bd, v8
    v_rcp_f32 v8, v8
    s_nop 0
    v_pk_mul_f32 v[0:1], v[0:1], v[8:9] op_sel_hi:[1,0]
    v_pk_mul_f32 v[2:3], v[2:3], v[8:9] op_sel_hi:[1,0]
    v_pk_mul_f32 v[4:5], v[4:5], v[8:9] op_sel_hi:[1,0]
    v_pk_mul_f32 v[6:7], v[6:7], v[8:9] op_sel_hi:[1,0]
    v_cvt_pk_bf16_f32 v12, v0, v1
    v_cvt_pk_bf16_f32 v13, v2, v3
    v_cvt_pk_bf16_f32 v14, v4, v5
    v_cvt_pk_bf16_f32 v15, v6, v7
    buffer_store_dwordx4 v[12:15], v244, s[40:43], s24 offen sc1
    v_add_f32 v80, 0x358637bd, v80
    v_rcp_f32 v80, v80
    s_nop 0
    v_pk_mul_f32 v[72:73], v[72:73], v[80:81] op_sel_hi:[1,0]
    v_pk_mul_f32 v[74:75], v[74:75], v[80:81] op_sel_hi:[1,0]
    v_pk_mul_f32 v[76:77], v[76:77], v[80:81] op_sel_hi:[1,0]
    v_pk_mul_f32 v[78:79], v[78:79], v[80:81] op_sel_hi:[1,0]
    v_cvt_pk_bf16_f32 v84, v72, v73
    v_cvt_pk_bf16_f32 v85, v74, v75
    v_cvt_pk_bf16_f32 v86, v76, v77
    v_cvt_pk_bf16_f32 v87, v78, v79
    buffer_store_dwordx4 v[84:87], v244, s[40:43], s25 offen sc1
    v_add_f32 v40, 0x358637bd, v40
    v_rcp_f32 v40, v40
    s_nop 0
    v_pk_mul_f32 v[32:33], v[32:33], v[40:41] op_sel_hi:[1,0]
    v_pk_mul_f32 v[34:35], v[34:35], v[40:41] op_sel_hi:[1,0]
    v_pk_mul_f32 v[36:37], v[36:37], v[40:41] op_sel_hi:[1,0]
    v_pk_mul_f32 v[38:39], v[38:39], v[40:41] op_sel_hi:[1,0]
    v_cvt_pk_bf16_f32 v44, v32, v33
    v_cvt_pk_bf16_f32 v45, v34, v35
    v_cvt_pk_bf16_f32 v46, v36, v37
    v_cvt_pk_bf16_f32 v47, v38, v39
    buffer_store_dwordx4 v[44:47], v244, s[40:43], s24 offen offset:1024 sc1
    v_add_f32 v24, 0x358637bd, v24
    v_rcp_f32 v24, v24
    s_nop 0
    v_pk_mul_f32 v[16:17], v[16:17], v[24:25] op_sel_hi:[1,0]
    v_pk_mul_f32 v[18:19], v[18:19], v[24:25] op_sel_hi:[1,0]
    v_pk_mul_f32 v[20:21], v[20:21], v[24:25] op_sel_hi:[1,0]
    v_pk_mul_f32 v[22:23], v[22:23], v[24:25] op_sel_hi:[1,0]
    v_cvt_pk_bf16_f32 v28, v16, v17
    v_cvt_pk_bf16_f32 v29, v18, v19
    v_cvt_pk_bf16_f32 v30, v20, v21
    v_cvt_pk_bf16_f32 v31, v22, v23
    buffer_store_dwordx4 v[28:31], v244, s[40:43], s25 offen offset:1024 sc1
    buffer_load_dwordx4 v253, s[52:55], s90 offen offset:2048 lds
    buffer_load_dwordx4 v254, s[52:55], s90 offen offset:3072 lds
    s_waitcnt vmcnt(12)
    v_cmp_ne_u32 vcc, v243, v239
    s_mov_b32 s101, 65536
    s_nop 3
    s_cbranch_vccz L_ok3
L_spin3:
    buffer_load_dword v239, v235, s[40:43], s19 offen offset:2048 sc1
    s_sub_u32 s101, s101, 1
    s_cmp_eq_u32 s101, 0
    s_cbranch_scc1 L_ok3
    s_waitcnt vmcnt(0)
    v_cmp_ne_u32 vcc, v243, v239
    s_nop 4
    s_cbranch_vccnz L_spin3
L_ok3:
    buffer_load_dwordx4 v[128:131], v234, s[56:59], s4 offen sc1
    ds_read_b64_tr_b16 a[16:17], v245 offset:49152
    ds_read_b64_tr_b16 a[18:19], v245 offset:49664
    ds_read_b64_tr_b16 a[80:81], v246 offset:49152
    ds_read_b64_tr_b16 a[82:83], v246 offset:49664
    ds_read_b64_tr_b16 a[144:145], v247 offset:49152
    buffer_load_dwordx4 v[132:135], v234, s[56:59], s4 offen offset:256 sc1
    ds_read_b64_tr_b16 a[146:147], v247 offset:49664
    ds_read_b64_tr_b16 a[208:209], v248 offset:49152
    ds_read_b64_tr_b16 a[210:211], v248 offset:49664
    v_add_u32 v245, 0x10000, v245
    v_add_u32 v246, 0x10000, v246
    buffer_load_dwordx4 v[136:139], v234, s[60:63], s4 offen sc1
    v_add_u32 v247, 0x10000, v247
    v_add_u32 v248, 0x10000, v248
    ds_read_b64_tr_b16 a[20:21], v245 offset:0
    ds_read_b64_tr_b16 a[22:23], v245 offset:512
    buffer_load_dwordx4 v[140:143], v234, s[60:63], s4 offen offset:256 sc1
    ds_read_b64_tr_b16 a[84:85], v246 offset:0
    ds_read_b64_tr_b16 a[86:87], v246 offset:512
    ds_read_b64_tr_b16 a[148:149], v247 offset:0
    ds_read_b64_tr_b16 a[150:151], v247 offset:512
    ds_read_b64_tr_b16 a[212:213], v248 offset:0
    buffer_load_dwordx4 v[144:147], v234, s[56:59], s5 offen sc1
    ds_read_b64_tr_b16 a[214:215], v248 offset:512
    v_add_u32 v245, 0xfffe0000, v245
    v_add_u32 v246, 0xfffe0000, v246
    v_add_u32 v247, 0xfffe0000, v247
    v_add_u32 v248, 0xfffe0000, v248
    buffer_load_dwordx4 v[148:151], v234, s[56:59], s5 offen offset:256 sc1
    ds_read_b64_tr_b16 a[24:25], v245 offset:0
    ds_read_b64_tr_b16 a[26:27], v245 offset:512
    ds_read_b64_tr_b16 a[88:89], v246 offset:0
    ds_read_b64_tr_b16 a[90:91], v246 offset:512
    buffer_load_dwordx4 v[152:155], v234, s[60:63], s5 offen sc1
    ds_read_b64_tr_b16 a[152:153], v247 offset:0
    ds_read_b64_tr_b16 a[154:155], v247 offset:512
    ds_read_b64_tr_b16 a[216:217], v248 offset:0
    ds_read_b64_tr_b16 a[218:219], v248 offset:512
    buffer_load_dwordx4 v[156:159], v234, s[60:63], s5 offen offset:256 sc1
    ds_read_b64_tr_b16 a[32:33], v245 offset:16384
    ds_read_b64_tr_b16 a[34:35], v245 offset:16896
    ds_read_b64_tr_b16 a[96:97], v246 offset:16384
    ds_read_b64_tr_b16 a[98:99], v246 offset:16896
    ds_read_b64_tr_b16 a[160:161], v247 offset:16384
    buffer_load_dwordx4 v[160:163], v234, s[56:59], s6 offen sc1
    ds_read_b64_tr_b16 a[162:163], v247 offset:16896
    ds_read_b64_tr_b16 a[224:225], v248 offset:16384
    ds_read_b64_tr_b16 a[226:227], v248 offset:16896
    ds_read_b64_tr_b16 a[36:37], v245 offset:32768
    buffer_load_dwordx4 v[164:167], v234, s[56:59], s6 offen offset:256 sc1
    ds_read_b64_tr_b16 a[38:39], v245 offset:33280
    ds_read_b64_tr_b16 a[100:101], v246 offset:32768
    ds_read_b64_tr_b16 a[102:103], v246 offset:33280
    ds_read_b64_tr_b16 a[164:165], v247 offset:32768
    ds_read_b64_tr_b16 a[166:167], v247 offset:33280
    buffer_load_dwordx4 v[168:171], v234, s[60:63], s6 offen sc1
    ds_read_b64_tr_b16 a[228:229], v248 offset:32768
    ds_read_b64_tr_b16 a[230:231], v248 offset:33280
    ds_read_b64_tr_b16 a[40:41], v245 offset:49152
    ds_read_b64_tr_b16 a[42:43], v245 offset:49664
    buffer_load_dwordx4 v[172:175], v234, s[60:63], s6 offen offset:256 sc1
    ds_read_b64_tr_b16 a[104:105], v246 offset:49152
    ds_read_b64_tr_b16 a[106:107], v246 offset:49664
    ds_read_b64_tr_b16 a[168:169], v247 offset:49152
    ds_read_b64_tr_b16 a[170:171], v247 offset:49664
    ds_read_b64_tr_b16 a[232:233], v248 offset:49152
    ds_read_b64_tr_b16 a[234:235], v248 offset:49664
    v_add_u32 v245, 0x10000, v245
    v_add_u32 v246, 0x10000, v246
    v_add_u32 v247, 0x10000, v247
    v_add_u32 v248, 0x10000, v248
    ds_read_b64_tr_b16 a[48:49], v245 offset:0
    ds_read_b64_tr_b16 a[50:51], v245 offset:512
    ds_read_b64_tr_b16 a[112:113], v246 offset:0
    ds_read_b64_tr_b16 a[114:115], v246 offset:512
    ds_read_b64_tr_b16 a[176:177], v247 offset:0
    ds_read_b64_tr_b16 a[178:179], v247 offset:512
    ds_read_b64_tr_b16 a[240:241], v248 offset:0
    ds_read_b64_tr_b16 a[242:243], v248 offset:512
    s_waitcnt vmcnt(20)
    ds_read_b64_tr_b16 a[52:53], v245 offset:16384
    ds_read_b64_tr_b16 a[54:55], v245 offset:16896
    ds_read_b64_tr_b16 a[116:117], v246 offset:16384
    ds_read_b64_tr_b16 a[118:119], v246 offset:16896
    ds_read_b64_tr_b16 a[180:181], v247 offset:16384
    ds_read_b64_tr_b16 a[182:183], v247 offset:16896
    ds_read_b64_tr_b16 a[244:245], v248 offset:16384
    ds_read_b64_tr_b16 a[246:247], v248 offset:16896
    s_waitcnt vmcnt(12)
L_pad_q_3:
    s_cbranch_execz L_walked_q
    ds_read_b64_tr_b16 a[56:57], v245 offset:32768
    ds_read_b64_tr_b16 a[58:59], v245 offset:33280
    ds_read_b64_tr_b16 a[120:121], v246 offset:32768
    ds_read_b64_tr_b16 a[122:123], v246 offset:33280
    ds_read_b64_tr_b16 a[184:185], v247 offset:32768
    ds_read_b64_tr_b16 a[186:187], v247 offset:33280
    ds_read_b64_tr_b16 a[248:249], v248 offset:32768
    ds_read_b64_tr_b16 a[250:251], v248 offset:33280
    buffer_store_dword v243, v237, s[40:43], s26 offen sc1
    s_waitcnt vmcnt(12)
    v_mfma_f32_16x16x32_bf16 v[0:3], a[0:3], v[128:131], 0
    v_mfma_f32_16x16x32_bf16 v[4:7], a[64:67], v[128:131], 0
    v_mfma_f32_16x16x32_bf16 v[8:11], a[128:131], v[128:131], 0
    v_mfma_f32_16x16x32_bf16 v[12:15], a[192:195], v[128:131], 0
    buffer_load_dwordx4 v[176:179], v234, s[56:59], s7 offen sc1
    s_waitcnt vmcnt(12)
    v_mfma_f32_16x16x32_bf16 v[16:19], a[0:3], v[132:135], 0
    buffer_load_dword v228, v236, s[40:43], s21 offen offset:0 sc1
    buffer_load_dword v229, v236, s[40:43], s21 offen offset:64 sc1
    v_mfma_f32_16x16x32_bf16 v[20:23], a[64:67], v[132:135], 0
    buffer_load_dword v232, v236, s[40:43], s21 offen offset:128 sc1
    buffer_load_dword v233, v236, s[40:43], s21 offen offset:192 sc1
    v_mfma_f32_16x16x32_bf16 v[24:27], a[128:131], v[132:135], 0
    v_mfma_f32_16x16x32_bf16 v[28:31], a[192:195], v[132:135], 0
    buffer_load_dwordx4 v[180:183], v234, s[56:59], s7 offen offset:256 sc1
    s_waitcnt vmcnt(16)
    v_mfma_f32_16x16x32_bf16 v[32:35], a[0:3], v[136:139], 0
    v_mfma_f32_16x16x32_bf16 v[36:39], a[64:67], v[136:139], 0
    v_mfma_f32_16x16x32_bf16 v[40:43], a[128:131], v[136:139], 0
    v_mfma_f32_16x16x32_bf16 v[44:47], a[192:195], v[136:139], 0
    buffer_load_dwordx4 v[184:187], v234, s[60:63], s7 offen sc1
    s_waitcnt vmcnt(16)
    v_mfma_f32_16x16x32_bf16 v[48:51], a[0:3], v[140:143], 0
    v_mfma_f32_16x16x32_bf16 v[52:55], a[64:67], v[140:143], 0
    v_mfma_f32_16x16x32_bf16 v[56:59], a[128:131], v[140:143], 0
    v_mfma_f32_16x16x32_bf16 v[60:63], a[192:195], v[140:143], 0
    buffer_load_dwordx4 v[188:191], v234, s[60:63], s7 offen offset:256 sc1
    s_waitcnt vmcnt(16)
    v_mfma_f32_16x16x32_bf16 v[0:3], a[4:7], v[144:147], v[0:3]
    v_mfma_f32_16x16x32_bf16 v[4:7], a[68:71], v[144:147], v[4:7]
    v_mfma_f32_16x16x32_bf16 v[8:11], a[132:135], v[144:147], v[8:11]
    v_mfma_f32_16x16x32_bf16 v[12:15], a[196:199], v[144:147], v[12:15]
    buffer_load_dwordx4 v[192:195], v234, s[56:59], s8 offen sc1
    s_waitcnt vmcnt(16)
    v_mfma_f32_16x16x32_bf16 v[16:19], a[4:7], v[148:151], v[16:19]
    v_mfma_f32_16x16x32_bf16 v[20:23], a[68:71], v[148:151], v[20:23]
    v_mfma_f32_16x16x32_bf16 v[24:27], a[132:135], v[148:151], v[24:27]
    v_mfma_f32_16x16x32_bf16 v[28:31], a[196:199], v[148:151], v[28:31]
    buffer_load_dwordx4 v[196:199], v234, s[56:59], s8 offen offset:256 sc1
    s_waitcnt vmcnt(16)
    v_mfma_f32_16x16x32_bf16 v[32:35], a[4:7], v[152:155], v[32:35]
    v_mfma_f32_16x16x32_bf16 v[36:39], a[68:71], v[152:155], v[36:39]
    v_mfma_f32_16x16x32_bf16 v[40:43], a[132:135], v[152:155], v[40:43]
    v_mfma_f32_16x16x32_bf16 v[44:47], a[196:199], v[152:155], v[44:47]
    buffer_load_dwordx4 v[200:203], v234, s[60:63], s8 offen sc1
    v_bfe_u32 v240, v255, 4, 1
    v_lshlrev_b32 v240, 5, v240
    v_xor_b32 v251, v251, v240
    s_lshl_b32 s101, s91, 13
    v_add_u32 v251, s101, v251
    s_mov_b32 s74, 0x8000
    v_add_u32 v242, s74, v234
    s_waitcnt vmcnt(16)
    v_mfma_f32_16x16x32_bf16 v[48:51], a[4:7], v[156:159], v[48:51]
    v_mfma_f32_16x16x32_bf16 v[52:55], a[68:71], v[156:159], v[52:55]
    v_mfma_f32_16x16x32_bf16 v[56:59], a[132:135], v[156:159], v[56:59]
    v_mfma_f32_16x16x32_bf16 v[60:63], a[196:199], v[156:159], v[60:63]
    buffer_load_dwordx4 v[204:207], v234, s[60:63], s8 offen offset:256 sc1
    s_waitcnt vmcnt(16)
    v_mfma_f32_16x16x32_bf16 v[0:3], a[8:11], v[160:163], v[0:3]
    v_mfma_f32_16x16x32_bf16 v[4:7], a[72:75], v[160:163], v[4:7]
    v_mfma_f32_16x16x32_bf16 v[8:11], a[136:139], v[160:163], v[8:11]
    v_mfma_f32_16x16x32_bf16 v[12:15], a[200:203], v[160:163], v[12:15]
    buffer_load_dword v239, v235, s[40:43], s19 offen sc1
    buffer_load_dwordx4 v[208:211], v234, s[56:59], s9 offen sc1
    s_waitcnt vmcnt(17)
    v_mfma_f32_16x16x32_bf16 v[16:19], a[8:11], v[164:167], v[16:19]
    v_mfma_f32_16x16x32_bf16 v[20:23], a[72:75], v[164:167], v[20:23]
    v_mfma_f32_16x16x32_bf16 v[24:27], a[136:139], v[164:167], v[24:27]
    v_mfma_f32_16x16x32_bf16 v[28:31], a[200:203], v[164:167], v[28:31]
    buffer_load_dwordx4 v[212:215], v234, s[56:59], s9 offen offset:256 sc1
    s_waitcnt vmcnt(17)
    v_mfma_f32_16x16x32_bf16 v[32:35], a[8:11], v[168:171], v[32:35]
    v_mfma_f32_16x16x32_bf16 v[36:39], a[72:75], v[168:171], v[36:39]
    v_mfma_f32_16x16x32_bf16 v[40:43], a[136:139], v[168:171], v[40:43]
    v_mfma_f32_16x16x32_bf16 v[44:47], a[200:203], v[168:171], v[44:47]
    buffer_load_dwordx4 v[216:219], v234, s[60:63], s9 offen sc1
    s_waitcnt vmcnt(17)
    v_mfma_f32_16x16x32_bf16 v[48:51], a[8:11], v[172:175], v[48:51]
    v_mfma_f32_16x16x32_bf16 v[52:55], a[72:75], v[172:175], v[52:55]
    v_mfma_f32_16x16x32_bf16 v[56:59], a[136:139], v[172:175], v[56:59]
    v_mfma_f32_16x16x32_bf16 v[60:63], a[200:203], v[172:175], v[60:63]
    buffer_load_dwordx4 v[220:223], v234, s[60:63], s9 offen offset:256 sc1
    s_waitcnt vmcnt(16)
    v_mfma_f32_16x16x32_bf16 v[0:3], a[12:15], v[176:179], v[0:3]
    v_mfma_f32_16x16x32_bf16 v[4:7], a[76:79], v[176:179], v[4:7]
    v_mfma_f32_16x16x32_bf16 v[8:11], a[140:143], v[176:179], v[8:11]
    v_mfma_f32_16x16x32_bf16 v[12:15], a[204:207], v[176:179], v[12:15]
    buffer_load_dwordx4 v[128:131], v234, s[56:59], s10 offen sc1
    s_waitcnt vmcnt(12)
    v_mfma_f32_16x16x32_bf16 v[16:19], a[12:15], v[180:183], v[16:19]
    v_mfma_f32_16x16x32_bf16 v[20:23], a[76:79], v[180:183], v[20:23]
    v_mfma_f32_16x16x32_bf16 v[24:27], a[140:143], v[180:183], v[24:27]
    v_mfma_f32_16x16x32_bf16 v[28:31], a[204:207], v[180:183], v[28:31]
    buffer_load_dwordx4 v[132:135], v234, s[56:59], s10 offen offset:256 sc1
    s_waitcnt vmcnt(12)
    v_mfma_f32_16x16x32_bf16 v[32:35], a[12:15], v[184:187], v[32:35]
    v_mfma_f32_16x16x32_bf16 v[36:39], a[76:79], v[184:187], v[36:39]
    v_mfma_f32_16x16x32_bf16 v[40:43], a[140:143], v[184:187], v[40:43]
    v_mfma_f32_16x16x32_bf16 v[44:47], a[204:207], v[184:187], v[44:47]
    buffer_load_dwordx4 v[136:139], v234, s[60:63], s10 offen sc1
    s_waitcnt vmcnt(12)
    v_mfma_f32_16x16x32_bf16 v[48:51], a[12:15], v[188:191], v[48:51]
    v_mfma_f32_16x16x32_bf16 v[52:55], a[76:79], v[188:191], v[52:55]
    v_mfma_f32_16x16x32_bf16 v[56:59], a[140:143], v[188:191], v[56:59]
    v_mfma_f32_16x16x32_bf16 v[60:63], a[204:207], v[188:191], v[60:63]
    buffer_load_dwordx4 v[140:143], v234, s[60:63], s10 offen offset:256 sc1
    s_waitcnt vmcnt(12) lgkmcnt(0)
    v_mfma_f32_16x16x32_bf16 v[0:3], a[16:19], v[192:195], v[0:3]
    v_mfma_f32_16x16x32_bf16 v[4:7], a[80:83], v[192:195], v[4:7]
    v_mfma_f32_16x16x32_bf16 v[8:11], a[144:147], v[192:195], v[8:11]
    v_mfma_f32_16x16x32_bf16 v[12:15], a[208:211], v[192:195], v[12:15]
    s_waitcnt vmcnt(8)
    v_cmp_ne_u32 vcc, v243, v239
    s_mov_b32 s101, 65536
    s_nop 3
    s_cbranch_vccz L_ok4
L_spin4:
    buffer_load_dword v239, v235, s[40:43], s19 offen sc1
    s_sub_u32 s101, s101, 1
    s_cmp_eq_u32 s101, 0
    s_cbranch_scc1 L_ok4
    s_waitcnt vmcnt(0)
    v_cmp_ne_u32 vcc, v243, v239
    s_nop 4
    s_cbranch_vccnz L_spin4
L_ok4:
    buffer_load_dwordx4 v[144:147], v234, s[56:59], s11 offen sc1
    v_mfma_f32_16x16x32_bf16 v[16:19], a[16:19], v[196:199], v[16:19]
    v_mfma_f32_16x16x32_bf16 v[20:23], a[80:83], v[196:199], v[20:23]
    v_mfma_f32_16x16x32_bf16 v[24:27], a[144:147], v[196:199], v[24:27]
    v_mfma_f32_16x16x32_bf16 v[28:31], a[208:211], v[196:199], v[28:31]
    buffer_load_dwordx4 v[148:151], v234, s[56:59], s11 offen offset:256 sc1
    v_mfma_f32_16x16x32_bf16 v[32:35], a[16:19], v[200:203], v[32:35]
    v_mfma_f32_16x16x32_bf16 v[36:39], a[80:83], v[200:203], v[36:39]
    v_mfma_f32_16x16x32_bf16 v[40:43], a[144:147], v[200:203], v[40:43]
    v_mfma_f32_16x16x32_bf16 v[44:47], a[208:211], v[200:203], v[44:47]
    buffer_load_dwordx4 v[152:155], v234, s[60:63], s11 offen sc1
    v_mfma_f32_16x16x32_bf16 v[48:51], a[16:19], v[204:207], v[48:51]
    v_mfma_f32_16x16x32_bf16 v[52:55], a[80:83], v[204:207], v[52:55]
    v_mfma_f32_16x16x32_bf16 v[56:59], a[144:147], v[204:207], v[56:59]
    v_mfma_f32_16x16x32_bf16 v[60:63], a[208:211], v[204:207], v[60:63]
    buffer_load_dwordx4 v[156:159], v234, s[60:63], s11 offen offset:256 sc1
    s_waitcnt vmcnt(11)
    v_mfma_f32_16x16x32_bf16 v[0:3], a[20:23], v[208:211], v[0:3]
    v_mfma_f32_16x16x32_bf16 v[4:7], a[84:87], v[208:211], v[4:7]
    v_mfma_f32_16x16x32_bf16 v[8:11], a[148:151], v[208:211], v[8:11]
    v_mfma_f32_16x16x32_bf16 v[12:15], a[212:215], v[208:211], v[12:15]
    buffer_load_dwordx4 v[160:163], v234, s[56:59], s12 offen sc1
    s_waitcnt vmcnt(11)
    v_mfma_f32_16x16x32_bf16 v[16:19], a[20:23], v[212:215], v[16:19]
    v_mfma_f32_16x16x32_bf16 v[20:23], a[84:87], v[212:215], v[20:23]
    v_mfma_f32_16x16x32_bf16 v[24:27], a[148:151], v[212:215], v[24:27]
    v_mfma_f32_16x16x32_bf16 v[28:31], a[212:215], v[212:215], v[28:31]
    buffer_load_dwordx4 v[164:167], v234, s[56:59], s12 offen offset:256 sc1
    s_waitcnt vmcnt(11)
    v_mfma_f32_16x16x32_bf16 v[32:35], a[20:23], v[216:219], v[32:35]
    v_mfma_f32_16x16x32_bf16 v[36:39], a[84:87], v[216:219], v[36:39]
    v_mfma_f32_16x16x32_bf16 v[40:43], a[148:151], v[216:219], v[40:43]
    v_mfma_f32_16x16x32_bf16 v[44:47], a[212:215], v[216:219], v[44:47]
    buffer_load_dwordx4 v[168:171], v234, s[60:63], s12 offen sc1
    s_waitcnt vmcnt(11)
    v_mfma_f32_16x16x32_bf16 v[48:51], a[20:23], v[220:223], v[48:51]
    v_mfma_f32_16x16x32_bf16 v[52:55], a[84:87], v[220:223], v[52:55]
    v_mfma_f32_16x16x32_bf16 v[56:59], a[148:151], v[220:223], v[56:59]
    v_mfma_f32_16x16x32_bf16 v[60:63], a[212:215], v[220:223], v[60:63]
    buffer_load_dwordx4 v[172:175], v234, s[60:63], s12 offen offset:256 sc1
    s_waitcnt vmcnt(11)
    v_mfma_f32_16x16x32_bf16 v[0:3], a[24:27], v[128:131], v[0:3]
    v_mfma_f32_16x16x32_bf16 v[4:7], a[88:91], v[128:131], v[4:7]
    v_mfma_f32_16x16x32_bf16 v[8:11], a[152:155], v[128:131], v[8:11]
    v_mfma_f32_16x16x32_bf16 v[12:15], a[216:219], v[128:131], v[12:15]
    buffer_load_dword v239, v235, s[40:43], s20 offen sc1
    buffer_load_dwordx4 v[176:179], v234, s[56:59], s13 offen sc1
    s_waitcnt vmcnt(12)
    v_mfma_f32_16x16x32_bf16 v[16:19], a[24:27], v[132:135], v[16:19]
    v_mfma_f32_16x16x32_bf16 v[20:23], a[88:91], v[132:135], v[20:23]
    v_mfma_f32_16x16x32_bf16 v[24:27], a[152:155], v[132:135], v[24:27]
    v_mfma_f32_16x16x32_bf16 v[28:31], a[216:219], v[132:135], v[28:31]
    buffer_load_dwordx4 v[180:183], v234, s[56:59], s13 offen offset:256 sc1
    s_waitcnt vmcnt(12)
    v_mfma_f32_16x16x32_bf16 v[32:35], a[24:27], v[136:139], v[32:35]
    v_mfma_f32_16x16x32_bf16 v[36:39], a[88:91], v[136:139], v[36:39]
    v_mfma_f32_16x16x32_bf16 v[40:43], a[152:155], v[136:139], v[40:43]
    v_mfma_f32_16x16x32_bf16 v[44:47], a[216:219], v[136:139], v[44:47]
    buffer_load_dwordx4 v[184:187], v234, s[60:63], s13 offen sc1
    s_waitcnt vmcnt(12)
    v_mfma_f32_16x16x32_bf16 v[48:51], a[24:27], v[140:143], v[48:51]
    v_mfma_f32_16x16x32_bf16 v[52:55], a[88:91], v[140:143], v[52:55]
    v_mfma_f32_16x16x32_bf16 v[56:59], a[152:155], v[140:143], v[56:59]
    v_mfma_f32_16x16x32_bf16 v[60:63], a[216:219], v[140:143], v[60:63]
    buffer_load_dwordx4 v[188:191], v234, s[60:63], s13 offen offset:256 sc1
    s_waitcnt vmcnt(12)
    v_mfma_f32_16x16x32_bf16 v[0:3], a[28:31], v[144:147], v[0:3]
    v_mfma_f32_16x16x32_bf16 v[4:7], a[92:95], v[144:147], v[4:7]
    v_mfma_f32_16x16x32_bf16 v[8:11], a[156:159], v[144:147], v[8:11]
    v_mfma_f32_16x16x32_bf16 v[12:15], a[220:223], v[144:147], v[12:15]
    buffer_load_dwordx4 v[192:195], v234, s[56:59], s14 offen sc1
    s_waitcnt vmcnt(12)
    v_mfma_f32_16x16x32_bf16 v[16:19], a[28:31], v[148:151], v[16:19]
    v_mfma_f32_16x16x32_bf16 v[20:23], a[92:95], v[148:151], v[20:23]
    v_mfma_f32_16x16x32_bf16 v[24:27], a[156:159], v[148:151], v[24:27]
    v_mfma_f32_16x16x32_bf16 v[28:31], a[220:223], v[148:151], v[28:31]
    buffer_load_dwordx4 v[196:199], v234, s[56:59], s14 offen offset:256 sc1
    s_waitcnt vmcnt(12)
    v_mfma_f32_16x16x32_bf16 v[32:35], a[28:31], v[152:155], v[32:35]
    v_mfma_f32_16x16x32_bf16 v[36:39], a[92:95], v[152:155], v[36:39]
    v_mfma_f32_16x16x32_bf16 v[40:43], a[156:159], v[152:155], v[40:43]
    v_mfma_f32_16x16x32_bf16 v[44:47], a[220:223], v[152:155], v[44:47]
    buffer_load_dwordx4 v[200:203], v234, s[60:63], s14 offen sc1
    v_sub_f32 v230, 1.0, v228
    v_sub_f32 v231, 1.0, v229
    v_sub_f32 v249, 1.0, v232
    v_sub_f32 v250, 1.0, v233
    s_waitcnt vmcnt(12)
    v_mfma_f32_16x16x32_bf16 v[48:51], a[28:31], v[156:159], v[48:51]
    v_mfma_f32_16x16x32_bf16 v[52:55], a[92:95], v[156:159], v[52:55]
    v_mfma_f32_16x16x32_bf16 v[56:59], a[156:159], v[156:159], v[56:59]
    v_mfma_f32_16x16x32_bf16 v[60:63], a[220:223], v[156:159], v[60:63]
    buffer_load_dwordx4 v[204:207], v234, s[60:63], s14 offen offset:256 sc1
    s_waitcnt vmcnt(12)
    v_mfma_f32_16x16x32_bf16 v[0:3], a[32:35], v[160:163], v[0:3]
    v_mfma_f32_16x16x32_bf16 v[4:7], a[96:99], v[160:163], v[4:7]
    v_mfma_f32_16x16x32_bf16 v[8:11], a[160:163], v[160:163], v[8:11]
    v_mfma_f32_16x16x32_bf16 v[12:15], a[224:227], v[160:163], v[12:15]
    s_waitcnt vmcnt(8)
    v_cmp_ne_u32 vcc, v243, v239
    s_mov_b32 s101, 65536
    s_nop 3
    s_cbranch_vccz L_ok5
L_spin5:
    buffer_load_dword v239, v235, s[40:43], s20 offen sc1
    s_sub_u32 s101, s101, 1
    s_cmp_eq_u32 s101, 0
    s_cbranch_scc1 L_ok5
    s_waitcnt vmcnt(0)
    v_cmp_ne_u32 vcc, v243, v239
    s_nop 4
    s_cbranch_vccnz L_spin5
L_ok5:
    buffer_load_dwordx4 v[208:211], v234, s[40:43], s15 offen sc1
    v_mfma_f32_16x16x32_bf16 v[16:19], a[32:35], v[164:167], v[16:19]
    v_mfma_f32_16x16x32_bf16 v[20:23], a[96:99], v[164:167], v[20:23]
    v_mfma_f32_16x16x32_bf16 v[24:27], a[160:163], v[164:167], v[24:27]
    v_mfma_f32_16x16x32_bf16 v[28:31], a[224:227], v[164:167], v[28:31]
    buffer_load_dwordx4 v[212:215], v234, s[40:43], s15 offen offset:256 sc1
    v_mfma_f32_16x16x32_bf16 v[32:35], a[32:35], v[168:171], v[32:35]
    v_mfma_f32_16x16x32_bf16 v[36:39], a[96:99], v[168:171], v[36:39]
    v_mfma_f32_16x16x32_bf16 v[40:43], a[160:163], v[168:171], v[40:43]
    v_mfma_f32_16x16x32_bf16 v[44:47], a[224:227], v[168:171], v[44:47]
    buffer_load_dwordx4 v[216:219], v234, s[40:43], s16 offen sc1
    v_and_b32 v241, 15, v255
    v_lshl_add_u32 v240, v241, 8, s97
    v_lshrrev_b32 v247, 4, v255
    v_and_b32 v248, 7, v255
    v_xor_b32 v246, v247, v248
    v_lshlrev_b32 v245, 4, v246
    v_add_u32 v226, v240, v245
    v_xor_b32 v227, 64, v226
    v_mfma_f32_16x16x32_bf16 v[48:51], a[32:35], v[172:175], v[48:51]
    v_mfma_f32_16x16x32_bf16 v[52:55], a[96:99], v[172:175], v[52:55]
    v_mfma_f32_16x16x32_bf16 v[56:59], a[160:163], v[172:175], v[56:59]
    v_mfma_f32_16x16x32_bf16 v[60:63], a[224:227], v[172:175], v[60:63]
    buffer_load_dwordx4 v[220:223], v234, s[40:43], s16 offen offset:256 sc1
    s_waitcnt vmcnt(11)
    v_mfma_f32_16x16x32_bf16 v[0:3], a[36:39], v[176:179], v[0:3]
    v_mfma_f32_16x16x32_bf16 v[4:7], a[100:103], v[176:179], v[4:7]
    v_mfma_f32_16x16x32_bf16 v[8:11], a[164:167], v[176:179], v[8:11]
    v_mfma_f32_16x16x32_bf16 v[12:15], a[228:231], v[176:179], v[12:15]
    buffer_load_dwordx4 v[128:131], v234, s[40:43], s17 offen sc1
    s_waitcnt vmcnt(11)
    v_mfma_f32_16x16x32_bf16 v[16:19], a[36:39], v[180:183], v[16:19]
    v_mfma_f32_16x16x32_bf16 v[20:23], a[100:103], v[180:183], v[20:23]
    v_mfma_f32_16x16x32_bf16 v[24:27], a[164:167], v[180:183], v[24:27]
    v_mfma_f32_16x16x32_bf16 v[28:31], a[228:231], v[180:183], v[28:31]
    buffer_load_dwordx4 v[132:135], v234, s[40:43], s17 offen offset:256 sc1
    s_waitcnt vmcnt(11)
    v_mfma_f32_16x16x32_bf16 v[32:35], a[36:39], v[184:187], v[32:35]
    v_mfma_f32_16x16x32_bf16 v[36:39], a[100:103], v[184:187], v[36:39]
    v_mfma_f32_16x16x32_bf16 v[40:43], a[164:167], v[184:187], v[40:43]
    v_mfma_f32_16x16x32_bf16 v[44:47], a[228:231], v[184:187], v[44:47]
    buffer_load_dwordx4 v[136:139], v234, s[40:43], s18 offen sc1
    s_waitcnt vmcnt(11)
    v_mfma_f32_16x16x32_bf16 v[48:51], a[36:39], v[188:191], v[48:51]
    v_mfma_f32_16x16x32_bf16 v[52:55], a[100:103], v[188:191], v[52:55]
    v_mfma_f32_16x16x32_bf16 v[56:59], a[164:167], v[188:191], v[56:59]
    v_mfma_f32_16x16x32_bf16 v[60:63], a[228:231], v[188:191], v[60:63]
    buffer_load_dwordx4 v[140:143], v234, s[40:43], s18 offen offset:256 sc1
    s_waitcnt vmcnt(11)
    v_mfma_f32_16x16x32_bf16 v[0:3], a[40:43], v[192:195], v[0:3]
    v_mfma_f32_16x16x32_bf16 v[4:7], a[104:107], v[192:195], v[4:7]
    v_mfma_f32_16x16x32_bf16 v[8:11], a[168:171], v[192:195], v[8:11]
    v_mfma_f32_16x16x32_bf16 v[12:15], a[232:235], v[192:195], v[12:15]
    buffer_load_dwordx4 v[144:147], v242, s[40:43], s15 offen sc1
    s_waitcnt vmcnt(11)
    v_mfma_f32_16x16x32_bf16 v[16:19], a[40:43], v[196:199], v[16:19]
    v_mfma_f32_16x16x32_bf16 v[20:23], a[104:107], v[196:199], v[20:23]
    s_nop 0
    v_mul_f32 v0, v0, v230
    v_mul_f32 v1, v1, v230
    v_mfma_f32_16x16x32_bf16 v[24:27], a[168:171], v[196:199], v[24:27]
    v_mul_f32 v2, v2, v230
    v_mul_f32 v3, v3, v230
    v_mfma_f32_16x16x32_bf16 v[28:31], a[232:235], v[196:199], v[28:31]
    buffer_load_dwordx4 v[148:151], v242, s[40:43], s15 offen offset:256 sc1
    s_waitcnt vmcnt(11)
    v_mfma_f32_16x16x32_bf16 v[32:35], a[40:43], v[200:203], v[32:35]
    v_mul_f32 v4, v4, v230
    v_mul_f32 v5, v5, v230
    v_mfma_f32_16x16x32_bf16 v[36:39], a[104:107], v[200:203], v[36:39]
    v_mul_f32 v6, v6, v230
    v_mul_f32 v7, v7, v230
    v_mfma_f32_16x16x32_bf16 v[40:43], a[168:171], v[200:203], v[40:43]
    v_mul_f32 v8, v8, v230
    v_mul_f32 v9, v9, v230
    v_mfma_f32_16x16x32_bf16 v[44:47], a[232:235], v[200:203], v[44:47]
    buffer_load_dwordx4 v[152:155], v242, s[40:43], s16 offen sc1
    s_waitcnt vmcnt(11)
    v_mfma_f32_16x16x32_bf16 v[48:51], a[40:43], v[204:207], v[48:51]
    v_mul_f32 v10, v10, v230
    v_mul_f32 v11, v11, v230
    v_mfma_f32_16x16x32_bf16 v[52:55], a[104:107], v[204:207], v[52:55]
    v_mul_f32 v12, v12, v230
    v_mul_f32 v13, v13, v230
    v_mfma_f32_16x16x32_bf16 v[56:59], a[168:171], v[204:207], v[56:59]
    v_mul_f32 v14, v14, v230
    v_mul_f32 v15, v15, v230
    v_mfma_f32_16x16x32_bf16 v[60:63], a[232:235], v[204:207], v[60:63]
    buffer_load_dwordx4 v[156:159], v242, s[40:43], s16 offen offset:256 sc1
    s_waitcnt vmcnt(11)
    v_mfma_f32_16x16x32_bf16 v[64:67], a[44:47], v[208:211], 0
    v_mul_f32 v16, v16, v231
    v_mul_f32 v17, v17, v231
    v_mfma_f32_16x16x32_bf16 v[68:71], a[108:111], v[208:211], 0
    buffer_load_dwordx4 v[160:163], v242, s[40:43], s17 offen sc1
    v_mul_f32 v18, v18, v231
    v_mul_f32 v19, v19, v231
    s_waitcnt vmcnt(11)
    v_mfma_f32_16x16x32_bf16 v[80:83], a[44:47], v[212:215], 0
    v_mul_f32 v20, v20, v231
    v_mul_f32 v21, v21, v231
    v_mfma_f32_16x16x32_bf16 v[84:87], a[108:111], v[212:215], 0
    buffer_load_dwordx4 v[164:167], v242, s[40:43], s17 offen offset:256 sc1
    v_mul_f32 v22, v22, v231
    v_mul_f32 v23, v23, v231
    s_waitcnt vmcnt(11)
    v_mfma_f32_16x16x32_bf16 v[64:67], a[48:51], v[216:219], v[64:67]
    v_mul_f32 v24, v24, v231
    v_mul_f32 v25, v25, v231
    v_mfma_f32_16x16x32_bf16 v[68:71], a[112:115], v[216:219], v[68:71]
    buffer_load_dwordx4 v[168:171], v242, s[40:43], s18 offen sc1
    v_mul_f32 v26, v26, v231
    v_mul_f32 v27, v27, v231
    s_waitcnt vmcnt(11)
    v_mfma_f32_16x16x32_bf16 v[80:83], a[48:51], v[220:223], v[80:83]
    v_mul_f32 v28, v28, v231
    v_mul_f32 v29, v29, v231
    v_mfma_f32_16x16x32_bf16 v[84:87], a[112:115], v[220:223], v[84:87]
    buffer_load_dwordx4 v[172:175], v242, s[40:43], s18 offen offset:256 sc1
    v_mul_f32 v30, v30, v231
    v_mul_f32 v31, v31, v231
    s_waitcnt vmcnt(11)
    v_mfma_f32_16x16x32_bf16 v[64:67], a[52:55], v[128:131], v[64:67]
    v_mul_f32 v32, v32, v249
    v_mul_f32 v33, v33, v249
    v_mfma_f32_16x16x32_bf16 v[68:71], a[116:119], v[128:131], v[68:71]
    v_mul_f32 v34, v34, v249
    v_mul_f32 v35, v35, v249
    s_waitcnt vmcnt(10)
    v_mfma_f32_16x16x32_bf16 v[80:83], a[52:55], v[132:135], v[80:83]
    v_mul_f32 v36, v36, v249
    v_mul_f32 v37, v37, v249
    v_mfma_f32_16x16x32_bf16 v[84:87], a[116:119], v[132:135], v[84:87]
    v_mul_f32 v38, v38, v249
    v_mul_f32 v39, v39, v249
    s_waitcnt vmcnt(9)
    v_mfma_f32_16x16x32_bf16 v[64:67], a[56:59], v[136:139], v[64:67]
    v_mul_f32 v40, v40, v249
    v_mul_f32 v41, v41, v249
    v_mfma_f32_16x16x32_bf16 v[68:71], a[120:123], v[136:139], v[68:71]
    v_mul_f32 v42, v42, v249
    v_mul_f32 v43, v43, v249
    s_waitcnt vmcnt(8)
    v_mfma_f32_16x16x32_bf16 v[80:83], a[56:59], v[140:143], v[80:83]
    v_mul_f32 v44, v44, v249
    v_mul_f32 v45, v45, v249
    v_mfma_f32_16x16x32_bf16 v[84:87], a[120:123], v[140:143], v[84:87]
    v_mfma_f32_16x16x32_bf16 v[72:75], a[172:175], v[208:211], 0
    v_mul_f32 v46, v46, v249
    v_mul_f32 v47, v47, v249
    v_mfma_f32_16x16x32_bf16 v[76:79], a[236:239], v[208:211], 0
    v_mul_f32 v48, v48, v250
    v_mul_f32 v49, v49, v250
    v_mfma_f32_16x16x32_bf16 v[88:91], a[172:175], v[212:215], 0
    v_mul_f32 v50, v50, v250
    v_mul_f32 v51, v51, v250
    v_mfma_f32_16x16x32_bf16 v[92:95], a[236:239], v[212:215], 0
    v_fmac_f32 v0, v64, v228
    v_fmac_f32 v1, v65, v228
    v_mfma_f32_16x16x32_bf16 v[72:75], a[176:179], v[216:219], v[72:75]
    v_fmac_f32 v2, v66, v228
    v_fmac_f32 v3, v67, v228
    v_mfma_f32_16x16x32_bf16 v[76:79], a[240:243], v[216:219], v[76:79]
    ds_write_b128 v226, v[0:3] offset:0
    v_fmac_f32 v4, v68, v228
    v_mfma_f32_16x16x32_bf16 v[88:91], a[176:179], v[220:223], v[88:91]
    v_fmac_f32 v5, v69, v228
    v_fmac_f32 v6, v70, v228
    v_mfma_f32_16x16x32_bf16 v[92:95], a[240:243], v[220:223], v[92:95]
    v_fmac_f32 v7, v71, v228
    ds_write_b128 v227, v[4:7] offset:0
    v_mfma_f32_16x16x32_bf16 v[72:75], a[180:183], v[128:131], v[72:75]
    v_fmac_f32 v16, v80, v229
    v_fmac_f32 v17, v81, v229
    v_mfma_f32_16x16x32_bf16 v[76:79], a[244:247], v[128:131], v[76:79]
    v_fmac_f32 v18, v82, v229
    v_fmac_f32 v19, v83, v229
    v_mfma_f32_16x16x32_bf16 v[88:91], a[180:183], v[132:135], v[88:91]
    ds_write_b128 v226, v[16:19] offset:16384
    v_fmac_f32 v20, v84, v229
    v_mfma_f32_16x16x32_bf16 v[92:95], a[244:247], v[132:135], v[92:95]
    v_fmac_f32 v21, v85, v229
    v_fmac_f32 v22, v86, v229
    v_mfma_f32_16x16x32_bf16 v[72:75], a[184:187], v[136:139], v[72:75]
    v_fmac_f32 v23, v87, v229
    ds_write_b128 v227, v[20:23] offset:16384
    v_mfma_f32_16x16x32_bf16 v[76:79], a[248:251], v[136:139], v[76:79]
    v_mul_f32 v52, v52, v250
    v_mul_f32 v53, v53, v250
    v_mfma_f32_16x16x32_bf16 v[88:91], a[184:187], v[140:143], v[88:91]
    v_mul_f32 v54, v54, v250
    v_mul_f32 v55, v55, v250
    v_mfma_f32_16x16x32_bf16 v[92:95], a[248:251], v[140:143], v[92:95]
    s_waitcnt vmcnt(7)
    v_mfma_f32_16x16x32_bf16 v[96:99], a[44:47], v[144:147], 0
    v_mul_f32 v56, v56, v250
    v_mul_f32 v57, v57, v250
    v_mfma_f32_16x16x32_bf16 v[100:103], a[108:111], v[144:147], 0
    v_mul_f32 v58, v58, v250
    v_mul_f32 v59, v59, v250
    s_waitcnt vmcnt(6)
    v_mfma_f32_16x16x32_bf16 v[112:115], a[44:47], v[148:151], 0
    v_mul_f32 v60, v60, v250
    v_mul_f32 v61, v61, v250
    v_mfma_f32_16x16x32_bf16 v[116:119], a[108:111], v[148:151], 0
    v_mul_f32 v62, v62, v250
    v_mul_f32 v63, v63, v250
    s_waitcnt vmcnt(5)
    v_mfma_f32_16x16x32_bf16 v[96:99], a[48:51], v[152:155], v[96:99]
    v_fmac_f32 v8, v72, v228
    v_fmac_f32 v9, v73, v228
    v_mfma_f32_16x16x32_bf16 v[100:103], a[112:115], v[152:155], v[100:103]
    v_fmac_f32 v10, v74, v228
    v_fmac_f32 v11, v75, v228
    s_waitcnt vmcnt(4)
    v_mfma_f32_16x16x32_bf16 v[112:115], a[48:51], v[156:159], v[112:115]
    ds_write_b128 v226, v[8:11] offset:128
    v_fmac_f32 v12, v76, v228
    v_mfma_f32_16x16x32_bf16 v[116:119], a[112:115], v[156:159], v[116:119]
    v_fmac_f32 v13, v77, v228
    v_fmac_f32 v14, v78, v228
    s_waitcnt vmcnt(3)
    v_mfma_f32_16x16x32_bf16 v[96:99], a[52:55], v[160:163], v[96:99]
    v_fmac_f32 v15, v79, v228
    ds_write_b128 v227, v[12:15] offset:128
    v_mfma_f32_16x16x32_bf16 v[100:103], a[116:119], v[160:163], v[100:103]
    v_fmac_f32 v24, v88, v229
    v_fmac_f32 v25, v89, v229
    s_waitcnt vmcnt(2)
    v_mfma_f32_16x16x32_bf16 v[112:115], a[52:55], v[164:167], v[112:115]
    v_fmac_f32 v26, v90, v229
    v_fmac_f32 v27, v91, v229
    v_mfma_f32_16x16x32_bf16 v[116:119], a[116:119], v[164:167], v[116:119]
    ds_write_b128 v226, v[24:27] offset:16512
    v_fmac_f32 v28, v92, v229
    s_waitcnt vmcnt(1)
    v_mfma_f32_16x16x32_bf16 v[96:99], a[56:59], v[168:171], v[96:99]
    v_fmac_f32 v29, v93, v229
    v_fmac_f32 v30, v94, v229
    v_mfma_f32_16x16x32_bf16 v[100:103], a[120:123], v[168:171], v[100:103]
    v_fmac_f32 v31, v95, v229
    ds_write_b128 v227, v[28:31] offset:16512
    s_waitcnt vmcnt(0)
    v_mfma_f32_16x16x32_bf16 v[112:115], a[56:59], v[172:175], v[112:115]
    v_mfma_f32_16x16x32_bf16 v[116:119], a[120:123], v[172:175], v[116:119]
    v_mfma_f32_16x16x32_bf16 v[104:107], a[172:175], v[144:147], 0
    s_waitcnt lgkmcnt(0)
    s_barrier
    v_mfma_f32_16x16x32_bf16 v[108:111], a[236:239], v[144:147], 0
    ds_read_b128 v[176:179], v224 offset:0
    ds_read_b128 v[180:183], v225 offset:0
    v_mfma_f32_16x16x32_bf16 v[120:123], a[172:175], v[148:151], 0
    v_fmac_f32 v32, v96, v232
    v_fmac_f32 v33, v97, v232
    v_mfma_f32_16x16x32_bf16 v[124:127], a[236:239], v[148:151], 0
    v_fmac_f32 v34, v98, v232
    v_fmac_f32 v35, v99, v232
    v_mfma_f32_16x16x32_bf16 v[104:107], a[176:179], v[152:155], v[104:107]
    ds_write_b128 v226, v[32:35] offset:32768
    v_fmac_f32 v36, v100, v232
    v_mfma_f32_16x16x32_bf16 v[108:111], a[240:243], v[152:155], v[108:111]
    v_fmac_f32 v37, v101, v232
    v_fmac_f32 v38, v102, v232
    v_mfma_f32_16x16x32_bf16 v[120:123], a[176:179], v[156:159], v[120:123]
    v_fmac_f32 v39, v103, v232
    ds_write_b128 v227, v[36:39] offset:32768
    v_mfma_f32_16x16x32_bf16 v[124:127], a[240:243], v[156:159], v[124:127]
    ds_read_b128 v[184:187], v224 offset:4096
    ds_read_b128 v[188:191], v225 offset:4096
    v_mfma_f32_16x16x32_bf16 v[104:107], a[180:183], v[160:163], v[104:107]
    ds_read_b128 v[192:195], v224 offset:8192
    ds_read_b128 v[196:199], v225 offset:8192
    v_mfma_f32_16x16x32_bf16 v[108:111], a[244:247], v[160:163], v[108:111]
    ds_read_b128 v[200:203], v224 offset:12288
    ds_read_b128 v[204:207], v225 offset:12288
    v_mfma_f32_16x16x32_bf16 v[120:123], a[180:183], v[164:167], v[120:123]
    v_fmac_f32 v48, v112, v233
    v_fmac_f32 v49, v113, v233
    v_mfma_f32_16x16x32_bf16 v[124:127], a[244:247], v[164:167], v[124:127]
    v_fmac_f32 v50, v114, v233
    v_fmac_f32 v51, v115, v233
    v_mfma_f32_16x16x32_bf16 v[104:107], a[184:187], v[168:171], v[104:107]
    ds_write_b128 v226, v[48:51] offset:49152
    v_fmac_f32 v52, v116, v233
    v_mfma_f32_16x16x32_bf16 v[108:111], a[248:251], v[168:171], v[108:111]
    v_fmac_f32 v53, v117, v233
    v_fmac_f32 v54, v118, v233
    v_mfma_f32_16x16x32_bf16 v[120:123], a[184:187], v[172:175], v[120:123]
    v_fmac_f32 v55, v119, v233
    ds_write_b128 v227, v[52:55] offset:49152
    v_mfma_f32_16x16x32_bf16 v[124:127], a[248:251], v[172:175], v[124:127]
    s_waitcnt lgkmcnt(7)
    v_pk_add_f32 v[176:177], v[176:177], v[184:185]
    v_pk_add_f32 v[178:179], v[178:179], v[186:187]
    s_waitcnt lgkmcnt(6)
    v_pk_add_f32 v[180:181], v[180:181], v[188:189]
    v_pk_add_f32 v[182:183], v[182:183], v[190:191]
    s_waitcnt lgkmcnt(3)
    v_pk_add_f32 v[192:193], v[192:193], v[200:201]
    v_pk_add_f32 v[194:195], v[194:195], v[202:203]
    s_waitcnt lgkmcnt(2)
    v_pk_add_f32 v[196:197], v[196:197], v[204:205]
    v_pk_add_f32 v[198:199], v[198:199], v[206:207]
    v_pk_add_f32 v[176:177], v[176:177], v[192:193]
    v_pk_add_f32 v[178:179], v[178:179], v[194:195]
    v_pk_add_f32 v[180:181], v[180:181], v[196:197]
    v_pk_add_f32 v[182:183], v[182:183], v[198:199]
    v_cvt_pk_bf16_f32 v184, v176, v177
    v_cvt_pk_bf16_f32 v185, v178, v179
    v_cvt_pk_bf16_f32 v186, v180, v181
    v_cvt_pk_bf16_f32 v187, v182, v183
    buffer_store_dwordx4 v[184:187], v251, s[64:67], 0 offen sc1
    v_pk_fma_f32 v[40:41], v[104:105], v[232:233], v[40:41] op_sel:[0,0,0] op_sel_hi:[1,0,1]
    v_pk_fma_f32 v[42:43], v[106:107], v[232:233], v[42:43] op_sel:[0,0,0] op_sel_hi:[1,0,1]
    ds_write_b128 v226, v[40:43] offset:32896
    v_pk_fma_f32 v[44:45], v[108:109], v[232:233], v[44:45] op_sel:[0,0,0] op_sel_hi:[1,0,1]
    v_pk_fma_f32 v[46:47], v[110:111], v[232:233], v[46:47] op_sel:[0,0,0] op_sel_hi:[1,0,1]
    ds_write_b128 v227, v[44:47] offset:32896
    v_pk_fma_f32 v[56:57], v[120:121], v[232:233], v[56:57] op_sel:[0,1,0] op_sel_hi:[1,1,1]
    v_pk_fma_f32 v[58:59], v[122:123], v[232:233], v[58:59] op_sel:[0,1,0] op_sel_hi:[1,1,1]
    ds_write_b128 v226, v[56:59] offset:49280
    v_pk_fma_f32 v[60:61], v[124:125], v[232:233], v[60:61] op_sel:[0,1,0] op_sel_hi:[1,1,1]
    v_pk_fma_f32 v[62:63], v[126:127], v[232:233], v[62:63] op_sel:[0,1,0] op_sel_hi:[1,1,1]
    ds_write_b128 v227, v[60:63] offset:49280
    s_waitcnt lgkmcnt(0)
    s_barrier
    ds_read_b128 v[128:131], v224 offset:32768
    ds_read_b128 v[132:135], v225 offset:32768
    ds_read_b128 v[136:139], v224 offset:36864
    ds_read_b128 v[140:143], v225 offset:36864
    ds_read_b128 v[144:147], v224 offset:40960
    ds_read_b128 v[148:151], v225 offset:40960
    ds_read_b128 v[152:155], v224 offset:45056
    ds_read_b128 v[156:159], v225 offset:45056
    s_waitcnt lgkmcnt(5)
    v_pk_add_f32 v[128:129], v[128:129], v[136:137]
    v_pk_add_f32 v[130:131], v[130:131], v[138:139]
    s_waitcnt lgkmcnt(4)
    v_pk_add_f32 v[132:133], v[132:133], v[140:141]
    v_pk_add_f32 v[134:135], v[134:135], v[142:143]
    s_waitcnt lgkmcnt(1)
    v_pk_add_f32 v[144:145], v[144:145], v[152:153]
    v_pk_add_f32 v[146:147], v[146:147], v[154:155]
    s_waitcnt lgkmcnt(0)
    v_pk_add_f32 v[148:149], v[148:149], v[156:157]
    v_pk_add_f32 v[150:151], v[150:151], v[158:159]
    v_pk_add_f32 v[128:129], v[128:129], v[144:145]
    v_pk_add_f32 v[130:131], v[130:131], v[146:147]
    v_pk_add_f32 v[132:133], v[132:133], v[148:149]
    v_pk_add_f32 v[134:135], v[134:135], v[150:151]
    v_cvt_pk_bf16_f32 v136, v128, v129
    v_cvt_pk_bf16_f32 v137, v130, v131
    v_cvt_pk_bf16_f32 v138, v132, v133
    v_cvt_pk_bf16_f32 v139, v134, v135
    buffer_store_dwordx4 v[136:139], v251, s[64:67], s74 offen sc1
    s_endpgm
    .p2align 12
L_body_qg:
    s_add_u32 s22, s96, 2
    s_and_b32 s22, s22, 7
    s_mul_i32 s22, s22, 176128
    s_add_u32 s23, s96, 3
    s_and_b32 s23, s23, 7
    s_mul_i32 s23, s23, 176128
    s_add_u32 s24, s96, 4
    s_and_b32 s24, s24, 7
    s_mul_i32 s24, s24, 176128
    s_add_u32 s25, s96, 5
    s_and_b32 s25, s25, 7
    s_mul_i32 s25, s25, 176128
    s_add_u32 s26, s96, 6
    s_and_b32 s26, s26, 7
    s_mul_i32 s26, s26, 176128
    s_add_u32 s27, s96, 7
    s_and_b32 s27, s27, 7
    s_mul_i32 s27, s27, 176128
    s_add_u32 s6, s96, 2
    s_and_b32 s6, s6, 7
    s_mul_i32 s6, s6, 128
    s_add_u32 s7, s96, 3
    s_and_b32 s7, s7, 7
    s_mul_i32 s7, s7, 128
    s_add_u32 s8, s96, 4
    s_and_b32 s8, s8, 7
    s_mul_i32 s8, s8, 128
    s_add_u32 s9, s96, 5
    s_and_b32 s9, s9, 7
    s_mul_i32 s9, s9, 128
    s_add_u32 s10, s96, 6
    s_and_b32 s10, s10, 7
    s_mul_i32 s10, s10, 128
    s_add_u32 s11, s96, 7
    s_and_b32 s11, s11, 7
    s_mul_i32 s11, s11, 128
    s_lshl_b32 s101, s92, 13
    v_and_b32 v25, 15, v255
    v_lshl_add_u32 v24, v25, 7, s101
    v_lshrrev_b32 v28, 1, v25
    v_xor_b32 v27, v23, v28
    v_lshlrev_b32 v26, 4, v27
    v_add_u32 v200, v24, v26
    v_xor_b32 v201, 64, v200
    s_lshl_b32 s101, s93, 12
    v_add_u32 v200, s101, v200
    v_xor_b32 v202, 0x1000, v200
    v_add_u32 v201, s101, v201
    v_xor_b32 v203, 0x1000, v201
    v_lshrrev_b32 v32, 5, v255
    v_bfe_u32 v33, v255, 2, 2
    v_lshl_add_u32 v31, v32, 3, v33
    v_mul_u32_u24 v30, 0xe0, v31
    v_add_u32 v29, 0x4000, v30
    v_and_b32 v36, 1, v23
    v_mul_u32_u24 v35, 0x1c80, v36
    v_and_b32 v38, 3, v255
    v_lshlrev_b32 v37, 3, v38
    v_add_u32 v34, v35, v37
    v_add_u32 v188, v29, v34
    s_mul_i32 s101, s93, 96
    v_add_u32 v187, s101, v188
    s_mov_b64 s[48:49], s[62:63]
    s_mov_b64 s[52:53], s[54:55]
    s_mov_b64 s[64:65], s[66:67]
    s_mov_b32 s50, 0x158000
    s_mov_b32 s51, 0x20000
    s_mov_b32 s54, 0x80000
    s_mov_b32 s55, 0x20000
    s_mov_b32 s58, 0x15800
    s_mov_b32 s59, 0x20000
    s_mov_b32 s62, 0x15800
    s_mov_b32 s63, 0x20000
    s_mov_b32 s66, 0x10000
    s_mov_b32 s67, 0x20000
    s_mul_i32 s101, s98, 176128
    s_add_u32 s56, s40, s101
    s_addc_u32 s57, s41, 0
    s_add_u32 s60, s56, 88064
    s_addc_u32 s61, s57, 0
    s_lshl_b32 s101, s98, 16
    s_add_u32 s64, s64, s101
    s_addc_u32 s65, s65, 0
    s_lshl_b32 s101, s2, 2
    s_add_u32 s101, s101, s91
    s_mul_i32 s3, s101, 1408
    s_lshl_b32 s101, s101, 9
    v_min_u32 v39, 10, v255
    v_lshl_add_u32 v196, v39, 7, s3
    v_min_u32 v40, 3, v255
    v_lshl_add_u32 v197, v40, 7, s101
    s_mov_b64 exec, 0
    s_cmp_eq_u32 s91, 0
    s_cbranch_scc1 L_pad_qg_0
    s_cmp_eq_u32 s91, 1
    s_cbranch_scc1 L_pad_qg_1
    s_cmp_eq_u32 s91, 2
    s_cbranch_scc1 L_pad_qg_2
    s_cmp_eq_u32 s91, 3
    s_cbranch_scc1 L_pad_qg_3
L_walked_qg:
    s_mov_b64 exec, -1
    s_waitcnt vmcnt(9)
    s_barrier
    ds_read_b128 a[0:3], v200 offset:0
    ds_read_b128 a[64:67], v200 offset:2048
    ds_read_b64_tr_b16 v[144:145], v187 offset:0
    ds_read_b64_tr_b16 v[146:147], v187 offset:896
    s_add_u32 m0, s12, 49408
    s_waitcnt lgkmcnt(0)
    v_mfma_f32_16x16x32_bf16 v[0:3], v[144:147], a[0:3], 0
    ds_read_b128 a[128:131], v202 offset:0
    ds_read_b128 a[192:195], v202 offset:2048
    v_mfma_f32_16x16x32_bf16 v[4:7], v[144:147], a[64:67], 0
    buffer_load_dwordx4 v180, s[36:39], s21 offen lds
    s_lshl_b32 s101, s91, 10
    s_waitcnt lgkmcnt(1)
    v_mfma_f32_16x16x32_bf16 v[16:19], v[144:147], a[128:131], 0
    ds_read_b64_tr_b16 v[148:149], v187 offset:14464
    ds_read_b64_tr_b16 v[150:151], v187 offset:15360
    s_waitcnt lgkmcnt(2)
    v_mfma_f32_16x16x32_bf16 v[20:23], v[144:147], a[192:195], 0
    buffer_load_dwordx4 v181, s[36:39], s21 offen offset:1024 lds
    s_add_u32 s101, s101, 149504
    s_waitcnt lgkmcnt(0)
    v_mfma_f32_16x16x32_bf16 v[8:11], v[148:151], a[0:3], 0
    ds_read_b64_tr_b16 v[152:153], v187 offset:32
    ds_read_b64_tr_b16 v[154:155], v187 offset:928
    v_mfma_f32_16x16x32_bf16 v[12:15], v[148:151], a[64:67], 0
    buffer_load_dwordx4 v182, s[36:39], s21 offen offset:2048 lds
    v_lshrrev_b32 v114, 5, v255
    v_mfma_f32_16x16x32_bf16 v[24:27], v[148:151], a[128:131], 0
    ds_read_b64_tr_b16 v[156:157], v187 offset:14496
    ds_read_b64_tr_b16 v[158:159], v187 offset:15392
    v_mfma_f32_16x16x32_bf16 v[28:31], v[148:151], a[192:195], 0
    s_add_u32 m0, s97, 90624
    s_nop 0
    buffer_load_dwordx4 v226, s[28:31], s6 offen lds
    s_waitcnt lgkmcnt(2)
    v_mfma_f32_16x16x32_bf16 v[32:35], v[152:155], a[0:3], 0
    ds_read_b64_tr_b16 v[160:161], v187 offset:64
    ds_read_b64_tr_b16 v[162:163], v187 offset:960
    v_mfma_f32_16x16x32_bf16 v[36:39], v[152:155], a[64:67], 0
    buffer_load_dwordx4 v227, s[28:31], s6 offen offset:1024 lds
    v_bfe_u32 v115, v255, 2, 2
    v_mfma_f32_16x16x32_bf16 v[48:51], v[152:155], a[128:131], 0
    ds_read_b64_tr_b16 v[164:165], v187 offset:14528
    ds_read_b64_tr_b16 v[166:167], v187 offset:15424
    v_mfma_f32_16x16x32_bf16 v[52:55], v[152:155], a[192:195], 0
    buffer_load_dwordx4 v228, s[28:31], s6 offen offset:2048 lds
    v_lshl_add_u32 v113, v114, 3, v115
    s_waitcnt lgkmcnt(4)
    v_mfma_f32_16x16x32_bf16 v[40:43], v[156:159], a[0:3], 0
    ds_read_b128 v[144:147], v193 offset:0
    ds_read_b128 a[4:7], v201 offset:0
    v_mfma_f32_16x16x32_bf16 v[44:47], v[156:159], a[64:67], 0
    buffer_load_dwordx4 v229, s[28:31], s6 offen offset:3072 lds
    v_lshl_add_u32 v112, v113, 5, s101
    v_mfma_f32_16x16x32_bf16 v[56:59], v[156:159], a[128:131], 0
    ds_read_b128 a[68:71], v201 offset:2048
    ds_read_b64_tr_b16 v[148:149], v187 offset:3584
    v_mfma_f32_16x16x32_bf16 v[60:63], v[156:159], a[192:195], 0
    s_add_u32 m0, s12, 90624
    s_nop 0
    buffer_load_dwordx4 v176, s[36:39], s22 offen lds
    s_waitcnt lgkmcnt(6)
    v_mfma_f32_16x16x32_bf16 v[64:67], v[160:163], a[0:3], 0
    ds_read_b64_tr_b16 v[150:151], v187 offset:4480
    ds_read_b128 a[132:135], v203 offset:0
    v_mfma_f32_16x16x32_bf16 v[68:71], v[160:163], a[64:67], 0
    buffer_load_dwordx4 v177, s[36:39], s22 offen offset:1024 lds
    v_bfe_u32 v118, v255, 4, 1
    v_mfma_f32_16x16x32_bf16 v[80:83], v[160:163], a[128:131], 0
    ds_read_b128 a[196:199], v203 offset:2048
    ds_read_b64_tr_b16 v[152:153], v187 offset:18048
    v_mfma_f32_16x16x32_bf16 v[84:87], v[160:163], a[192:195], 0
    buffer_load_dwordx4 v178, s[36:39], s22 offen offset:2048 lds
    v_and_b32 v120, 3, v255
    s_waitcnt lgkmcnt(8)
    v_mfma_f32_16x16x32_bf16 v[72:75], v[164:167], a[0:3], 0
    ds_read_b64_tr_b16 v[154:155], v187 offset:18944
    ds_read_b64_tr_b16 v[156:157], v187 offset:3616
    v_mfma_f32_16x16x32_bf16 v[76:79], v[164:167], a[64:67], 0
    buffer_load_dwordx4 v179, s[36:39], s22 offen offset:3072 lds
    v_lshrrev_b32 v119, 1, v120
    v_mfma_f32_16x16x32_bf16 v[88:91], v[164:167], a[128:131], 0
    ds_read_b64_tr_b16 v[158:159], v187 offset:4512
    ds_read_b64_tr_b16 v[160:161], v187 offset:18080
    v_mfma_f32_16x16x32_bf16 v[92:95], v[164:167], a[192:195], 0
    s_add_u32 m0, s12, 94720
    s_nop 0
    buffer_load_dwordx4 v180, s[36:39], s22 offen lds
    s_waitcnt lgkmcnt(8)
    v_mfma_f32_16x16x32_bf16 v[96:99], v[144:147], a[0:3], 0
    ds_read_b64_tr_b16 v[162:163], v187 offset:18976
    ds_read_b64_tr_b16 v[164:165], v187 offset:3648
    v_mfma_f32_16x16x32_bf16 v[100:103], v[144:147], a[64:67], 0
    buffer_load_dwordx4 v181, s[36:39], s22 offen offset:1024 lds
    v_lshl_add_u32 v117, v118, 1, v119
    s_waitcnt lgkmcnt(8)
    v_mfma_f32_16x16x32_bf16 v[0:3], v[148:151], a[4:7], v[0:3]
    ds_read_b64_tr_b16 v[166:167], v187 offset:4544
    ds_read_b64_tr_b16 v[144:145], v187 offset:18112
    v_mfma_f32_16x16x32_bf16 v[4:7], v[148:151], a[68:71], v[4:7]
    buffer_load_dwordx4 v182, s[36:39], s22 offen offset:2048 lds
    v_lshlrev_b32 v116, 3, v117
    v_mfma_f32_16x16x32_bf16 v[16:19], v[148:151], a[132:135], v[16:19]
    ds_read_b64_tr_b16 v[146:147], v187 offset:19008
    s_waitcnt lgkmcnt(8)
    v_mfma_f32_16x16x32_bf16 v[20:23], v[148:151], a[196:199], v[20:23]
    ds_read_b128 v[148:151], v193 offset:64
    v_add_u32 v194, v112, v116
    v_bfe_u32 v121, v255, 2, 1
    v_mfma_f32_16x16x32_bf16 v[8:11], v[152:155], a[4:7], v[8:11]
    v_add_u32 v200, 0xb100, v200
    v_add_u32 v201, 0xb100, v201
    v_mfma_f32_16x16x32_bf16 v[12:15], v[152:155], a[68:71], v[12:15]
    v_add_u32 v202, 0xb100, v202
    v_lshlrev_b32 v195, 15, v121
    v_mfma_f32_16x16x32_bf16 v[24:27], v[152:155], a[132:135], v[24:27]
    v_add_u32 v203, 0xb100, v203
    v_add_u32 v187, 0xb100, v187
    v_mfma_f32_16x16x32_bf16 v[28:31], v[152:155], a[196:199], v[28:31]
    v_add_u32 v188, 0xb100, v188
    v_lshl_or_b32 v195, v195, 16, v195
    s_waitcnt lgkmcnt(4)
    v_mfma_f32_16x16x32_bf16 v[32:35], v[156:159], a[4:7], v[32:35]
    s_mov_b32 s72, 0x3fb8aa3b
    s_lshl_b32 s101, s95, 7
    v_mfma_f32_16x16x32_bf16 v[36:39], v[156:159], a[68:71], v[36:39]
    v_lshrrev_b32 v124, 3, v255
    v_mul_u32_u24 v123, 0xc00, v124
    v_mfma_f32_16x16x32_bf16 v[48:51], v[156:159], a[132:135], v[48:51]
    v_add_u32 v122, s101, v123
    v_and_b32 v128, 7, v255
    v_mfma_f32_16x16x32_bf16 v[52:55], v[156:159], a[196:199], v[52:55]
    v_lshrrev_b32 v127, 1, v128
    v_xor_b32 v126, v127, v118
    v_mfma_f32_16x16x32_bf16 v[40:43], v[160:163], a[4:7], v[40:43]
    v_and_b32 v130, 1, v255
    v_lshlrev_b32 v129, 4, v130
    v_mfma_f32_16x16x32_bf16 v[44:47], v[160:163], a[68:71], v[44:47]
    v_lshl_add_u32 v125, v126, 5, v129
    v_add_u32 v183, v122, v125
    v_mfma_f32_16x16x32_bf16 v[56:59], v[160:163], a[132:135], v[56:59]
    v_add_u32 v132, 0x5c00, v123
    v_add_u32 v131, s101, v132
    v_mfma_f32_16x16x32_bf16 v[60:63], v[160:163], a[196:199], v[60:63]
    v_xor_b32 v134, 2, v126
    v_lshl_add_u32 v133, v134, 5, v129
    s_waitcnt lgkmcnt(0)
    v_mfma_f32_16x16x32_bf16 v[64:67], v[164:167], a[4:7], v[64:67]
    v_add_u32 v184, v131, v133
    v_add_u32 v136, 0xb800, v123
    v_mfma_f32_16x16x32_bf16 v[68:71], v[164:167], a[68:71], v[68:71]
    v_add_u32 v135, s101, v136
    v_add_u32 v185, v135, v125
    v_mfma_f32_16x16x32_bf16 v[80:83], v[164:167], a[132:135], v[80:83]
    v_add_u32 v138, 0x11400, v123
    v_add_u32 v137, s101, v138
    v_mfma_f32_16x16x32_bf16 v[84:87], v[164:167], a[196:199], v[84:87]
    v_add_u32 v186, v137, v133
    s_lshl_b32 s101, s93, 1
    v_mfma_f32_16x16x32_bf16 v[72:75], v[144:147], a[4:7], v[72:75]
    v_mfma_f32_16x16x32_bf16 v[76:79], v[144:147], a[68:71], v[76:79]
    s_waitcnt vmcnt(11)
    s_barrier
    ds_read_b128 a[8:11], v200 offset:0
    ds_read_b128 a[72:75], v200 offset:2048
    v_mfma_f32_16x16x32_bf16 v[88:91], v[144:147], a[132:135], v[88:91]
    ds_read_b64_tr_b16 v[152:153], v187 offset:0
    ds_read_b64_tr_b16 v[154:155], v187 offset:896
    v_mfma_f32_16x16x32_bf16 v[92:95], v[144:147], a[196:199], v[92:95]
    s_add_u32 m0, s97, 0
    s_nop 0
    buffer_load_dwordx4 v226, s[28:31], s7 offen lds
    v_mfma_f32_16x16x32_bf16 v[96:99], v[148:151], a[4:7], v[96:99]
    ds_read_b128 a[136:139], v202 offset:0
    ds_read_b128 a[200:203], v202 offset:2048
    v_mfma_f32_16x16x32_bf16 v[100:103], v[148:151], a[68:71], v[100:103]
    v_lshrrev_b32 v141, 4, v255
    v_lshl_add_u32 v140, v141, 3, v115
    s_waitcnt lgkmcnt(2)
    v_mfma_f32_16x16x32_bf16 v[0:3], v[152:155], a[8:11], v[0:3]
    ds_read_b64_tr_b16 v[156:157], v187 offset:14464
    ds_read_b64_tr_b16 v[158:159], v187 offset:15360
    v_mfma_f32_16x16x32_bf16 v[4:7], v[152:155], a[72:75], v[4:7]
    buffer_load_dwordx4 v227, s[28:31], s7 offen offset:1024 lds
    v_lshlrev_b32 v142, 3, v120
    s_waitcnt lgkmcnt(3)
    v_mfma_f32_16x16x32_bf16 v[16:19], v[152:155], a[136:139], v[16:19]
    ds_read_b64_tr_b16 v[160:161], v187 offset:32
    ds_read_b64_tr_b16 v[162:163], v187 offset:928
    s_waitcnt lgkmcnt(4)
    v_mfma_f32_16x16x32_bf16 v[20:23], v[152:155], a[200:203], v[20:23]
    v_lshl_add_u32 v139, v140, 7, v142
    v_lshrrev_b32 v210, 1, v115
    s_waitcnt lgkmcnt(2)
    v_mfma_f32_16x16x32_bf16 v[8:11], v[156:159], a[8:11], v[8:11]
    ds_read_b64_tr_b16 v[164:165], v187 offset:14496
    ds_read_b64_tr_b16 v[166:167], v187 offset:15392
    v_mfma_f32_16x16x32_bf16 v[12:15], v[156:159], a[72:75], v[12:15]
    buffer_load_dwordx4 v228, s[28:31], s7 offen offset:2048 lds
    v_lshl_add_u32 v209, v118, 1, v210
    v_mfma_f32_16x16x32_bf16 v[24:27], v[156:159], a[136:139], v[24:27]
    ds_read_b64_tr_b16 v[144:145], v187 offset:64
    ds_read_b64_tr_b16 v[146:147], v187 offset:960
    v_mfma_f32_16x16x32_bf16 v[28:31], v[156:159], a[200:203], v[28:31]
    v_xor_b32 v208, s101, v209
    v_lshlrev_b32 v143, 5, v208
    s_waitcnt lgkmcnt(4)
    v_mfma_f32_16x16x32_bf16 v[32:35], v[160:163], a[8:11], v[32:35]
    ds_read_b64_tr_b16 v[148:149], v187 offset:14528
    ds_read_b64_tr_b16 v[150:151], v187 offset:15424
    v_mfma_f32_16x16x32_bf16 v[36:39], v[160:163], a[72:75], v[36:39]
    buffer_load_dwordx4 v229, s[28:31], s7 offen offset:3072 lds
    v_add_u32 v191, v139, v143
    v_mfma_f32_16x16x32_bf16 v[48:51], v[160:163], a[136:139], v[48:51]
    ds_read_b128 v[152:155], v193 offset:128
    ds_read_b128 a[12:15], v201 offset:0
    v_mfma_f32_16x16x32_bf16 v[52:55], v[160:163], a[200:203], v[52:55]
    v_xor_b32 v192, 32, v191
    v_add_u32 v189, 98304, v191
    s_waitcnt lgkmcnt(6)
    v_mfma_f32_16x16x32_bf16 v[40:43], v[164:167], a[8:11], v[40:43]
    ds_read_b128 a[76:79], v201 offset:2048
    ds_read_b64_tr_b16 v[156:157], v187 offset:3584
    v_mfma_f32_16x16x32_bf16 v[44:47], v[164:167], a[72:75], v[44:47]
    s_add_u32 m0, s12, 0
    v_add_u32 v190, 98304, v192
    v_mfma_f32_16x16x32_bf16 v[56:59], v[164:167], a[136:139], v[56:59]
    ds_read_b64_tr_b16 v[158:159], v187 offset:4480
    ds_read_b128 a[140:143], v203 offset:0
    v_mfma_f32_16x16x32_bf16 v[60:63], v[164:167], a[200:203], v[60:63]
    buffer_load_dwordx4 v176, s[36:39], s23 offen lds
    s_lshl_b32 s14, s91, 13
    s_waitcnt lgkmcnt(8)
    v_mfma_f32_16x16x32_bf16 v[64:67], v[144:147], a[8:11], v[64:67]
    ds_read_b128 a[204:207], v203 offset:2048
    ds_read_b64_tr_b16 v[160:161], v187 offset:18048
    v_mfma_f32_16x16x32_bf16 v[68:71], v[144:147], a[72:75], v[68:71]
    s_add_u32 s71, s96, s91
    s_add_u32 s73, s71, 4
    v_mfma_f32_16x16x32_bf16 v[80:83], v[144:147], a[136:139], v[80:83]
    ds_read_b64_tr_b16 v[162:163], v187 offset:18944
    ds_read_b64_tr_b16 v[164:165], v187 offset:3616
    v_mfma_f32_16x16x32_bf16 v[84:87], v[144:147], a[200:203], v[84:87]
    buffer_load_dwordx4 v177, s[36:39], s23 offen offset:1024 lds
    s_and_b32 s71, s71, 7
    s_waitcnt lgkmcnt(8)
    v_mfma_f32_16x16x32_bf16 v[72:75], v[148:151], a[8:11], v[72:75]
    ds_read_b64_tr_b16 v[166:167], v187 offset:4512
    ds_read_b64_tr_b16 v[144:145], v187 offset:18080
    v_mfma_f32_16x16x32_bf16 v[76:79], v[148:151], a[72:75], v[76:79]
    s_and_b32 s73, s73, 7
    s_mul_i32 s71, s71, 196608
    v_mfma_f32_16x16x32_bf16 v[88:91], v[148:151], a[136:139], v[88:91]
    ds_read_b64_tr_b16 v[146:147], v187 offset:18976
    v_mfma_f32_16x16x32_bf16 v[92:95], v[148:151], a[200:203], v[92:95]
    ds_read_b64_tr_b16 v[148:149], v187 offset:3648
    buffer_load_dwordx4 v178, s[36:39], s23 offen offset:2048 lds
    s_mul_i32 s73, s73, 196608
    v_mfma_f32_16x16x32_bf16 v[96:99], v[152:155], a[8:11], v[96:99]
    ds_read_b64_tr_b16 v[150:151], v187 offset:4544
    v_mfma_f32_16x16x32_bf16 v[100:103], v[152:155], a[72:75], v[100:103]
    ds_read_b64_tr_b16 v[152:153], v187 offset:18112
    s_mul_i32 s101, s91, 1536
    s_add_u32 s101, s101, 157696
    s_waitcnt lgkmcnt(8)
    v_mfma_f32_16x16x32_bf16 v[0:3], v[156:159], a[12:15], v[0:3]
    ds_read_b64_tr_b16 v[154:155], v187 offset:19008
    v_lshl_add_u32 v230, v255, 3, s101
    v_mfma_f32_16x16x32_bf16 v[4:7], v[156:159], a[76:79], v[4:7]
    s_mul_i32 s101, s93, 3072
    s_add_u32 s101, s101, 157696
    v_mfma_f32_16x16x32_bf16 v[16:19], v[156:159], a[140:143], v[16:19]
    v_mfma_f32_16x16x32_bf16 v[20:23], v[156:159], a[204:207], v[20:23]
    ds_read_b128 v[156:159], v193 offset:192
    buffer_load_dwordx4 v179, s[36:39], s23 offen offset:3072 lds
    v_and_b32 v216, 31, v255
    v_and_b32 v215, 19, v216
    s_waitcnt lgkmcnt(6)
    v_mfma_f32_16x16x32_bf16 v[8:11], v[160:163], a[12:15], v[8:11]
    v_add_u32 v200, 0xb100, v200
    v_add_u32 v201, 0xb100, v201
    v_mfma_f32_16x16x32_bf16 v[12:15], v[160:163], a[76:79], v[12:15]
    v_add_u32 v202, 0xb100, v202
    s_add_u32 m0, s12, 4096
    v_mfma_f32_16x16x32_bf16 v[24:27], v[160:163], a[140:143], v[24:27]
    v_add_u32 v203, 0xb100, v203
    v_add_u32 v187, 0xb100, v187
    v_mfma_f32_16x16x32_bf16 v[28:31], v[160:163], a[204:207], v[28:31]
    v_add_u32 v188, 0xb100, v188
    buffer_load_dwordx4 v180, s[36:39], s23 offen lds
    v_mfma_f32_16x16x32_bf16 v[32:35], v[164:167], a[12:15], v[32:35]
    v_and_b32 v218, 4, v216
    v_lshlrev_b32 v217, 1, v218
    v_mfma_f32_16x16x32_bf16 v[36:39], v[164:167], a[76:79], v[36:39]
    v_add_u32 v214, v215, v217
    v_lshrrev_b32 v220, 1, v216
    v_mfma_f32_16x16x32_bf16 v[48:51], v[164:167], a[140:143], v[48:51]
    buffer_load_dwordx4 v181, s[36:39], s23 offen offset:1024 lds
    v_and_b32 v219, 4, v220
    v_mfma_f32_16x16x32_bf16 v[52:55], v[164:167], a[204:207], v[52:55]
    v_add_u32 v213, v214, v219
    v_min_u32 v212, 16, v213
    s_waitcnt lgkmcnt(0)
    v_mfma_f32_16x16x32_bf16 v[40:43], v[144:147], a[12:15], v[40:43]
    v_lshl_add_u32 v211, v212, 6, s101
    v_lshlrev_b32 v221, 5, v114
    v_mfma_f32_16x16x32_bf16 v[44:47], v[144:147], a[76:79], v[44:47]
    v_add_u32 v231, v211, v221
    s_lshl_b32 s101, s94, 2
    v_mfma_f32_16x16x32_bf16 v[56:59], v[144:147], a[140:143], v[56:59]
    s_lshl_b32 s3, s92, 1
    s_add_u32 s101, s101, s3
    v_mfma_f32_16x16x32_bf16 v[60:63], v[144:147], a[204:207], v[60:63]
    s_add_u32 s101, s101, s93
    s_xor_b32 s87, s101, 1
    v_mfma_f32_16x16x32_bf16 v[64:67], v[148:151], a[12:15], v[64:67]
    buffer_load_dwordx4 v182, s[36:39], s23 offen offset:2048 lds
    s_mul_i32 s86, s101, 88064
    v_mfma_f32_16x16x32_bf16 v[68:71], v[148:151], a[76:79], v[68:71]
    s_mul_i32 s87, s87, 88064
    s_lshl_b32 s3, s13, 10
    v_mfma_f32_16x16x32_bf16 v[80:83], v[148:151], a[140:143], v[80:83]
    s_add_u32 s86, s86, s3
    s_add_u32 s87, s87, s3
    v_mfma_f32_16x16x32_bf16 v[84:87], v[148:151], a[204:207], v[84:87]
    s_mul_i32 s3, s93, 3072
    s_add_u32 s68, s86, s3
    v_mfma_f32_16x16x32_bf16 v[72:75], v[152:155], a[12:15], v[72:75]
    v_mfma_f32_16x16x32_bf16 v[76:79], v[152:155], a[76:79], v[76:79]
    s_waitcnt vmcnt(11)
    s_barrier
    ds_read_b64_tr_b16 v[168:169], v194 offset:0
    ds_read_b64_tr_b16 v[170:171], v194 offset:128
    ds_read_b64_tr_b16 v[172:173], v194 offset:512
    ds_read_b64_tr_b16 v[174:175], v194 offset:640
    ds_read_b128 a[16:19], v200 offset:0
    ds_read_b128 a[80:83], v200 offset:2048
    v_mfma_f32_16x16x32_bf16 v[88:91], v[152:155], a[140:143], v[88:91]
    ds_read_b64_tr_b16 v[160:161], v187 offset:0
    ds_read_b64_tr_b16 v[162:163], v187 offset:896
    v_mfma_f32_16x16x32_bf16 v[92:95], v[152:155], a[204:207], v[92:95]
    s_add_u32 m0, s97, 45312
    s_nop 0
    buffer_load_dwordx4 v226, s[28:31], s8 offen lds
    v_mfma_f32_16x16x32_bf16 v[96:99], v[156:159], a[12:15], v[96:99]
    ds_read_b128 a[144:147], v202 offset:0
    ds_read_b128 a[208:211], v202 offset:2048
    v_mfma_f32_16x16x32_bf16 v[100:103], v[156:159], a[76:79], v[100:103]
    s_add_u32 s69, s87, s3
    s_add_u32 s70, s86, 6144
    s_waitcnt lgkmcnt(2)
    v_mfma_f32_16x16x32_bf16 v[0:3], v[160:163], a[16:19], v[0:3]
    ds_read_b64_tr_b16 v[164:165], v187 offset:14464
    ds_read_b64_tr_b16 v[166:167], v187 offset:15360
    v_mfma_f32_16x16x32_bf16 v[4:7], v[160:163], a[80:83], v[4:7]
    buffer_load_dwordx4 v227, s[28:31], s8 offen offset:1024 lds
    s_lshl_b32 s101, s101, 7
    s_waitcnt lgkmcnt(3)
    v_mfma_f32_16x16x32_bf16 v[16:19], v[160:163], a[144:147], v[16:19]
    ds_read_b64_tr_b16 v[144:145], v187 offset:32
    ds_read_b64_tr_b16 v[146:147], v187 offset:928
    s_waitcnt lgkmcnt(4)
    v_mfma_f32_16x16x32_bf16 v[20:23], v[160:163], a[208:211], v[20:23]
    s_add_u32 s70, s101, 7733248
    s_lshl_b32 s101, s94, 1
    s_waitcnt lgkmcnt(2)
    v_mfma_f32_16x16x32_bf16 v[8:11], v[164:167], a[16:19], v[8:11]
    ds_read_b64_tr_b16 v[148:149], v187 offset:14496
    ds_read_b64_tr_b16 v[150:151], v187 offset:15392
    v_mfma_f32_16x16x32_bf16 v[12:15], v[164:167], a[80:83], v[12:15]
    buffer_load_dwordx4 v228, s[28:31], s8 offen offset:2048 lds
    s_add_u32 s101, s101, s92
    v_mfma_f32_16x16x32_bf16 v[24:27], v[164:167], a[144:147], v[24:27]
    ds_read_b64_tr_b16 v[152:153], v187 offset:64
    ds_read_b64_tr_b16 v[154:155], v187 offset:960
    v_mfma_f32_16x16x32_bf16 v[28:31], v[164:167], a[208:211], v[28:31]
    s_lshl_b32 s101, s101, 12
    s_lshl_b32 s3, s95, 8
    s_waitcnt lgkmcnt(4)
    v_mfma_f32_16x16x32_bf16 v[32:35], v[144:147], a[16:19], v[32:35]
    ds_read_b64_tr_b16 v[156:157], v187 offset:14528
    ds_read_b64_tr_b16 v[158:159], v187 offset:15424
    v_mfma_f32_16x16x32_bf16 v[36:39], v[144:147], a[80:83], v[36:39]
    buffer_load_dwordx4 v229, s[28:31], s8 offen offset:3072 lds
    s_add_u32 s101, s101, s3
    v_mfma_f32_16x16x32_bf16 v[48:51], v[144:147], a[144:147], v[48:51]
    ds_read_b128 v[160:163], v193 offset:256
    ds_read_b128 a[20:23], v201 offset:0
    v_mfma_f32_16x16x32_bf16 v[52:55], v[144:147], a[208:211], v[52:55]
    s_lshl_b32 s3, s93, 7
    s_add_u32 s101, s101, s3
    s_waitcnt lgkmcnt(6)
    v_mfma_f32_16x16x32_bf16 v[40:43], v[148:151], a[16:19], v[40:43]
    ds_read_b128 a[84:87], v201 offset:2048
    ds_read_b64_tr_b16 v[164:165], v187 offset:3584
    v_mfma_f32_16x16x32_bf16 v[44:47], v[148:151], a[80:83], v[44:47]
    s_add_u32 m0, s12, 45312
    s_add_u32 s75, s101, 7817216
    v_mfma_f32_16x16x32_bf16 v[56:59], v[148:151], a[144:147], v[56:59]
    ds_read_b64_tr_b16 v[166:167], v187 offset:4480
    ds_read_b128 a[148:151], v203 offset:0
    v_mfma_f32_16x16x32_bf16 v[60:63], v[148:151], a[208:211], v[60:63]
    buffer_load_dwordx4 v176, s[36:39], s24 offen lds
    s_mul_i32 s101, s99, 7
    s_waitcnt lgkmcnt(8)
    v_mfma_f32_16x16x32_bf16 v[64:67], v[152:155], a[16:19], v[64:67]
    ds_read_b128 a[212:215], v203 offset:2048
    ds_read_b64_tr_b16 v[144:145], v187 offset:18048
    v_mfma_f32_16x16x32_bf16 v[68:71], v[152:155], a[80:83], v[68:71]
    s_lshr_b32 s101, s101, 3
    s_mul_i32 s3, s100, 7
    v_mfma_f32_16x16x32_bf16 v[80:83], v[152:155], a[144:147], v[80:83]
    ds_read_b64_tr_b16 v[146:147], v187 offset:18944
    ds_read_b64_tr_b16 v[148:149], v187 offset:3616
    v_mfma_f32_16x16x32_bf16 v[84:87], v[152:155], a[208:211], v[84:87]
    buffer_load_dwordx4 v177, s[36:39], s24 offen offset:1024 lds
    s_lshr_b32 s3, s3, 2
    s_waitcnt lgkmcnt(8)
    v_mfma_f32_16x16x32_bf16 v[72:75], v[156:159], a[16:19], v[72:75]
    ds_read_b64_tr_b16 v[150:151], v187 offset:4512
    ds_read_b64_tr_b16 v[152:153], v187 offset:18080
    v_mfma_f32_16x16x32_bf16 v[76:79], v[156:159], a[80:83], v[76:79]
    s_add_u32 s90, s101, s3
    s_sub_u32 s101, s90, 7
    v_mfma_f32_16x16x32_bf16 v[88:91], v[156:159], a[144:147], v[88:91]
    ds_read_b64_tr_b16 v[154:155], v187 offset:18976
    v_mfma_f32_16x16x32_bf16 v[92:95], v[156:159], a[208:211], v[92:95]
    ds_read_b64_tr_b16 v[156:157], v187 offset:3648
    buffer_load_dwordx4 v178, s[36:39], s24 offen offset:2048 lds
    s_min_u32 s90, s90, s101
    v_mfma_f32_16x16x32_bf16 v[96:99], v[160:163], a[16:19], v[96:99]
    ds_read_b64_tr_b16 v[158:159], v187 offset:4544
    v_mfma_f32_16x16x32_bf16 v[100:103], v[160:163], a[80:83], v[100:103]
    ds_read_b64_tr_b16 v[160:161], v187 offset:18112
    s_mul_i32 s3, s91, 7
    s_add_u32 s3, s3, 16
    s_waitcnt lgkmcnt(8)
    v_mfma_f32_16x16x32_bf16 v[0:3], v[164:167], a[20:23], v[0:3]
    ds_read_b64_tr_b16 v[162:163], v187 offset:19008
    s_add_u32 s76, s90, 0
    v_mfma_f32_16x16x32_bf16 v[4:7], v[164:167], a[84:87], v[4:7]
    s_sub_u32 s101, s76, 7
    s_min_u32 s76, s76, s101
    v_mfma_f32_16x16x32_bf16 v[16:19], v[164:167], a[148:151], v[16:19]
    v_mfma_f32_16x16x32_bf16 v[20:23], v[164:167], a[212:215], v[20:23]
    ds_read_b128 v[164:167], v193 offset:320
    buffer_load_dwordx4 v179, s[36:39], s24 offen offset:3072 lds
    s_add_u32 s76, s76, s3
    s_lshl_b32 s76, s76, 15
    s_waitcnt lgkmcnt(6)
    v_mfma_f32_16x16x32_bf16 v[8:11], v[144:147], a[20:23], v[8:11]
    v_add_u32 v200, 0xfffe9e00, v200
    v_add_u32 v201, 0xfffe9e00, v201
    v_mfma_f32_16x16x32_bf16 v[12:15], v[144:147], a[84:87], v[12:15]
    v_add_u32 v202, 0xfffe9e00, v202
    s_add_u32 m0, s12, 49408
    v_mfma_f32_16x16x32_bf16 v[24:27], v[144:147], a[148:151], v[24:27]
    v_add_u32 v203, 0xfffe9e00, v203
    v_add_u32 v187, 0xfffe9e00, v187
    v_mfma_f32_16x16x32_bf16 v[28:31], v[144:147], a[212:215], v[28:31]
    v_add_u32 v188, 0xfffe9e00, v188
    buffer_load_dwordx4 v180, s[36:39], s24 offen lds
    v_mfma_f32_16x16x32_bf16 v[32:35], v[148:151], a[20:23], v[32:35]
    s_add_u32 s77, s90, 1
    s_sub_u32 s101, s77, 7
    v_mfma_f32_16x16x32_bf16 v[36:39], v[148:151], a[84:87], v[36:39]
    s_min_u32 s77, s77, s101
    s_add_u32 s77, s77, s3
    v_mfma_f32_16x16x32_bf16 v[48:51], v[148:151], a[148:151], v[48:51]
    buffer_load_dwordx4 v181, s[36:39], s24 offen offset:1024 lds
    s_lshl_b32 s77, s77, 15
    v_mfma_f32_16x16x32_bf16 v[52:55], v[148:151], a[212:215], v[52:55]
    s_add_u32 s78, s90, 2
    s_sub_u32 s101, s78, 7
    s_waitcnt lgkmcnt(0)
    v_mfma_f32_16x16x32_bf16 v[40:43], v[152:155], a[20:23], v[40:43]
    s_min_u32 s78, s78, s101
    s_add_u32 s78, s78, s3
    v_mfma_f32_16x16x32_bf16 v[44:47], v[152:155], a[84:87], v[44:47]
    s_lshl_b32 s78, s78, 15
    s_add_u32 s79, s90, 3
    v_mfma_f32_16x16x32_bf16 v[56:59], v[152:155], a[148:151], v[56:59]
    s_sub_u32 s101, s79, 7
    s_min_u32 s79, s79, s101
    v_mfma_f32_16x16x32_bf16 v[60:63], v[152:155], a[212:215], v[60:63]
    s_add_u32 s79, s79, s3
    s_lshl_b32 s79, s79, 15
    v_mfma_f32_16x16x32_bf16 v[64:67], v[156:159], a[20:23], v[64:67]
    buffer_load_dwordx4 v182, s[36:39], s24 offen offset:2048 lds
    s_add_u32 s80, s90, 4
    v_mfma_f32_16x16x32_bf16 v[68:71], v[156:159], a[84:87], v[68:71]
    s_sub_u32 s101, s80, 7
    s_min_u32 s80, s80, s101
    v_mfma_f32_16x16x32_bf16 v[80:83], v[156:159], a[148:151], v[80:83]
    s_add_u32 s80, s80, s3
    s_lshl_b32 s80, s80, 15
    v_mfma_f32_16x16x32_bf16 v[84:87], v[156:159], a[212:215], v[84:87]
    s_add_u32 s81, s90, 5
    s_sub_u32 s101, s81, 7
    v_mfma_f32_16x16x32_bf16 v[72:75], v[160:163], a[20:23], v[72:75]
    v_mfma_f32_16x16x32_bf16 v[76:79], v[160:163], a[84:87], v[76:79]
    s_waitcnt vmcnt(11)
    s_barrier
    buffer_load_dword v196, v196, s[48:51], 0 offen
    buffer_load_dword v197, v197, s[52:55], 0 offen
    ds_read_b128 a[24:27], v200 offset:0
    ds_read_b128 a[88:91], v200 offset:2048
    v_mfma_f32_16x16x32_bf16 v[88:91], v[160:163], a[148:151], v[88:91]
    ds_read_b64_tr_b16 v[144:145], v187 offset:0
    ds_read_b64_tr_b16 v[146:147], v187 offset:896
    v_mfma_f32_16x16x32_bf16 v[92:95], v[160:163], a[212:215], v[92:95]
    s_add_u32 m0, s97, 90624
    s_nop 0
    buffer_load_dwordx4 v226, s[28:31], s9 offen lds
    v_mfma_f32_16x16x32_bf16 v[96:99], v[164:167], a[20:23], v[96:99]
    ds_read_b128 a[152:155], v202 offset:0
    ds_read_b128 a[216:219], v202 offset:2048
    v_mfma_f32_16x16x32_bf16 v[100:103], v[164:167], a[84:87], v[100:103]
L_pad_qg_0:
    s_cbranch_execz L_walked_qg
    s_min_u32 s81, s81, s101
    s_add_u32 s81, s81, s3
    s_waitcnt lgkmcnt(2)
    v_mfma_f32_16x16x32_bf16 v[0:3], v[144:147], a[24:27], v[0:3]
    ds_read_b64_tr_b16 v[148:149], v187 offset:14464
    ds_read_b64_tr_b16 v[150:151], v187 offset:15360
    v_mfma_f32_16x16x32_bf16 v[4:7], v[144:147], a[88:91], v[4:7]
    buffer_load_dwordx4 v227, s[28:31], s9 offen offset:1024 lds
    s_lshl_b32 s81, s81, 15
    s_waitcnt lgkmcnt(3)
    v_mfma_f32_16x16x32_bf16 v[16:19], v[144:147], a[152:155], v[16:19]
    ds_read_b64_tr_b16 v[152:153], v187 offset:32
    ds_read_b64_tr_b16 v[154:155], v187 offset:928
    s_waitcnt lgkmcnt(4)
    v_mfma_f32_16x16x32_bf16 v[20:23], v[144:147], a[216:219], v[20:23]
    s_add_u32 s82, s90, 6
    s_sub_u32 s101, s82, 7
    s_waitcnt lgkmcnt(2)
    v_mfma_f32_16x16x32_bf16 v[8:11], v[148:151], a[24:27], v[8:11]
    ds_read_b64_tr_b16 v[156:157], v187 offset:14496
    ds_read_b64_tr_b16 v[158:159], v187 offset:15392
    v_mfma_f32_16x16x32_bf16 v[12:15], v[148:151], a[88:91], v[12:15]
    buffer_load_dwordx4 v228, s[28:31], s9 offen offset:2048 lds
    s_min_u32 s82, s82, s101
    v_mfma_f32_16x16x32_bf16 v[24:27], v[148:151], a[152:155], v[24:27]
    ds_read_b64_tr_b16 v[160:161], v187 offset:64
    ds_read_b64_tr_b16 v[162:163], v187 offset:960
    v_mfma_f32_16x16x32_bf16 v[28:31], v[148:151], a[216:219], v[28:31]
    s_add_u32 s82, s82, s3
    s_lshl_b32 s82, s82, 15
    s_waitcnt lgkmcnt(4)
    v_mfma_f32_16x16x32_bf16 v[32:35], v[152:155], a[24:27], v[32:35]
    ds_read_b64_tr_b16 v[164:165], v187 offset:14528
    ds_read_b64_tr_b16 v[166:167], v187 offset:15424
    v_mfma_f32_16x16x32_bf16 v[36:39], v[152:155], a[88:91], v[36:39]
    buffer_load_dwordx4 v229, s[28:31], s9 offen offset:3072 lds
    s_lshr_b32 s101, s99, 1
    v_mfma_f32_16x16x32_bf16 v[48:51], v[152:155], a[152:155], v[48:51]
    ds_read_b128 v[144:147], v193 offset:384
    ds_read_b128 a[28:31], v201 offset:0
    v_mfma_f32_16x16x32_bf16 v[52:55], v[152:155], a[216:219], v[52:55]
    s_add_u32 s101, s101, s100
    s_lshl_b32 s3, s91, 2
    s_waitcnt lgkmcnt(6)
    v_mfma_f32_16x16x32_bf16 v[40:43], v[156:159], a[24:27], v[40:43]
    ds_read_b128 a[92:95], v201 offset:2048
    ds_read_b64_tr_b16 v[148:149], v187 offset:3584
    v_mfma_f32_16x16x32_bf16 v[44:47], v[156:159], a[88:91], v[44:47]
    s_add_u32 m0, s12, 90624
    s_add_u32 s87, s101, 0
    v_mfma_f32_16x16x32_bf16 v[56:59], v[156:159], a[152:155], v[56:59]
    ds_read_b64_tr_b16 v[150:151], v187 offset:4480
    ds_read_b128 a[156:159], v203 offset:0
    v_mfma_f32_16x16x32_bf16 v[60:63], v[156:159], a[216:219], v[60:63]
    buffer_load_dwordx4 v176, s[36:39], s25 offen lds
    s_and_b32 s87, s87, 3
    s_waitcnt lgkmcnt(8)
    v_mfma_f32_16x16x32_bf16 v[64:67], v[160:163], a[24:27], v[64:67]
    ds_read_b128 a[220:223], v203 offset:2048
    ds_read_b64_tr_b16 v[152:153], v187 offset:18048
    v_mfma_f32_16x16x32_bf16 v[68:71], v[160:163], a[88:91], v[68:71]
    s_add_u32 s87, s87, s3
    s_lshl_b32 s87, s87, 15
    v_mfma_f32_16x16x32_bf16 v[80:83], v[160:163], a[152:155], v[80:83]
    ds_read_b64_tr_b16 v[154:155], v187 offset:18944
    ds_read_b64_tr_b16 v[156:157], v187 offset:3616
    v_mfma_f32_16x16x32_bf16 v[84:87], v[160:163], a[216:219], v[84:87]
    buffer_load_dwordx4 v177, s[36:39], s25 offen offset:1024 lds
    s_mov_b32 s83, s87
    s_waitcnt lgkmcnt(8)
    v_mfma_f32_16x16x32_bf16 v[72:75], v[164:167], a[24:27], v[72:75]
    ds_read_b64_tr_b16 v[158:159], v187 offset:4512
    ds_read_b64_tr_b16 v[160:161], v187 offset:18080
    v_mfma_f32_16x16x32_bf16 v[76:79], v[164:167], a[88:91], v[76:79]
    s_add_u32 s88, s101, 1
    s_and_b32 s88, s88, 3
    v_mfma_f32_16x16x32_bf16 v[88:91], v[164:167], a[152:155], v[88:91]
    ds_read_b64_tr_b16 v[162:163], v187 offset:18976
    v_mfma_f32_16x16x32_bf16 v[92:95], v[164:167], a[216:219], v[92:95]
    ds_read_b64_tr_b16 v[164:165], v187 offset:3648
    buffer_load_dwordx4 v178, s[36:39], s25 offen offset:2048 lds
    s_add_u32 s88, s88, s3
    v_mfma_f32_16x16x32_bf16 v[96:99], v[144:147], a[24:27], v[96:99]
    ds_read_b64_tr_b16 v[166:167], v187 offset:4544
    v_mfma_f32_16x16x32_bf16 v[100:103], v[144:147], a[88:91], v[100:103]
    ds_read_b64_tr_b16 v[144:145], v187 offset:18112
    s_lshl_b32 s88, s88, 15
    s_mov_b32 s84, s88
    s_waitcnt lgkmcnt(8)
    v_mfma_f32_16x16x32_bf16 v[0:3], v[148:151], a[28:31], v[0:3]
    ds_read_b64_tr_b16 v[146:147], v187 offset:19008
    s_add_u32 s89, s101, 2
    v_mfma_f32_16x16x32_bf16 v[4:7], v[148:151], a[92:95], v[4:7]
    s_and_b32 s89, s89, 3
    s_add_u32 s89, s89, s3
    v_mfma_f32_16x16x32_bf16 v[16:19], v[148:151], a[156:159], v[16:19]
    v_mfma_f32_16x16x32_bf16 v[20:23], v[148:151], a[220:223], v[20:23]
    ds_read_b128 v[148:151], v193 offset:448
    buffer_load_dwordx4 v179, s[36:39], s25 offen offset:3072 lds
    s_lshl_b32 s89, s89, 15
    s_mov_b32 s85, s89
    s_waitcnt lgkmcnt(6)
    v_mfma_f32_16x16x32_bf16 v[8:11], v[152:155], a[28:31], v[8:11]
    v_add_u32 v200, 0xb100, v200
    v_add_u32 v201, 0xb100, v201
    v_mfma_f32_16x16x32_bf16 v[12:15], v[152:155], a[92:95], v[12:15]
    v_add_u32 v202, 0xb100, v202
    s_add_u32 m0, s12, 94720
    v_mfma_f32_16x16x32_bf16 v[24:27], v[152:155], a[156:159], v[24:27]
    v_add_u32 v203, 0xb100, v203
    v_add_u32 v187, 0xb100, v187
    v_mfma_f32_16x16x32_bf16 v[28:31], v[152:155], a[220:223], v[28:31]
    v_add_u32 v188, 0xb100, v188
    buffer_load_dwordx4 v180, s[36:39], s25 offen lds
    v_mfma_f32_16x16x32_bf16 v[32:35], v[156:159], a[28:31], v[32:35]
    v_xor_b32 v168, v168, v195
    v_xor_b32 v169, v169, v195
    v_mfma_f32_16x16x32_bf16 v[36:39], v[156:159], a[92:95], v[36:39]
    v_xor_b32 v170, v170, v195
    s_add_u32 s90, s101, 3
    v_mfma_f32_16x16x32_bf16 v[48:51], v[156:159], a[156:159], v[48:51]
    v_xor_b32 v171, v171, v195
    v_xor_b32 v172, v172, v195
    v_mfma_f32_16x16x32_bf16 v[52:55], v[156:159], a[220:223], v[52:55]
    v_xor_b32 v173, v173, v195
    buffer_load_dwordx4 v181, s[36:39], s25 offen offset:1024 lds
    s_waitcnt lgkmcnt(0)
    v_mfma_f32_16x16x32_bf16 v[40:43], v[160:163], a[28:31], v[40:43]
    v_xor_b32 v174, v174, v195
    v_xor_b32 v175, v175, v195
    v_mfma_f32_16x16x32_bf16 v[44:47], v[160:163], a[92:95], v[44:47]
    s_and_b32 s90, s90, 3
    s_add_u32 s90, s90, s3
    v_mfma_f32_16x16x32_bf16 v[56:59], v[160:163], a[156:159], v[56:59]
    s_lshl_b32 s90, s90, 15
    s_mov_b32 s86, s90
    v_mfma_f32_16x16x32_bf16 v[60:63], v[160:163], a[220:223], v[60:63]
    s_lshl_b32 s101, s99, 7
    v_lshrrev_b32 v113, 3, v255
    v_mfma_f32_16x16x32_bf16 v[64:67], v[164:167], a[28:31], v[64:67]
    buffer_load_dwordx4 v182, s[36:39], s25 offen offset:2048 lds
    v_lshl_add_u32 v112, v113, 10, s101
    v_mfma_f32_16x16x32_bf16 v[68:71], v[164:167], a[92:95], v[68:71]
    v_and_b32 v117, 7, v255
    v_lshrrev_b32 v116, 1, v117
    v_mfma_f32_16x16x32_bf16 v[80:83], v[164:167], a[156:159], v[80:83]
    v_bfe_u32 v118, v255, 4, 1
    v_xor_b32 v115, v116, v118
    v_mfma_f32_16x16x32_bf16 v[84:87], v[164:167], a[220:223], v[84:87]
    v_and_b32 v120, 1, v255
    v_lshlrev_b32 v119, 4, v120
    v_mfma_f32_16x16x32_bf16 v[72:75], v[144:147], a[28:31], v[72:75]
    v_mfma_f32_16x16x32_bf16 v[76:79], v[144:147], a[92:95], v[76:79]
    s_waitcnt vmcnt(13)
    s_barrier
    ds_read_b128 a[32:35], v200 offset:0
    ds_read_b128 a[96:99], v200 offset:2048
    v_mfma_f32_16x16x32_bf16 v[88:91], v[144:147], a[156:159], v[88:91]
    ds_read_b64_tr_b16 v[152:153], v187 offset:0
    ds_read_b64_tr_b16 v[154:155], v187 offset:896
    v_mfma_f32_16x16x32_bf16 v[92:95], v[144:147], a[220:223], v[92:95]
    s_add_u32 m0, s97, 0
    s_nop 0
    buffer_load_dwordx4 v226, s[28:31], s10 offen lds
    v_mfma_f32_16x16x32_bf16 v[96:99], v[148:151], a[28:31], v[96:99]
    ds_read_b128 a[160:163], v202 offset:0
    ds_read_b128 a[224:227], v202 offset:2048
    v_mfma_f32_16x16x32_bf16 v[100:103], v[148:151], a[92:95], v[100:103]
    v_lshl_add_u32 v114, v115, 5, v119
    v_add_u32 v251, v112, v114
    s_waitcnt lgkmcnt(2)
    v_mfma_f32_16x16x32_bf16 v[0:3], v[152:155], a[32:35], v[0:3]
    ds_read_b64_tr_b16 v[156:157], v187 offset:14464
    ds_read_b64_tr_b16 v[158:159], v187 offset:15360
    v_mfma_f32_16x16x32_bf16 v[4:7], v[152:155], a[96:99], v[4:7]
    buffer_load_dwordx4 v227, s[28:31], s10 offen offset:1024 lds
    v_lshlrev_b32 v123, 10, v113
    s_waitcnt lgkmcnt(3)
    v_mfma_f32_16x16x32_bf16 v[16:19], v[152:155], a[160:163], v[16:19]
    ds_read_b64_tr_b16 v[160:161], v187 offset:32
    ds_read_b64_tr_b16 v[162:163], v187 offset:928
    s_waitcnt lgkmcnt(4)
    v_mfma_f32_16x16x32_bf16 v[20:23], v[152:155], a[224:227], v[20:23]
    v_add_u32 v122, 0x1c00, v123
    v_add_u32 v121, s101, v122
    s_waitcnt lgkmcnt(2)
    v_mfma_f32_16x16x32_bf16 v[8:11], v[156:159], a[32:35], v[8:11]
    ds_read_b64_tr_b16 v[164:165], v187 offset:14496
    ds_read_b64_tr_b16 v[166:167], v187 offset:15392
    v_mfma_f32_16x16x32_bf16 v[12:15], v[156:159], a[96:99], v[12:15]
    buffer_load_dwordx4 v228, s[28:31], s10 offen offset:2048 lds
    v_xor_b32 v125, 2, v115
    v_mfma_f32_16x16x32_bf16 v[24:27], v[156:159], a[160:163], v[24:27]
    ds_read_b64_tr_b16 v[144:145], v187 offset:64
    ds_read_b64_tr_b16 v[146:147], v187 offset:960
    v_mfma_f32_16x16x32_bf16 v[28:31], v[156:159], a[224:227], v[28:31]
    v_lshl_add_u32 v124, v125, 5, v119
    v_add_u32 v252, v121, v124
    s_waitcnt lgkmcnt(4)
    v_mfma_f32_16x16x32_bf16 v[32:35], v[160:163], a[32:35], v[32:35]
    ds_read_b64_tr_b16 v[148:149], v187 offset:14528
    ds_read_b64_tr_b16 v[150:151], v187 offset:15424
    v_mfma_f32_16x16x32_bf16 v[36:39], v[160:163], a[96:99], v[36:39]
    buffer_load_dwordx4 v229, s[28:31], s10 offen offset:3072 lds
    v_add_u32 v127, 0x3800, v123
    v_mfma_f32_16x16x32_bf16 v[48:51], v[160:163], a[160:163], v[48:51]
    ds_read_b128 v[152:155], v193 offset:512
    ds_read_b128 a[36:39], v201 offset:0
    v_mfma_f32_16x16x32_bf16 v[52:55], v[160:163], a[224:227], v[52:55]
    v_add_u32 v126, s101, v127
    v_add_u32 v253, v126, v114
    s_waitcnt lgkmcnt(6)
    v_mfma_f32_16x16x32_bf16 v[40:43], v[164:167], a[32:35], v[40:43]
    ds_read_b128 a[100:103], v201 offset:2048
    ds_read_b64_tr_b16 v[156:157], v187 offset:3584
    v_mfma_f32_16x16x32_bf16 v[44:47], v[164:167], a[96:99], v[44:47]
    s_add_u32 m0, s12, 0
    v_add_u32 v129, 0x5400, v123
    v_mfma_f32_16x16x32_bf16 v[56:59], v[164:167], a[160:163], v[56:59]
    ds_read_b64_tr_b16 v[158:159], v187 offset:4480
    ds_read_b128 a[164:167], v203 offset:0
    v_mfma_f32_16x16x32_bf16 v[60:63], v[164:167], a[224:227], v[60:63]
    buffer_load_dwordx4 v176, s[36:39], s26 offen lds
    v_add_u32 v128, s101, v129
    s_waitcnt lgkmcnt(8)
    v_mfma_f32_16x16x32_bf16 v[64:67], v[144:147], a[32:35], v[64:67]
    ds_read_b128 a[228:231], v203 offset:2048
    ds_read_b64_tr_b16 v[160:161], v187 offset:18048
    v_mfma_f32_16x16x32_bf16 v[68:71], v[144:147], a[96:99], v[68:71]
    v_add_u32 v254, v128, v124
    v_lshrrev_b32 v132, 4, v255
    v_mfma_f32_16x16x32_bf16 v[80:83], v[144:147], a[160:163], v[80:83]
    ds_read_b64_tr_b16 v[162:163], v187 offset:18944
    ds_read_b64_tr_b16 v[164:165], v187 offset:3616
    v_mfma_f32_16x16x32_bf16 v[84:87], v[144:147], a[224:227], v[84:87]
    buffer_load_dwordx4 v177, s[36:39], s26 offen offset:1024 lds
    v_bfe_u32 v133, v255, 2, 2
    s_waitcnt lgkmcnt(8)
    v_mfma_f32_16x16x32_bf16 v[72:75], v[148:151], a[32:35], v[72:75]
    ds_read_b64_tr_b16 v[166:167], v187 offset:4512
    ds_read_b64_tr_b16 v[144:145], v187 offset:18080
    v_mfma_f32_16x16x32_bf16 v[76:79], v[148:151], a[96:99], v[76:79]
    v_lshl_add_u32 v131, v132, 3, v133
    v_and_b32 v135, 3, v255
    v_mfma_f32_16x16x32_bf16 v[88:91], v[148:151], a[160:163], v[88:91]
    ds_read_b64_tr_b16 v[146:147], v187 offset:18976
    v_mfma_f32_16x16x32_bf16 v[92:95], v[148:151], a[224:227], v[92:95]
    ds_read_b64_tr_b16 v[148:149], v187 offset:3648
    buffer_load_dwordx4 v178, s[36:39], s26 offen offset:2048 lds
    v_lshl_add_u32 v134, v135, 3, s97
    v_mfma_f32_16x16x32_bf16 v[96:99], v[152:155], a[32:35], v[96:99]
    ds_read_b64_tr_b16 v[150:151], v187 offset:4544
    v_mfma_f32_16x16x32_bf16 v[100:103], v[152:155], a[96:99], v[100:103]
    ds_read_b64_tr_b16 v[152:153], v187 offset:18112
    v_lshl_add_u32 v130, v131, 7, v134
    v_lshrrev_b32 v138, 1, v133
    s_waitcnt lgkmcnt(8)
    v_mfma_f32_16x16x32_bf16 v[0:3], v[156:159], a[36:39], v[0:3]
    ds_read_b64_tr_b16 v[154:155], v187 offset:19008
    v_lshl_add_u32 v137, v118, 1, v138
    v_mfma_f32_16x16x32_bf16 v[4:7], v[156:159], a[100:103], v[4:7]
    v_lshlrev_b32 v136, 5, v137
    v_add_u32 v245, v130, v136
    v_mfma_f32_16x16x32_bf16 v[16:19], v[156:159], a[164:167], v[16:19]
    v_mfma_f32_16x16x32_bf16 v[20:23], v[156:159], a[228:231], v[20:23]
    ds_read_b128 v[156:159], v193 offset:576
    buffer_load_dwordx4 v179, s[36:39], s26 offen offset:3072 lds
    v_xor_b32 v246, 32, v245
    v_xor_b32 v247, 64, v245
    s_waitcnt lgkmcnt(6)
    v_mfma_f32_16x16x32_bf16 v[8:11], v[160:163], a[36:39], v[8:11]
    v_add_u32 v200, 0xb100, v200
    v_add_u32 v201, 0xb100, v201
    v_mfma_f32_16x16x32_bf16 v[12:15], v[160:163], a[100:103], v[12:15]
    v_add_u32 v202, 0xb100, v202
    s_add_u32 m0, s12, 4096
    v_mfma_f32_16x16x32_bf16 v[24:27], v[160:163], a[164:167], v[24:27]
    v_add_u32 v203, 0xb100, v203
    v_add_u32 v187, 0xb100, v187
    v_mfma_f32_16x16x32_bf16 v[28:31], v[160:163], a[228:231], v[28:31]
    v_add_u32 v188, 0xb100, v188
    buffer_load_dwordx4 v180, s[36:39], s26 offen lds
    v_mfma_f32_16x16x32_bf16 v[32:35], v[164:167], a[36:39], v[32:35]
    v_xor_b32 v248, 96, v245
    v_and_b32 v139, 15, v255
    v_mfma_f32_16x16x32_bf16 v[36:39], v[164:167], a[100:103], v[36:39]
    v_lshlrev_b32 v236, 2, v139
    v_lshlrev_b32 v235, 7, v139
    v_mfma_f32_16x16x32_bf16 v[48:51], v[164:167], a[164:167], v[48:51]
    buffer_load_dwordx4 v181, s[36:39], s26 offen offset:1024 lds
    v_lshlrev_b32 v140, 4, v139
    v_mfma_f32_16x16x32_bf16 v[52:55], v[164:167], a[228:231], v[52:55]
    v_lshl_add_u32 v234, v132, 9, v140
    s_lshl_b32 s101, s93, 14
    s_waitcnt lgkmcnt(0)
    v_mfma_f32_16x16x32_bf16 v[40:43], v[144:147], a[36:39], v[40:43]
    s_lshl_b32 s3, s92, 11
    s_add_u32 s101, s101, s3
    v_mfma_f32_16x16x32_bf16 v[44:47], v[144:147], a[100:103], v[44:47]
    v_lshl_add_u32 v141, v113, 8, s101
    v_lshlrev_b32 v209, 1, v117
    v_mfma_f32_16x16x32_bf16 v[56:59], v[144:147], a[164:167], v[56:59]
    v_and_b32 v208, 8, v209
    v_and_b32 v211, 7, v209
    v_mfma_f32_16x16x32_bf16 v[60:63], v[144:147], a[228:231], v[60:63]
    v_xor_b32 v210, v211, v113
    v_add_u32 v143, v208, v210
    v_mfma_f32_16x16x32_bf16 v[64:67], v[148:151], a[36:39], v[64:67]
    buffer_load_dwordx4 v182, s[36:39], s26 offen offset:2048 lds
    v_lshlrev_b32 v142, 4, v143
    v_mfma_f32_16x16x32_bf16 v[68:71], v[148:151], a[100:103], v[68:71]
    v_add_u32 v224, v141, v142
    v_lshl_add_u32 v212, v113, 8, s101
    v_mfma_f32_16x16x32_bf16 v[80:83], v[148:151], a[164:167], v[80:83]
    v_add_u32 v216, 1, v209
    v_and_b32 v215, 8, v216
    v_mfma_f32_16x16x32_bf16 v[84:87], v[148:151], a[228:231], v[84:87]
    v_and_b32 v218, 7, v216
    v_xor_b32 v217, v218, v113
    v_mfma_f32_16x16x32_bf16 v[72:75], v[152:155], a[36:39], v[72:75]
    v_mfma_f32_16x16x32_bf16 v[76:79], v[152:155], a[100:103], v[76:79]
    s_waitcnt vmcnt(11)
    s_barrier
    v_mov_b32 v240, 0
    buffer_load_dword v243, v240, s[44:47], 0 offen sc1
    ds_read_b128 a[40:43], v200 offset:0
    ds_read_b128 a[104:107], v200 offset:2048
    v_mfma_f32_16x16x32_bf16 v[88:91], v[152:155], a[164:167], v[88:91]
    ds_read_b64_tr_b16 v[160:161], v187 offset:0
    ds_read_b64_tr_b16 v[162:163], v187 offset:896
    v_mfma_f32_16x16x32_bf16 v[92:95], v[152:155], a[228:231], v[92:95]
    s_add_u32 m0, s97, 45312
    s_nop 0
    buffer_load_dwordx4 v226, s[28:31], s11 offen lds
    v_mfma_f32_16x16x32_bf16 v[96:99], v[156:159], a[36:39], v[96:99]
    ds_read_b128 a[168:171], v202 offset:0
    ds_read_b128 a[232:235], v202 offset:2048
    v_mfma_f32_16x16x32_bf16 v[100:103], v[156:159], a[100:103], v[100:103]
    v_add_u32 v214, v215, v217
    v_lshlrev_b32 v213, 4, v214
    s_waitcnt lgkmcnt(2)
    v_mfma_f32_16x16x32_bf16 v[0:3], v[160:163], a[40:43], v[0:3]
    ds_read_b64_tr_b16 v[164:165], v187 offset:14464
    ds_read_b64_tr_b16 v[166:167], v187 offset:15360
    v_mfma_f32_16x16x32_bf16 v[4:7], v[160:163], a[104:107], v[4:7]
    buffer_load_dwordx4 v227, s[28:31], s11 offen offset:1024 lds
    v_add_u32 v225, v212, v213
    s_waitcnt lgkmcnt(3)
    v_mfma_f32_16x16x32_bf16 v[16:19], v[160:163], a[168:171], v[16:19]
    ds_read_b64_tr_b16 v[144:145], v187 offset:32
    ds_read_b64_tr_b16 v[146:147], v187 offset:928
    s_waitcnt lgkmcnt(4)
    v_mfma_f32_16x16x32_bf16 v[20:23], v[160:163], a[232:235], v[20:23]
    s_waitcnt lgkmcnt(2)
    v_mfma_f32_16x16x32_bf16 v[8:11], v[164:167], a[40:43], v[8:11]
    ds_read_b64_tr_b16 v[148:149], v187 offset:14496
    ds_read_b64_tr_b16 v[150:151], v187 offset:15392
    v_mfma_f32_16x16x32_bf16 v[12:15], v[164:167], a[104:107], v[12:15]
    buffer_load_dwordx4 v228, s[28:31], s11 offen offset:2048 lds
    v_mfma_f32_16x16x32_bf16 v[24:27], v[164:167], a[168:171], v[24:27]
    ds_read_b64_tr_b16 v[152:153], v187 offset:64
    ds_read_b64_tr_b16 v[154:155], v187 offset:960
    v_mfma_f32_16x16x32_bf16 v[28:31], v[164:167], a[232:235], v[28:31]
    s_waitcnt lgkmcnt(4)
    v_mfma_f32_16x16x32_bf16 v[32:35], v[144:147], a[40:43], v[32:35]
    ds_read_b64_tr_b16 v[156:157], v187 offset:14528
    ds_read_b64_tr_b16 v[158:159], v187 offset:15424
    v_mfma_f32_16x16x32_bf16 v[36:39], v[144:147], a[104:107], v[36:39]
    buffer_load_dwordx4 v229, s[28:31], s11 offen offset:3072 lds
    v_mfma_f32_16x16x32_bf16 v[48:51], v[144:147], a[168:171], v[48:51]
    ds_read_b128 v[160:163], v193 offset:640
    ds_read_b128 a[44:47], v201 offset:0
    v_mfma_f32_16x16x32_bf16 v[52:55], v[144:147], a[232:235], v[52:55]
    s_waitcnt lgkmcnt(6)
    v_mfma_f32_16x16x32_bf16 v[40:43], v[148:151], a[40:43], v[40:43]
    ds_read_b128 a[108:111], v201 offset:2048
    ds_read_b64_tr_b16 v[164:165], v187 offset:3584
    v_mfma_f32_16x16x32_bf16 v[44:47], v[148:151], a[104:107], v[44:47]
    s_add_u32 m0, s12, 45312
    v_mfma_f32_16x16x32_bf16 v[56:59], v[148:151], a[168:171], v[56:59]
    ds_read_b64_tr_b16 v[166:167], v187 offset:4480
    ds_read_b128 a[172:175], v203 offset:0
    v_mfma_f32_16x16x32_bf16 v[60:63], v[148:151], a[232:235], v[60:63]
    buffer_load_dwordx4 v176, s[36:39], s27 offen lds
    s_waitcnt lgkmcnt(8)
    v_mfma_f32_16x16x32_bf16 v[64:67], v[152:155], a[40:43], v[64:67]
    ds_read_b128 a[236:239], v203 offset:2048
    ds_read_b64_tr_b16 v[144:145], v187 offset:18048
    v_mfma_f32_16x16x32_bf16 v[68:71], v[152:155], a[104:107], v[68:71]
    v_mfma_f32_16x16x32_bf16 v[80:83], v[152:155], a[168:171], v[80:83]
    ds_read_b64_tr_b16 v[146:147], v187 offset:18944
    ds_read_b64_tr_b16 v[148:149], v187 offset:3616
    v_mfma_f32_16x16x32_bf16 v[84:87], v[152:155], a[232:235], v[84:87]
    buffer_load_dwordx4 v177, s[36:39], s27 offen offset:1024 lds
    s_waitcnt lgkmcnt(8)
    v_mfma_f32_16x16x32_bf16 v[72:75], v[156:159], a[40:43], v[72:75]
    ds_read_b64_tr_b16 v[150:151], v187 offset:4512
    ds_read_b64_tr_b16 v[152:153], v187 offset:18080
    v_mfma_f32_16x16x32_bf16 v[76:79], v[156:159], a[104:107], v[76:79]
    v_mfma_f32_16x16x32_bf16 v[88:91], v[156:159], a[168:171], v[88:91]
    ds_read_b64_tr_b16 v[154:155], v187 offset:18976
    v_mfma_f32_16x16x32_bf16 v[92:95], v[156:159], a[232:235], v[92:95]
    ds_read_b64_tr_b16 v[156:157], v187 offset:3648
    buffer_load_dwordx4 v178, s[36:39], s27 offen offset:2048 lds
    v_mfma_f32_16x16x32_bf16 v[96:99], v[160:163], a[40:43], v[96:99]
    ds_read_b64_tr_b16 v[158:159], v187 offset:4544
    v_mfma_f32_16x16x32_bf16 v[100:103], v[160:163], a[104:107], v[100:103]
    ds_read_b64_tr_b16 v[160:161], v187 offset:18112
    s_waitcnt lgkmcnt(8)
    v_mfma_f32_16x16x32_bf16 v[0:3], v[164:167], a[44:47], v[0:3]
    ds_read_b64_tr_b16 v[162:163], v187 offset:19008
    v_mfma_f32_16x16x32_bf16 v[4:7], v[164:167], a[108:111], v[4:7]
    v_mfma_f32_16x16x32_bf16 v[16:19], v[164:167], a[172:175], v[16:19]
    v_mfma_f32_16x16x32_bf16 v[20:23], v[164:167], a[236:239], v[20:23]
    ds_read_b128 v[164:167], v193 offset:704
    buffer_load_dwordx4 v179, s[36:39], s27 offen offset:3072 lds
    s_waitcnt lgkmcnt(6)
    v_mfma_f32_16x16x32_bf16 v[8:11], v[144:147], a[44:47], v[8:11]
    v_add_u32 v200, 0xfffe9e00, v200
    v_add_u32 v201, 0xfffe9e00, v201
    v_mfma_f32_16x16x32_bf16 v[12:15], v[144:147], a[108:111], v[12:15]
    v_add_u32 v202, 0xfffe9e00, v202
    s_add_u32 m0, s12, 49408
    v_mfma_f32_16x16x32_bf16 v[24:27], v[144:147], a[172:175], v[24:27]
    v_add_u32 v203, 0xfffe9e00, v203
    v_add_u32 v187, 0xfffe9e00, v187
    v_mfma_f32_16x16x32_bf16 v[28:31], v[144:147], a[236:239], v[28:31]
    v_add_u32 v188, 0xfffe9e00, v188
    buffer_load_dwordx4 v180, s[36:39], s27 offen lds
    v_mfma_f32_16x16x32_bf16 v[32:35], v[148:151], a[44:47], v[32:35]
    v_mfma_f32_16x16x32_bf16 v[36:39], v[148:151], a[108:111], v[36:39]
    v_mfma_f32_16x16x32_bf16 v[48:51], v[148:151], a[172:175], v[48:51]
    buffer_load_dwordx4 v181, s[36:39], s27 offen offset:1024 lds
    v_mfma_f32_16x16x32_bf16 v[52:55], v[148:151], a[236:239], v[52:55]
    s_waitcnt lgkmcnt(1)
    v_mfma_f32_16x16x32_bf16 v[40:43], v[152:155], a[44:47], v[40:43]
    v_mfma_f32_16x16x32_bf16 v[44:47], v[152:155], a[108:111], v[44:47]
    v_mfma_f32_16x16x32_bf16 v[56:59], v[152:155], a[172:175], v[56:59]
    v_mfma_f32_16x16x32_bf16 v[60:63], v[152:155], a[236:239], v[60:63]
    v_mfma_f32_16x16x32_bf16 v[64:67], v[156:159], a[44:47], v[64:67]
    buffer_load_dwordx4 v182, s[36:39], s27 offen offset:2048 lds
    v_mfma_f32_16x16x32_bf16 v[68:71], v[156:159], a[108:111], v[68:71]
    v_mfma_f32_16x16x32_bf16 v[80:83], v[156:159], a[172:175], v[80:83]
    v_mfma_f32_16x16x32_bf16 v[84:87], v[156:159], a[236:239], v[84:87]
    v_mfma_f32_16x16x32_bf16 v[72:75], v[160:163], a[44:47], v[72:75]
    v_mfma_f32_16x16x32_bf16 v[76:79], v[160:163], a[108:111], v[76:79]
    s_waitcnt lgkmcnt(0)
    s_waitcnt vmcnt(12)
    s_barrier
    ds_read_b128 a[48:51], v200 offset:0
    ds_read_b128 a[112:115], v200 offset:2048
    v_mfma_f32_16x16x32_bf16 v[88:91], v[160:163], a[172:175], v[88:91]
    ds_read_b64_tr_b16 v[144:145], v187 offset:0
    ds_read_b64_tr_b16 v[146:147], v187 offset:896
    v_mfma_f32_16x16x32_bf16 v[92:95], v[160:163], a[236:239], v[92:95]
    s_add_u32 m0, s14, 98304
    s_nop 0
    buffer_load_dwordx4 v183, s[32:35], s71 offen lds
    v_mfma_f32_16x16x32_bf16 v[96:99], v[164:167], a[44:47], v[96:99]
    ds_read_b128 a[176:179], v202 offset:0
    ds_read_b128 a[240:243], v202 offset:2048
    v_mfma_f32_16x16x32_bf16 v[100:103], v[164:167], a[108:111], v[100:103]
    s_waitcnt lgkmcnt(2)
    v_mfma_f32_16x16x32_bf16 v[0:3], v[144:147], a[48:51], v[0:3]
    ds_read_b64_tr_b16 v[148:149], v187 offset:14464
    ds_read_b64_tr_b16 v[150:151], v187 offset:15360
    v_mfma_f32_16x16x32_bf16 v[4:7], v[144:147], a[112:115], v[4:7]
    buffer_load_dwordx4 v184, s[32:35], s71 offen offset:1024 lds
    s_waitcnt lgkmcnt(3)
    v_mfma_f32_16x16x32_bf16 v[16:19], v[144:147], a[176:179], v[16:19]
    ds_read_b64_tr_b16 v[152:153], v187 offset:32
    ds_read_b64_tr_b16 v[154:155], v187 offset:928
    s_waitcnt lgkmcnt(4)
    v_mfma_f32_16x16x32_bf16 v[20:23], v[144:147], a[240:243], v[20:23]
    s_waitcnt lgkmcnt(2)
    v_mfma_f32_16x16x32_bf16 v[8:11], v[148:151], a[48:51], v[8:11]
    ds_read_b64_tr_b16 v[156:157], v187 offset:14496
    ds_read_b64_tr_b16 v[158:159], v187 offset:15392
    v_mfma_f32_16x16x32_bf16 v[12:15], v[148:151], a[112:115], v[12:15]
    buffer_load_dwordx4 v185, s[32:35], s71 offen offset:2048 lds
    v_mfma_f32_16x16x32_bf16 v[24:27], v[148:151], a[176:179], v[24:27]
    ds_read_b64_tr_b16 v[160:161], v187 offset:64
    ds_read_b64_tr_b16 v[162:163], v187 offset:960
    v_mfma_f32_16x16x32_bf16 v[28:31], v[148:151], a[240:243], v[28:31]
    s_waitcnt lgkmcnt(4)
    v_mfma_f32_16x16x32_bf16 v[32:35], v[152:155], a[48:51], v[32:35]
    ds_read_b64_tr_b16 v[164:165], v187 offset:14528
    ds_read_b64_tr_b16 v[166:167], v187 offset:15424
    v_mfma_f32_16x16x32_bf16 v[36:39], v[152:155], a[112:115], v[36:39]
    buffer_load_dwordx4 v186, s[32:35], s71 offen offset:3072 lds
    v_mfma_f32_16x16x32_bf16 v[48:51], v[152:155], a[176:179], v[48:51]
    ds_read_b128 v[144:147], v193 offset:768
    ds_read_b128 a[52:55], v201 offset:0
    v_mfma_f32_16x16x32_bf16 v[52:55], v[152:155], a[240:243], v[52:55]
    s_waitcnt lgkmcnt(6)
    v_mfma_f32_16x16x32_bf16 v[40:43], v[156:159], a[48:51], v[40:43]
    ds_read_b128 a[116:119], v201 offset:2048
    ds_read_b64_tr_b16 v[148:149], v187 offset:3584
    v_mfma_f32_16x16x32_bf16 v[44:47], v[156:159], a[112:115], v[44:47]
    s_add_u32 s71, s71, 98304
    s_add_u32 m0, s14, 102400
    v_mfma_f32_16x16x32_bf16 v[56:59], v[156:159], a[176:179], v[56:59]
    ds_read_b64_tr_b16 v[150:151], v187 offset:4480
    ds_read_b128 a[180:183], v203 offset:0
    v_mfma_f32_16x16x32_bf16 v[60:63], v[156:159], a[240:243], v[60:63]
    buffer_load_dwordx4 v183, s[32:35], s71 offen lds
    s_waitcnt lgkmcnt(8)
    v_mfma_f32_16x16x32_bf16 v[64:67], v[160:163], a[48:51], v[64:67]
    ds_read_b128 a[244:247], v203 offset:2048
    ds_read_b64_tr_b16 v[152:153], v187 offset:18048
    v_mfma_f32_16x16x32_bf16 v[68:71], v[160:163], a[112:115], v[68:71]
    v_mfma_f32_16x16x32_bf16 v[80:83], v[160:163], a[176:179], v[80:83]
    ds_read_b64_tr_b16 v[154:155], v187 offset:18944
    ds_read_b64_tr_b16 v[156:157], v187 offset:3616
    v_mfma_f32_16x16x32_bf16 v[84:87], v[160:163], a[240:243], v[84:87]
    buffer_load_dwordx4 v184, s[32:35], s71 offen offset:1024 lds
    s_waitcnt lgkmcnt(8)
    v_mfma_f32_16x16x32_bf16 v[72:75], v[164:167], a[48:51], v[72:75]
    ds_read_b64_tr_b16 v[158:159], v187 offset:4512
    ds_read_b64_tr_b16 v[160:161], v187 offset:18080
    v_mfma_f32_16x16x32_bf16 v[76:79], v[164:167], a[112:115], v[76:79]
    v_mfma_f32_16x16x32_bf16 v[88:91], v[164:167], a[176:179], v[88:91]
    ds_read_b64_tr_b16 v[162:163], v187 offset:18976
    v_mfma_f32_16x16x32_bf16 v[92:95], v[164:167], a[240:243], v[92:95]
    ds_read_b64_tr_b16 v[164:165], v187 offset:3648
    buffer_load_dwordx4 v185, s[32:35], s71 offen offset:2048 lds
    v_mfma_f32_16x16x32_bf16 v[96:99], v[144:147], a[48:51], v[96:99]
    ds_read_b64_tr_b16 v[166:167], v187 offset:4544
    v_mfma_f32_16x16x32_bf16 v[100:103], v[144:147], a[112:115], v[100:103]
    ds_read_b64_tr_b16 v[144:145], v187 offset:18112
    s_waitcnt lgkmcnt(8)
    v_mfma_f32_16x16x32_bf16 v[0:3], v[148:151], a[52:55], v[0:3]
    ds_read_b64_tr_b16 v[146:147], v187 offset:19008
    v_mfma_f32_16x16x32_bf16 v[4:7], v[148:151], a[116:119], v[4:7]
    v_mfma_f32_16x16x32_bf16 v[16:19], v[148:151], a[180:183], v[16:19]
    v_mfma_f32_16x16x32_bf16 v[20:23], v[148:151], a[244:247], v[20:23]
    ds_read_b128 v[148:151], v193 offset:832
    buffer_load_dwordx4 v186, s[32:35], s71 offen offset:3072 lds
    s_waitcnt lgkmcnt(6)
    v_mfma_f32_16x16x32_bf16 v[8:11], v[152:155], a[52:55], v[8:11]
    v_add_u32 v200, 0xb100, v200
    v_add_u32 v201, 0xb100, v201
    v_mfma_f32_16x16x32_bf16 v[12:15], v[152:155], a[116:119], v[12:15]
    v_add_u32 v202, 0xb100, v202
    s_add_u32 m0, s97, 131072
    v_mfma_f32_16x16x32_bf16 v[24:27], v[152:155], a[180:183], v[24:27]
    v_add_u32 v203, 0xb100, v203
    v_add_u32 v187, 0xb100, v187
    v_mfma_f32_16x16x32_bf16 v[28:31], v[152:155], a[244:247], v[28:31]
    v_add_u32 v188, 0xb100, v188
    buffer_load_dwordx4 v251, s[48:51], s76 offen lds
    v_mfma_f32_16x16x32_bf16 v[32:35], v[156:159], a[52:55], v[32:35]
    v_mfma_f32_16x16x32_bf16 v[36:39], v[156:159], a[116:119], v[36:39]
    v_mfma_f32_16x16x32_bf16 v[48:51], v[156:159], a[180:183], v[48:51]
    buffer_load_dwordx4 v252, s[48:51], s76 offen offset:1024 lds
    v_mfma_f32_16x16x32_bf16 v[52:55], v[156:159], a[244:247], v[52:55]
    s_waitcnt lgkmcnt(1)
    v_mfma_f32_16x16x32_bf16 v[40:43], v[160:163], a[52:55], v[40:43]
    v_mfma_f32_16x16x32_bf16 v[44:47], v[160:163], a[116:119], v[44:47]
    v_mfma_f32_16x16x32_bf16 v[56:59], v[160:163], a[180:183], v[56:59]
    v_mfma_f32_16x16x32_bf16 v[60:63], v[160:163], a[244:247], v[60:63]
    v_mfma_f32_16x16x32_bf16 v[64:67], v[164:167], a[52:55], v[64:67]
    buffer_load_dwordx4 v253, s[48:51], s76 offen offset:2048 lds
    v_mfma_f32_16x16x32_bf16 v[68:71], v[164:167], a[116:119], v[68:71]
    v_mfma_f32_16x16x32_bf16 v[80:83], v[164:167], a[180:183], v[80:83]
    v_mfma_f32_16x16x32_bf16 v[84:87], v[164:167], a[244:247], v[84:87]
    v_mfma_f32_16x16x32_bf16 v[72:75], v[144:147], a[52:55], v[72:75]
    v_mfma_f32_16x16x32_bf16 v[76:79], v[144:147], a[116:119], v[76:79]
    s_waitcnt lgkmcnt(0)
    s_waitcnt vmcnt(11)
    s_barrier
    v_cmp_eq_u32 vcc, 0, v243
    s_mov_b32 s101, 65536
    s_nop 3
    s_cbranch_vccz L_ok6
L_spin6:
    buffer_load_dword v243, v240, s[44:47], 0 offen sc1
    s_sub_u32 s101, s101, 1
    s_cmp_eq_u32 s101, 0
    s_cbranch_scc1 L_ok6
    s_waitcnt vmcnt(0)
    v_cmp_eq_u32 vcc, 0, v243
    s_nop 4
    s_cbranch_vccnz L_spin6
L_ok6:
    ds_read_b128 a[56:59], v200 offset:0
    ds_read_b128 a[120:123], v200 offset:2048
    buffer_load_dwordx4 v254, s[48:51], s76 offen offset:3072 lds
    v_mfma_f32_16x16x32_bf16 v[88:91], v[144:147], a[180:183], v[88:91]
    ds_read_b64_tr_b16 v[152:153], v187 offset:0
L_pad_qg_1:
    s_cbranch_execz L_walked_qg
    ds_read_b64_tr_b16 v[154:155], v187 offset:896
    v_mfma_f32_16x16x32_bf16 v[92:95], v[144:147], a[244:247], v[92:95]
    s_add_u32 m0, s14, 0
    v_mfma_f32_16x16x32_bf16 v[96:99], v[148:151], a[52:55], v[96:99]
    ds_read_b128 a[184:187], v202 offset:0
    ds_read_b128 a[248:251], v202 offset:2048
    v_mfma_f32_16x16x32_bf16 v[100:103], v[148:151], a[116:119], v[100:103]
    buffer_load_dwordx4 v183, s[32:35], s73 offen lds
    s_waitcnt lgkmcnt(2)
    v_mfma_f32_16x16x32_bf16 v[0:3], v[152:155], a[56:59], v[0:3]
    ds_read_b64_tr_b16 v[156:157], v187 offset:14464
    ds_read_b64_tr_b16 v[158:159], v187 offset:15360
    v_mfma_f32_16x16x32_bf16 v[4:7], v[152:155], a[120:123], v[4:7]
    s_waitcnt lgkmcnt(3)
    v_mfma_f32_16x16x32_bf16 v[16:19], v[152:155], a[184:187], v[16:19]
    ds_read_b128 a[60:63], v201 offset:0
    ds_read_b128 a[124:127], v201 offset:2048
    s_waitcnt lgkmcnt(4)
    v_mfma_f32_16x16x32_bf16 v[20:23], v[152:155], a[248:251], v[20:23]
    s_waitcnt lgkmcnt(2)
    v_mfma_f32_16x16x32_bf16 v[8:11], v[156:159], a[56:59], v[8:11]
    ds_read_b64_tr_b16 v[160:161], v187 offset:3584
    ds_read_b64_tr_b16 v[162:163], v187 offset:4480
    v_mfma_f32_16x16x32_bf16 v[12:15], v[156:159], a[120:123], v[12:15]
    buffer_load_dwordx4 v184, s[32:35], s73 offen offset:1024 lds
    v_mfma_f32_16x16x32_bf16 v[24:27], v[156:159], a[184:187], v[24:27]
    ds_read_b128 a[188:191], v203 offset:0
    ds_read_b128 a[252:255], v203 offset:2048
    v_mfma_f32_16x16x32_bf16 v[28:31], v[156:159], a[248:251], v[28:31]
    s_waitcnt lgkmcnt(2)
    v_mfma_f32_16x16x32_bf16 v[0:3], v[160:163], a[60:63], v[0:3]
    ds_read_b64_tr_b16 v[164:165], v187 offset:18048
    ds_read_b64_tr_b16 v[166:167], v187 offset:18944
    v_mfma_f32_16x16x32_bf16 v[4:7], v[160:163], a[124:127], v[4:7]
    buffer_load_dwordx4 v185, s[32:35], s73 offen offset:2048 lds
    s_waitcnt lgkmcnt(3)
    v_mfma_f32_16x16x32_bf16 v[16:19], v[160:163], a[188:191], v[16:19]
    ds_read_b128 v[144:147], v193 offset:896
    ds_read_b128 v[148:151], v193 offset:960
    s_waitcnt lgkmcnt(4)
    v_mfma_f32_16x16x32_bf16 v[20:23], v[160:163], a[252:255], v[20:23]
    s_waitcnt lgkmcnt(2)
    v_mfma_f32_16x16x32_bf16 v[8:11], v[164:167], a[60:63], v[8:11]
    ds_read_b64_tr_b16 v[152:153], v187 offset:32
    ds_read_b64_tr_b16 v[154:155], v187 offset:928
    v_mfma_f32_16x16x32_bf16 v[12:15], v[164:167], a[124:127], v[12:15]
    buffer_load_dwordx4 v186, s[32:35], s73 offen offset:3072 lds
    v_mfma_f32_16x16x32_bf16 v[24:27], v[164:167], a[188:191], v[24:27]
    ds_read_b64_tr_b16 v[156:157], v187 offset:14496
    ds_read_b64_tr_b16 v[158:159], v187 offset:15392
    v_mfma_f32_16x16x32_bf16 v[28:31], v[164:167], a[252:255], v[28:31]
    s_waitcnt lgkmcnt(5)
    v_mfma_f32_16x16x32_bf16 v[96:99], v[144:147], a[56:59], v[96:99]
    ds_read_b64_tr_b16 v[160:161], v187 offset:3616
    ds_read_b64_tr_b16 v[162:163], v187 offset:4512
    v_mfma_f32_16x16x32_bf16 v[100:103], v[144:147], a[120:123], v[100:103]
    s_add_u32 s73, s73, 98304
    s_add_u32 m0, s14, 4096
    s_waitcnt lgkmcnt(6)
    v_mfma_f32_16x16x32_bf16 v[96:99], v[148:151], a[60:63], v[96:99]
    ds_read_b64_tr_b16 v[164:165], v187 offset:18080
    ds_read_b64_tr_b16 v[166:167], v187 offset:18976
    v_mfma_f32_16x16x32_bf16 v[100:103], v[148:151], a[124:127], v[100:103]
    buffer_load_dwordx4 v183, s[32:35], s73 offen lds
    v_mul_f32 v0, v0, v8
    s_waitcnt lgkmcnt(6)
    v_mfma_f32_16x16x32_bf16 v[32:35], v[152:155], a[56:59], v[32:35]
    ds_read_b64_tr_b16 v[144:145], v187 offset:64
    ds_read_b64_tr_b16 v[146:147], v187 offset:960
    v_mfma_f32_16x16x32_bf16 v[36:39], v[152:155], a[120:123], v[36:39]
    v_mul_f32 v1, v1, v9
    v_mul_f32 v2, v2, v10
    v_mfma_f32_16x16x32_bf16 v[48:51], v[152:155], a[184:187], v[48:51]
    ds_read_b64_tr_b16 v[148:149], v187 offset:14528
    ds_read_b64_tr_b16 v[150:151], v187 offset:15424
    v_mfma_f32_16x16x32_bf16 v[52:55], v[152:155], a[248:251], v[52:55]
    buffer_load_dwordx4 v184, s[32:35], s73 offen offset:1024 lds
    v_mul_f32 v3, v3, v11
    s_waitcnt lgkmcnt(8)
    v_mfma_f32_16x16x32_bf16 v[40:43], v[156:159], a[56:59], v[40:43]
    ds_read_b64_tr_b16 v[152:153], v187 offset:3648
    ds_read_b64_tr_b16 v[154:155], v187 offset:4544
    v_mfma_f32_16x16x32_bf16 v[44:47], v[156:159], a[120:123], v[44:47]
    v_mul_f32 v4, v4, v12
    v_mul_f32 v5, v5, v13
    v_mfma_f32_16x16x32_bf16 v[56:59], v[156:159], a[184:187], v[56:59]
    v_mfma_f32_16x16x32_bf16 v[60:63], v[156:159], a[248:251], v[60:63]
    ds_read_b64_tr_b16 v[156:157], v187 offset:18112
    ds_read_b64_tr_b16 v[158:159], v187 offset:19008
    buffer_load_dwordx4 v185, s[32:35], s73 offen offset:2048 lds
    v_mul_f32 v6, v6, v14
    s_waitcnt lgkmcnt(8)
    v_mfma_f32_16x16x32_bf16 v[32:35], v[160:163], a[60:63], v[32:35]
    v_mul_f32 v7, v7, v15
    v_cvt_pk_bf16_f32 v8, v0, v1
    v_mfma_f32_16x16x32_bf16 v[36:39], v[160:163], a[124:127], v[36:39]
    v_cvt_pk_bf16_f32 v9, v2, v3
    v_cvt_pk_bf16_f32 v10, v4, v5
    v_mfma_f32_16x16x32_bf16 v[48:51], v[160:163], a[188:191], v[48:51]
    v_cvt_pk_bf16_f32 v11, v6, v7
    v_permlane16_swap_b32 v8, v10
    v_mfma_f32_16x16x32_bf16 v[52:55], v[160:163], a[252:255], v[52:55]
    v_permlane16_swap_b32 v9, v11
    buffer_store_dwordx4 v[8:11], v244, s[40:43], s68 offen sc1
    v_mfma_f32_16x16x32_bf16 v[40:43], v[164:167], a[60:63], v[40:43]
    buffer_load_dwordx4 v186, s[32:35], s73 offen offset:3072 lds
    v_mul_f32 v16, v16, v24
    v_mfma_f32_16x16x32_bf16 v[44:47], v[164:167], a[124:127], v[44:47]
    v_mul_f32 v17, v17, v25
    v_mul_f32 v18, v18, v26
    v_mfma_f32_16x16x32_bf16 v[56:59], v[164:167], a[188:191], v[56:59]
    v_mul_f32 v19, v19, v27
    v_mul_f32 v20, v20, v28
    v_mfma_f32_16x16x32_bf16 v[60:63], v[164:167], a[252:255], v[60:63]
    v_mul_f32 v21, v21, v29
    v_mul_f32 v22, v22, v30
    s_waitcnt lgkmcnt(0)
    v_mfma_f32_16x16x32_bf16 v[64:67], v[144:147], a[56:59], v[64:67]
    v_mul_f32 v23, v23, v31
    v_cvt_pk_bf16_f32 v24, v16, v17
    v_mfma_f32_16x16x32_bf16 v[68:71], v[144:147], a[120:123], v[68:71]
    v_cvt_pk_bf16_f32 v25, v18, v19
    v_cvt_pk_bf16_f32 v26, v20, v21
    v_mfma_f32_16x16x32_bf16 v[80:83], v[144:147], a[184:187], v[80:83]
    v_cvt_pk_bf16_f32 v27, v22, v23
    v_permlane16_swap_b32 v24, v26
    v_mfma_f32_16x16x32_bf16 v[84:87], v[144:147], a[248:251], v[84:87]
    v_permlane16_swap_b32 v25, v27
    buffer_store_dwordx4 v[24:27], v244, s[40:43], s69 offen sc1
    v_mfma_f32_16x16x32_bf16 v[72:75], v[148:151], a[56:59], v[72:75]
    v_bfe_i32 v239, v255, 4, 1
    v_bfi_b32 v96, v239, v100, v96
    v_mfma_f32_16x16x32_bf16 v[76:79], v[148:151], a[120:123], v[76:79]
    v_mul_f32 v96, s72, v96
    v_mfma_f32_16x16x32_bf16 v[88:91], v[148:151], a[184:187], v[88:91]
    v_exp_f32 v96, -v96
    s_nop 0
    v_add_f32 v96, 1.0, v96
    v_mfma_f32_16x16x32_bf16 v[92:95], v[148:151], a[248:251], v[92:95]
    v_mfma_f32_16x16x32_bf16 v[64:67], v[152:155], a[60:63], v[64:67]
    v_rcp_f32 v96, v96
    v_lshrrev_b32 v239, 5, v255
    v_mfma_f32_16x16x32_bf16 v[68:71], v[152:155], a[124:127], v[68:71]
    v_lshlrev_b32 v239, 31, v239
    v_mfma_f32_16x16x32_bf16 v[80:83], v[152:155], a[188:191], v[80:83]
    v_mfma_f32_16x16x32_bf16 v[84:87], v[152:155], a[252:255], v[84:87]
    s_waitcnt vmcnt(14)
    s_barrier
    ds_read_b64_tr_b16 v[160:161], v189 offset:0
    ds_read_b64_tr_b16 v[162:163], v189 offset:512
    v_mfma_f32_16x16x32_bf16 v[72:75], v[156:159], a[60:63], v[72:75]
    ds_read_b64_tr_b16 v[164:165], v190 offset:0
    ds_read_b64_tr_b16 v[166:167], v190 offset:512
    v_mfma_f32_16x16x32_bf16 v[76:79], v[156:159], a[124:127], v[76:79]
    s_add_u32 m0, s97, 32768
    s_nop 0
    buffer_load_dwordx4 v251, s[48:51], s77 offen lds
    v_mfma_f32_16x16x32_bf16 v[88:91], v[156:159], a[188:191], v[88:91]
    ds_read_b64_tr_b16 v[144:145], v189 offset:4096
    ds_read_b64_tr_b16 v[146:147], v189 offset:4608
    v_mfma_f32_16x16x32_bf16 v[92:95], v[156:159], a[252:255], v[92:95]
    v_lshl_add_u32 v239, v255, 2, v239
    buffer_store_dword v96, v239, s[40:43], s70 offen sc1
    s_waitcnt lgkmcnt(4)
    v_mfma_f32_16x16x32_bf16 v[112:115], v[160:163], a[0:3], 0
    ds_read_b64_tr_b16 v[148:149], v190 offset:4096
    ds_read_b64_tr_b16 v[150:151], v190 offset:4608
    v_mfma_f32_16x16x32_bf16 v[116:119], v[160:163], a[64:67], 0
    buffer_load_dwordx4 v252, s[48:51], s77 offen offset:1024 lds
    v_mul_f32 v32, v32, v40
    v_mfma_f32_16x16x32_bf16 v[120:123], v[160:163], a[128:131], 0
    ds_read_b64_tr_b16 v[152:153], v189 offset:8192
    ds_read_b64_tr_b16 v[154:155], v189 offset:8704
    v_mfma_f32_16x16x32_bf16 v[124:127], v[160:163], a[192:195], 0
    v_mul_f32 v33, v33, v41
    v_mul_f32 v34, v34, v42
    s_waitcnt lgkmcnt(6)
    v_mfma_f32_16x16x32_bf16 v[128:131], v[164:167], a[0:3], 0
    ds_read_b64_tr_b16 v[156:157], v190 offset:8192
    ds_read_b64_tr_b16 v[158:159], v190 offset:8704
    v_mfma_f32_16x16x32_bf16 v[132:135], v[164:167], a[64:67], 0
    buffer_load_dwordx4 v253, s[48:51], s77 offen offset:2048 lds
    v_mul_f32 v35, v35, v43
    v_mfma_f32_16x16x32_bf16 v[136:139], v[164:167], a[128:131], 0
    ds_read_b64_tr_b16 v[160:161], v189 offset:12288
    ds_read_b64_tr_b16 v[162:163], v189 offset:12800
    v_mfma_f32_16x16x32_bf16 v[140:143], v[164:167], a[192:195], 0
    v_mul_f32 v36, v36, v44
    v_mul_f32 v37, v37, v45
    s_waitcnt lgkmcnt(8)
    v_mfma_f32_16x16x32_bf16 v[112:115], v[144:147], a[4:7], v[112:115]
    ds_read_b64_tr_b16 v[164:165], v190 offset:12288
    ds_read_b64_tr_b16 v[166:167], v190 offset:12800
    v_mfma_f32_16x16x32_bf16 v[116:119], v[144:147], a[68:71], v[116:119]
    buffer_load_dwordx4 v254, s[48:51], s77 offen offset:3072 lds
    v_mul_f32 v38, v38, v46
    v_mfma_f32_16x16x32_bf16 v[120:123], v[144:147], a[132:135], v[120:123]
    v_mfma_f32_16x16x32_bf16 v[124:127], v[144:147], a[196:199], v[124:127]
    ds_read_b64_tr_b16 v[144:145], v189 offset:16384
    ds_read_b64_tr_b16 v[146:147], v189 offset:16896
    s_add_u32 m0, s97, 49152
    v_mul_f32 v39, v39, v47
    s_waitcnt lgkmcnt(8)
    v_mfma_f32_16x16x32_bf16 v[128:131], v[148:151], a[4:7], v[128:131]
    buffer_load_dwordx4 v251, s[48:51], s83 offen lds
    v_cvt_pk_bf16_f32 v40, v32, v33
    v_mfma_f32_16x16x32_bf16 v[132:135], v[148:151], a[68:71], v[132:135]
    v_cvt_pk_bf16_f32 v41, v34, v35
    v_cvt_pk_bf16_f32 v42, v36, v37
    v_mfma_f32_16x16x32_bf16 v[136:139], v[148:151], a[132:135], v[136:139]
    v_mfma_f32_16x16x32_bf16 v[140:143], v[148:151], a[196:199], v[140:143]
    ds_read_b64_tr_b16 v[148:149], v190 offset:16384
    ds_read_b64_tr_b16 v[150:151], v190 offset:16896
    v_cvt_pk_bf16_f32 v43, v38, v39
    v_permlane16_swap_b32 v40, v42
    v_mfma_f32_16x16x32_bf16 v[112:115], v[152:155], a[8:11], v[112:115]
    buffer_load_dwordx4 v252, s[48:51], s83 offen offset:1024 lds
    v_permlane16_swap_b32 v41, v43
    v_mfma_f32_16x16x32_bf16 v[116:119], v[152:155], a[72:75], v[116:119]
    buffer_store_dwordx4 v[40:43], v244, s[40:43], s68 offen offset:1024 sc1
    v_mul_f32 v48, v48, v56
    v_mfma_f32_16x16x32_bf16 v[120:123], v[152:155], a[136:139], v[120:123]
    v_mfma_f32_16x16x32_bf16 v[124:127], v[152:155], a[200:203], v[124:127]
    ds_read_b64_tr_b16 v[152:153], v189 offset:20480
    ds_read_b64_tr_b16 v[154:155], v189 offset:20992
    v_mul_f32 v49, v49, v57
    v_mul_f32 v50, v50, v58
    s_waitcnt lgkmcnt(4)
    v_mfma_f32_16x16x32_bf16 v[128:131], v[156:159], a[8:11], v[128:131]
    buffer_load_dwordx4 v253, s[48:51], s83 offen offset:2048 lds
    v_mul_f32 v51, v51, v59
    v_mfma_f32_16x16x32_bf16 v[132:135], v[156:159], a[72:75], v[132:135]
    v_mul_f32 v52, v52, v60
    v_mul_f32 v53, v53, v61
    v_mfma_f32_16x16x32_bf16 v[136:139], v[156:159], a[136:139], v[136:139]
    v_mfma_f32_16x16x32_bf16 v[140:143], v[156:159], a[200:203], v[140:143]
    ds_read_b64_tr_b16 v[156:157], v190 offset:20480
    ds_read_b64_tr_b16 v[158:159], v190 offset:20992
    v_mul_f32 v54, v54, v62
    v_mul_f32 v55, v55, v63
    v_mfma_f32_16x16x32_bf16 v[112:115], v[160:163], a[12:15], v[112:115]
    buffer_load_dwordx4 v254, s[48:51], s83 offen offset:3072 lds
    v_cvt_pk_bf16_f32 v56, v48, v49
    v_mfma_f32_16x16x32_bf16 v[116:119], v[160:163], a[76:79], v[116:119]
    v_cvt_pk_bf16_f32 v57, v50, v51
    v_cvt_pk_bf16_f32 v58, v52, v53
    v_mfma_f32_16x16x32_bf16 v[120:123], v[160:163], a[140:143], v[120:123]
    v_mfma_f32_16x16x32_bf16 v[124:127], v[160:163], a[204:207], v[124:127]
    ds_read_b64_tr_b16 v[160:161], v189 offset:24576
    ds_read_b64_tr_b16 v[162:163], v189 offset:25088
    s_add_u32 m0, s97, 65536
    v_cvt_pk_bf16_f32 v59, v54, v55
    v_mfma_f32_16x16x32_bf16 v[128:131], v[164:167], a[12:15], v[128:131]
    buffer_load_dwordx4 v251, s[52:55], s87 offen lds
    v_permlane16_swap_b32 v56, v58
    v_mfma_f32_16x16x32_bf16 v[132:135], v[164:167], a[76:79], v[132:135]
    v_permlane16_swap_b32 v57, v59
    buffer_store_dwordx4 v[56:59], v244, s[40:43], s69 offen offset:1024 sc1
    v_mul_f32 v64, v64, v72
    v_mfma_f32_16x16x32_bf16 v[136:139], v[164:167], a[140:143], v[136:139]
    v_mfma_f32_16x16x32_bf16 v[140:143], v[164:167], a[204:207], v[140:143]
    ds_read_b64_tr_b16 v[164:165], v190 offset:24576
    ds_read_b64_tr_b16 v[166:167], v190 offset:25088
    v_mul_f32 v65, v65, v73
    v_mul_f32 v66, v66, v74
    v_mul_f32 v67, v67, v75
    v_mfma_f32_16x16x32_bf16 v[112:115], v[144:147], a[16:19], v[112:115]
    buffer_load_dwordx4 v252, s[52:55], s87 offen offset:1024 lds
    v_mul_f32 v68, v68, v76
    v_mfma_f32_16x16x32_bf16 v[116:119], v[144:147], a[80:83], v[116:119]
    v_mul_f32 v69, v69, v77
    v_mul_f32 v70, v70, v78
    v_mul_f32 v71, v71, v79
    v_mfma_f32_16x16x32_bf16 v[120:123], v[144:147], a[144:147], v[120:123]
    v_mfma_f32_16x16x32_bf16 v[124:127], v[144:147], a[208:211], v[124:127]
    ds_read_b64_tr_b16 v[144:145], v189 offset:28672
    ds_read_b64_tr_b16 v[146:147], v189 offset:29184
    v_cvt_pk_bf16_f32 v72, v64, v65
    v_cvt_pk_bf16_f32 v73, v66, v67
    v_cvt_pk_bf16_f32 v74, v68, v69
    s_waitcnt lgkmcnt(4)
    v_mfma_f32_16x16x32_bf16 v[128:131], v[148:151], a[16:19], v[128:131]
    buffer_load_dwordx4 v253, s[52:55], s87 offen offset:2048 lds
    v_cvt_pk_bf16_f32 v75, v70, v71
    v_mfma_f32_16x16x32_bf16 v[132:135], v[148:151], a[80:83], v[132:135]
    v_permlane16_swap_b32 v72, v74
    v_permlane16_swap_b32 v73, v75
    buffer_store_dwordx4 v[72:75], v244, s[40:43], s68 offen offset:2048 sc1
    v_mfma_f32_16x16x32_bf16 v[136:139], v[148:151], a[144:147], v[136:139]
    v_mfma_f32_16x16x32_bf16 v[140:143], v[148:151], a[208:211], v[140:143]
    ds_read_b64_tr_b16 v[148:149], v190 offset:28672
    ds_read_b64_tr_b16 v[150:151], v190 offset:29184
    v_mul_f32 v80, v80, v88
    v_mul_f32 v81, v81, v89
    v_mul_f32 v82, v82, v90
    v_mfma_f32_16x16x32_bf16 v[112:115], v[152:155], a[20:23], v[112:115]
    buffer_load_dwordx4 v254, s[52:55], s87 offen offset:3072 lds
    v_mul_f32 v83, v83, v91
    v_mfma_f32_16x16x32_bf16 v[116:119], v[152:155], a[84:87], v[116:119]
    v_mul_f32 v84, v84, v92
    v_mul_f32 v85, v85, v93
    v_mul_f32 v86, v86, v94
    v_mfma_f32_16x16x32_bf16 v[120:123], v[152:155], a[148:151], v[120:123]
    s_add_u32 m0, s97, 81920
    v_mul_f32 v87, v87, v95
    v_mfma_f32_16x16x32_bf16 v[124:127], v[152:155], a[212:215], v[124:127]
    v_cvt_pk_bf16_f32 v88, v80, v81
    v_cvt_pk_bf16_f32 v89, v82, v83
    v_cvt_pk_bf16_f32 v90, v84, v85
    v_mfma_f32_16x16x32_bf16 v[128:131], v[156:159], a[20:23], v[128:131]
    buffer_load_dwordx4 v251, s[48:51], s78 offen lds
    v_cvt_pk_bf16_f32 v91, v86, v87
    v_mfma_f32_16x16x32_bf16 v[132:135], v[156:159], a[84:87], v[132:135]
    v_permlane16_swap_b32 v88, v90
    v_permlane16_swap_b32 v89, v91
    buffer_store_dwordx4 v[88:91], v244, s[40:43], s69 offen offset:2048 sc1
    v_mfma_f32_16x16x32_bf16 v[136:139], v[156:159], a[148:151], v[136:139]
    s_lshr_b32 s4, s76, 4
    s_lshr_b32 s5, s77, 4
    v_mfma_f32_16x16x32_bf16 v[140:143], v[156:159], a[212:215], v[140:143]
    s_lshr_b32 s6, s78, 4
    s_lshr_b32 s7, s79, 4
    s_lshr_b32 s8, s80, 4
    v_mfma_f32_16x16x32_bf16 v[112:115], v[160:163], a[24:27], v[112:115]
    buffer_load_dwordx4 v252, s[48:51], s78 offen offset:1024 lds
    s_lshr_b32 s9, s81, 4
    v_mfma_f32_16x16x32_bf16 v[116:119], v[160:163], a[88:91], v[116:119]
    s_lshr_b32 s10, s82, 4
    s_lshr_b32 s11, s83, 4
    s_lshr_b32 s12, s84, 4
    v_mfma_f32_16x16x32_bf16 v[120:123], v[160:163], a[152:155], v[120:123]
    s_lshr_b32 s13, s85, 4
    s_lshr_b32 s14, s86, 4
    v_mfma_f32_16x16x32_bf16 v[124:127], v[160:163], a[216:219], v[124:127]
    s_lshl_b32 s19, s98, 16
    s_add_u32 s19, s19, 5636096
    s_lshr_b32 s15, s87, 4
    s_waitcnt lgkmcnt(0)
    v_mfma_f32_16x16x32_bf16 v[128:131], v[164:167], a[24:27], v[128:131]
    buffer_load_dwordx4 v253, s[48:51], s78 offen offset:2048 lds
    s_add_u32 s15, s15, s19
    v_mfma_f32_16x16x32_bf16 v[132:135], v[164:167], a[88:91], v[132:135]
    s_lshr_b32 s16, s88, 4
    s_add_u32 s16, s16, s19
    s_lshr_b32 s17, s89, 4
    v_mfma_f32_16x16x32_bf16 v[136:139], v[164:167], a[152:155], v[136:139]
    s_add_u32 s17, s17, s19
    s_lshr_b32 s18, s90, 4
    v_mfma_f32_16x16x32_bf16 v[140:143], v[164:167], a[216:219], v[140:143]
    s_add_u32 s18, s18, s19
    s_lshl_b32 s19, s98, 12
    s_add_u32 s19, s19, 7815168
    v_mfma_f32_16x16x32_bf16 v[112:115], v[144:147], a[28:31], v[112:115]
    buffer_load_dwordx4 v254, s[48:51], s78 offen offset:3072 lds
    s_lshl_b32 s20, s98, 11
    v_mfma_f32_16x16x32_bf16 v[116:119], v[144:147], a[92:95], v[116:119]
    s_add_u32 s20, s20, 8011776
    s_lshl_b32 s21, s98, 8
    s_add_u32 s21, s21, 7733248
    v_mfma_f32_16x16x32_bf16 v[120:123], v[144:147], a[156:159], v[120:123]
    v_mfma_f32_16x16x32_bf16 v[124:127], v[144:147], a[220:223], v[124:127]
    s_waitcnt vmcnt(22)
    s_barrier
    ds_read_b64_tr_b16 v[152:153], v191 offset:0
    ds_read_b64_tr_b16 v[154:155], v191 offset:512
    s_lshl_b32 s23, s95, 2
    v_mfma_f32_16x16x32_bf16 v[128:131], v[148:151], a[28:31], v[128:131]
    ds_read_b64_tr_b16 v[156:157], v192 offset:0
    ds_read_b64_tr_b16 v[158:159], v192 offset:512
    v_mfma_f32_16x16x32_bf16 v[132:135], v[148:151], a[92:95], v[132:135]
    s_add_u32 m0, s97, 98304
    s_nop 0
    buffer_load_dwordx4 v251, s[48:51], s79 offen lds
    s_add_u32 s23, s23, s91
    v_mfma_f32_16x16x32_bf16 v[136:139], v[148:151], a[156:159], v[136:139]
    ds_read_b64_tr_b16 v[160:161], v191 offset:4096
    ds_read_b64_tr_b16 v[162:163], v191 offset:4608
    v_mfma_f32_16x16x32_bf16 v[140:143], v[148:151], a[220:223], v[140:143]
    s_lshl_b32 s22, s23, 11
    s_add_u32 s22, s22, 7946240
    s_mul_i32 s23, s23, 2176
    s_waitcnt lgkmcnt(4)
    v_mfma_f32_16x16x32_bf16 v[112:115], v[152:155], a[32:35], v[112:115]
    ds_read_b64_tr_b16 v[164:165], v192 offset:4096
    ds_read_b64_tr_b16 v[166:167], v192 offset:4608
    v_mfma_f32_16x16x32_bf16 v[116:119], v[152:155], a[96:99], v[116:119]
    buffer_load_dwordx4 v252, s[48:51], s79 offen offset:1024 lds
    s_add_u32 s23, s23, 7741440
    s_lshl_b32 s24, s94, 2
    v_mfma_f32_16x16x32_bf16 v[120:123], v[152:155], a[160:163], v[120:123]
    ds_read_b64_tr_b16 v[144:145], v191 offset:8192
    ds_read_b64_tr_b16 v[146:147], v191 offset:8704
    v_mfma_f32_16x16x32_bf16 v[124:127], v[152:155], a[224:227], v[124:127]
    s_lshl_b32 s25, s92, 1
    s_add_u32 s24, s24, s25
    s_add_u32 s24, s24, s93
    s_waitcnt lgkmcnt(6)
    v_mfma_f32_16x16x32_bf16 v[128:131], v[156:159], a[32:35], v[128:131]
    ds_read_b64_tr_b16 v[148:149], v192 offset:8192
    ds_read_b64_tr_b16 v[150:151], v192 offset:8704
    v_mfma_f32_16x16x32_bf16 v[132:135], v[156:159], a[96:99], v[132:135]
    buffer_load_dwordx4 v253, s[48:51], s79 offen offset:2048 lds
    s_lshl_b32 s24, s24, 15
    s_lshl_b32 s25, s95, 12
    v_mfma_f32_16x16x32_bf16 v[136:139], v[156:159], a[160:163], v[136:139]
    ds_read_b64_tr_b16 v[152:153], v191 offset:12288
    ds_read_b64_tr_b16 v[154:155], v191 offset:12800
    v_mfma_f32_16x16x32_bf16 v[140:143], v[156:159], a[224:227], v[140:143]
    s_add_u32 s24, s24, s25
    s_lshl_b32 s25, s93, 11
    s_add_u32 s24, s24, s25
    s_waitcnt lgkmcnt(8)
    v_mfma_f32_16x16x32_bf16 v[112:115], v[160:163], a[36:39], v[112:115]
    ds_read_b64_tr_b16 v[156:157], v192 offset:12288
    ds_read_b64_tr_b16 v[158:159], v192 offset:12800
    v_mfma_f32_16x16x32_bf16 v[116:119], v[160:163], a[100:103], v[116:119]
    buffer_load_dwordx4 v254, s[48:51], s79 offen offset:3072 lds
    s_xor_b32 s25, s24, 0x8000
    s_add_u32 s24, s24, 5636096
    v_mfma_f32_16x16x32_bf16 v[120:123], v[160:163], a[164:167], v[120:123]
    v_mfma_f32_16x16x32_bf16 v[124:127], v[160:163], a[228:231], v[124:127]
    ds_read_b64_tr_b16 v[160:161], v191 offset:16384
    ds_read_b64_tr_b16 v[162:163], v191 offset:16896
    s_add_u32 m0, s97, 114688
    s_add_u32 s25, s25, 5636096
    s_lshl_b32 s26, s94, 1
    s_waitcnt lgkmcnt(6)
    v_mfma_f32_16x16x32_bf16 v[128:131], v[164:167], a[36:39], v[128:131]
    buffer_load_dwordx4 v251, s[48:51], s80 offen lds
    s_add_u32 s26, s26, s92
    v_mfma_f32_16x16x32_bf16 v[132:135], v[164:167], a[100:103], v[132:135]
    s_lshl_b32 s26, s26, 3
    s_add_u32 s26, s26, s95
    s_lshl_b32 s26, s26, 1
    v_mfma_f32_16x16x32_bf16 v[136:139], v[164:167], a[164:167], v[136:139]
    v_mfma_f32_16x16x32_bf16 v[140:143], v[164:167], a[228:231], v[140:143]
    ds_read_b64_tr_b16 v[164:165], v192 offset:16384
    ds_read_b64_tr_b16 v[166:167], v192 offset:16896
    s_add_u32 s26, s26, s93
    s_lshl_b32 s26, s26, 7
    s_add_u32 s26, s26, 8011776
    v_mfma_f32_16x16x32_bf16 v[112:115], v[144:147], a[40:43], v[112:115]
    buffer_load_dwordx4 v252, s[48:51], s80 offen offset:1024 lds
    v_mfma_f32_16x16x32_bf16 v[116:119], v[144:147], a[104:107], v[116:119]
    v_mfma_f32_16x16x32_bf16 v[120:123], v[144:147], a[168:171], v[120:123]
    v_mfma_f32_16x16x32_bf16 v[124:127], v[144:147], a[232:235], v[124:127]
    ds_read_b64_tr_b16 v[144:145], v191 offset:20480
    ds_read_b64_tr_b16 v[146:147], v191 offset:20992
    v_mfma_f32_16x16x32_bf16 v[128:131], v[148:151], a[40:43], v[128:131]
    buffer_load_dwordx4 v253, s[48:51], s80 offen offset:2048 lds
    s_waitcnt vmcnt(10)
    v_mfma_f32_16x16x32_bf16 v[132:135], v[148:151], a[104:107], v[132:135]
    buffer_store_dword v243, v237, s[40:43], s75 offen sc1
    v_mfma_f32_16x16x32_bf16 v[136:139], v[148:151], a[168:171], v[136:139]
    v_mfma_f32_16x16x32_bf16 v[140:143], v[148:151], a[232:235], v[140:143]
    ds_read_b64_tr_b16 v[148:149], v192 offset:20480
    ds_read_b64_tr_b16 v[150:151], v192 offset:20992
    s_waitcnt lgkmcnt(4)
    v_mfma_f32_16x16x32_bf16 v[112:115], v[152:155], a[44:47], v[112:115]
    buffer_load_dwordx4 v254, s[48:51], s80 offen offset:3072 lds
    v_mfma_f32_16x16x32_bf16 v[116:119], v[152:155], a[108:111], v[116:119]
    v_mfma_f32_16x16x32_bf16 v[120:123], v[152:155], a[172:175], v[120:123]
    v_mfma_f32_16x16x32_bf16 v[124:127], v[152:155], a[236:239], v[124:127]
    ds_read_b64_tr_b16 v[152:153], v191 offset:24576
    ds_read_b64_tr_b16 v[154:155], v191 offset:25088
    v_mfma_f32_16x16x32_bf16 v[128:131], v[156:159], a[44:47], v[128:131]
    v_mfma_f32_16x16x32_bf16 v[132:135], v[156:159], a[108:111], v[132:135]
    v_mfma_f32_16x16x32_bf16 v[136:139], v[156:159], a[172:175], v[136:139]
    v_mfma_f32_16x16x32_bf16 v[140:143], v[156:159], a[236:239], v[140:143]
    ds_read_b64_tr_b16 v[156:157], v192 offset:24576
    ds_read_b64_tr_b16 v[158:159], v192 offset:25088
    v_mfma_f32_16x16x32_bf16 v[112:115], v[160:163], a[48:51], v[112:115]
    v_mfma_f32_16x16x32_bf16 v[116:119], v[160:163], a[112:115], v[116:119]
    v_mfma_f32_16x16x32_bf16 v[120:123], v[160:163], a[176:179], v[120:123]
    v_mfma_f32_16x16x32_bf16 v[124:127], v[160:163], a[240:243], v[124:127]
    ds_read_b64_tr_b16 v[160:161], v191 offset:28672
    ds_read_b64_tr_b16 v[162:163], v191 offset:29184
    v_mfma_f32_16x16x32_bf16 v[128:131], v[164:167], a[48:51], v[128:131]
    v_add_u32 v245, 0x20000, v245
    v_add_u32 v246, 0x20000, v246
    v_mfma_f32_16x16x32_bf16 v[132:135], v[164:167], a[112:115], v[132:135]
    v_add_u32 v247, 0x20000, v247
    v_add_u32 v248, 0x20000, v248
    v_mfma_f32_16x16x32_bf16 v[136:139], v[164:167], a[176:179], v[136:139]
    v_mfma_f32_16x16x32_bf16 v[140:143], v[164:167], a[240:243], v[140:143]
    ds_read_b64_tr_b16 v[164:165], v192 offset:28672
    ds_read_b64_tr_b16 v[166:167], v192 offset:29184
    ds_read_b64_tr_b16 a[0:1], v245 offset:0
    ds_read_b64_tr_b16 a[2:3], v245 offset:512
    ds_read_b64_tr_b16 a[64:65], v246 offset:0
    s_waitcnt lgkmcnt(7)
    v_mfma_f32_16x16x32_bf16 v[112:115], v[144:147], a[52:55], v[112:115]
    ds_read_b64_tr_b16 a[66:67], v246 offset:512
    ds_read_b64_tr_b16 a[128:129], v247 offset:0
    v_mfma_f32_16x16x32_bf16 v[116:119], v[144:147], a[116:119], v[116:119]
    ds_read_b64_tr_b16 a[130:131], v247 offset:512
    ds_read_b64_tr_b16 a[192:193], v248 offset:0
    ds_read_b64_tr_b16 a[194:195], v248 offset:512
    v_mfma_f32_16x16x32_bf16 v[120:123], v[144:147], a[180:183], v[120:123]
    s_waitcnt lgkmcnt(0)
    s_add_u32 m0, s97, 131072
    v_mfma_f32_16x16x32_bf16 v[124:127], v[144:147], a[244:247], v[124:127]
    buffer_load_dwordx4 v251, s[48:51], s81 offen lds
    buffer_load_dwordx4 v252, s[48:51], s81 offen offset:1024 lds
    buffer_load_dwordx4 v253, s[48:51], s81 offen offset:2048 lds
    v_mfma_f32_16x16x32_bf16 v[128:131], v[148:151], a[52:55], v[128:131]
    buffer_load_dwordx4 v254, s[48:51], s81 offen offset:3072 lds
    v_add_u32 v245, 0xfffe0000, v245
    v_mfma_f32_16x16x32_bf16 v[132:135], v[148:151], a[116:119], v[132:135]
    v_add_u32 v246, 0xfffe0000, v246
    v_add_u32 v247, 0xfffe0000, v247
    v_add_u32 v248, 0xfffe0000, v248
    v_mfma_f32_16x16x32_bf16 v[136:139], v[148:151], a[180:183], v[136:139]
    ds_read_b64_tr_b16 a[4:5], v245 offset:32768
    v_mfma_f32_16x16x32_bf16 v[140:143], v[148:151], a[244:247], v[140:143]
    ds_read_b64_tr_b16 a[6:7], v245 offset:33280
    ds_read_b64_tr_b16 a[68:69], v246 offset:32768
    ds_read_b64_tr_b16 a[70:71], v246 offset:33280
    v_mfma_f32_16x16x32_bf16 v[112:115], v[152:155], a[56:59], v[112:115]
    ds_read_b64_tr_b16 a[132:133], v247 offset:32768
    ds_read_b64_tr_b16 a[134:135], v247 offset:33280
    v_mfma_f32_16x16x32_bf16 v[116:119], v[152:155], a[120:123], v[116:119]
    ds_read_b64_tr_b16 a[196:197], v248 offset:32768
    ds_read_b64_tr_b16 a[198:199], v248 offset:33280
    v_mfma_f32_16x16x32_bf16 v[120:123], v[152:155], a[184:187], v[120:123]
    v_mfma_f32_16x16x32_bf16 v[124:127], v[152:155], a[248:251], v[124:127]
    v_mfma_f32_16x16x32_bf16 v[128:131], v[156:159], a[56:59], v[128:131]
    v_mfma_f32_16x16x32_bf16 v[132:135], v[156:159], a[120:123], v[132:135]
    v_mfma_f32_16x16x32_bf16 v[136:139], v[156:159], a[184:187], v[136:139]
    v_mfma_f32_16x16x32_bf16 v[140:143], v[156:159], a[248:251], v[140:143]
    v_mfma_f32_16x16x32_bf16 v[112:115], v[160:163], a[60:63], v[112:115]
    v_mfma_f32_16x16x32_bf16 v[116:119], v[160:163], a[124:127], v[116:119]
    v_mfma_f32_16x16x32_bf16 v[120:123], v[160:163], a[188:191], v[120:123]
    v_mfma_f32_16x16x32_bf16 v[124:127], v[160:163], a[252:255], v[124:127]
    s_waitcnt lgkmcnt(0)
    s_barrier
    v_mfma_f32_16x16x32_bf16 v[128:131], v[164:167], a[60:63], v[128:131]
    v_mfma_f32_16x16x32_bf16 v[132:135], v[164:167], a[124:127], v[132:135]
    v_mfma_f32_16x16x32_bf16 v[136:139], v[164:167], a[188:191], v[136:139]
    v_mfma_f32_16x16x32_bf16 v[140:143], v[164:167], a[252:255], v[140:143]
    v_cvt_pk_bf16_f32 v32, v112, v113
    s_add_u32 m0, s97, 0
    s_nop 0
    buffer_load_dwordx4 v251, s[48:51], s82 offen lds
    v_cvt_pk_bf16_f32 v33, v114, v115
    v_cvt_pk_bf16_f32 v34, v116, v117
    v_cvt_pk_bf16_f32 v35, v118, v119
    v_cvt_pk_bf16_f32 v36, v120, v121
    v_cvt_pk_bf16_f32 v37, v122, v123
    v_cvt_pk_bf16_f32 v38, v124, v125
    v_cvt_pk_bf16_f32 v39, v126, v127
    v_permlane16_swap_b32 v32, v34
    v_permlane16_swap_b32 v33, v35
    v_permlane16_swap_b32 v36, v38
    v_permlane16_swap_b32 v37, v39
    v_mfma_f32_32x32x16_bf16 v[0:15], v[168:171], v[32:35], 0
    s_nop 0
    v_mfma_f32_32x32x16_bf16 v[16:31], v[168:171], v[36:39], 0
    buffer_load_dwordx4 v252, s[48:51], s82 offen offset:1024 lds
    s_nop 8
    v_max3_f32 v40, v0, v1, v2
    v_max3_f32 v42, v3, v4, v5
    v_max3_f32 v40, v40, v6, v7
    v_max3_f32 v42, v42, v8, v9
    v_max3_f32 v40, v40, v10, v11
    v_max3_f32 v42, v42, v12, v13
    v_max3_f32 v40, v40, v14, v15
    v_max_f32 v40, v40, v42
    v_mul_f32 v40, s72, v40
    v_pk_fma_f32 v[0:1], v[0:1], s[72:73], v[40:41] op_sel_hi:[1,0,0] neg_lo:[0,0,1] neg_hi:[0,0,1]
    v_pk_fma_f32 v[2:3], v[2:3], s[72:73], v[40:41] op_sel_hi:[1,0,0] neg_lo:[0,0,1] neg_hi:[0,0,1]
    v_pk_fma_f32 v[4:5], v[4:5], s[72:73], v[40:41] op_sel_hi:[1,0,0] neg_lo:[0,0,1] neg_hi:[0,0,1]
    v_cvt_pk_bf16_f32 v32, v128, v129
    v_cvt_pk_bf16_f32 v33, v130, v131
    v_cvt_pk_bf16_f32 v34, v132, v133
    buffer_load_dwordx4 v253, s[48:51], s82 offen offset:2048 lds
    v_cvt_pk_bf16_f32 v35, v134, v135
    v_pk_fma_f32 v[6:7], v[6:7], s[72:73], v[40:41] op_sel_hi:[1,0,0] neg_lo:[0,0,1] neg_hi:[0,0,1]
    v_pk_fma_f32 v[8:9], v[8:9], s[72:73], v[40:41] op_sel_hi:[1,0,0] neg_lo:[0,0,1] neg_hi:[0,0,1]
    v_pk_fma_f32 v[10:11], v[10:11], s[72:73], v[40:41] op_sel_hi:[1,0,0] neg_lo:[0,0,1] neg_hi:[0,0,1]
    v_pk_fma_f32 v[12:13], v[12:13], s[72:73], v[40:41] op_sel_hi:[1,0,0] neg_lo:[0,0,1] neg_hi:[0,0,1]
    v_pk_fma_f32 v[14:15], v[14:15], s[72:73], v[40:41] op_sel_hi:[1,0,0] neg_lo:[0,0,1] neg_hi:[0,0,1]
    v_exp_f32 v0, v0
    v_exp_f32 v1, v1
    v_exp_f32 v2, v2
    v_permlane16_swap_b32 v32, v34
    v_permlane16_swap_b32 v33, v35
    v_exp_f32 v3, v3
    buffer_load_dwordx4 v254, s[48:51], s82 offen offset:3072 lds
    s_add_u32 m0, s97, 16384
    v_exp_f32 v4, v4
    v_exp_f32 v5, v5
    v_pk_add_f32 v[42:43], v[0:1], v[2:3]
L_pad_qg_2:
    s_cbranch_execz L_walked_qg
    v_exp_f32 v6, v6
    v_exp_f32 v7, v7
    v_pk_add_f32 v[42:43], v[42:43], v[4:5]
    v_exp_f32 v8, v8
    v_exp_f32 v9, v9
    buffer_load_dwordx4 v251, s[48:51], s84 offen lds
    v_pk_add_f32 v[42:43], v[42:43], v[6:7]
    v_exp_f32 v10, v10
    v_exp_f32 v11, v11
    v_pk_add_f32 v[42:43], v[42:43], v[8:9]
    v_exp_f32 v12, v12
    v_exp_f32 v13, v13
    v_pk_add_f32 v[42:43], v[42:43], v[10:11]
    v_exp_f32 v14, v14
    v_exp_f32 v15, v15
    buffer_load_dwordx4 v252, s[48:51], s84 offen offset:1024 lds
    v_pk_add_f32 v[42:43], v[42:43], v[12:13]
    v_pk_add_f32 v[42:43], v[42:43], v[14:15]
    v_add_f32 v42, v42, v43
    v_rcp_f32 v42, v42
    s_nop 0
    v_pk_mul_f32 v[0:1], v[0:1], v[42:43] op_sel_hi:[1,0]
    v_cvt_pk_bf16_f32 v112, v0, v1
    v_pk_mul_f32 v[2:3], v[2:3], v[42:43] op_sel_hi:[1,0]
    v_cvt_pk_bf16_f32 v113, v2, v3
    v_pk_mul_f32 v[4:5], v[4:5], v[42:43] op_sel_hi:[1,0]
    v_cvt_pk_bf16_f32 v114, v4, v5
    v_pk_mul_f32 v[6:7], v[6:7], v[42:43] op_sel_hi:[1,0]
    v_cvt_pk_bf16_f32 v115, v6, v7
    v_pk_mul_f32 v[8:9], v[8:9], v[42:43] op_sel_hi:[1,0]
    v_cvt_pk_bf16_f32 v116, v8, v9
    buffer_load_dwordx4 v253, s[48:51], s84 offen offset:2048 lds
    v_pk_mul_f32 v[10:11], v[10:11], v[42:43] op_sel_hi:[1,0]
    v_cvt_pk_bf16_f32 v117, v10, v11
    v_pk_mul_f32 v[12:13], v[12:13], v[42:43] op_sel_hi:[1,0]
    v_cvt_pk_bf16_f32 v118, v12, v13
    v_pk_mul_f32 v[14:15], v[14:15], v[42:43] op_sel_hi:[1,0]
    v_cvt_pk_bf16_f32 v119, v14, v15
    v_mfma_f32_32x32x16_bf16 v[0:15], v[172:175], v[32:35], 0
    buffer_load_dword v241, v235, s[40:43], s22 offen sc1
    v_max3_f32 v40, v16, v17, v18
    buffer_load_dwordx4 v254, s[48:51], s84 offen offset:3072 lds
    v_max3_f32 v42, v19, v20, v21
    ds_read_b64_tr_b16 a[28:29], v245 offset:49152
    v_max3_f32 v40, v40, v22, v23
    ds_read_b64_tr_b16 a[30:31], v245 offset:49664
    ds_read_b64_tr_b16 a[92:93], v246 offset:49152
    v_max3_f32 v42, v42, v24, v25
    ds_read_b64_tr_b16 a[94:95], v246 offset:49664
    ds_read_b64_tr_b16 a[156:157], v247 offset:49152
    v_max3_f32 v40, v40, v26, v27
    ds_read_b64_tr_b16 a[158:159], v247 offset:49664
    ds_read_b64_tr_b16 a[220:221], v248 offset:49152
    v_max3_f32 v42, v42, v28, v29
    ds_read_b64_tr_b16 a[222:223], v248 offset:49664
    s_add_u32 m0, s97, 32768
    v_max3_f32 v40, v40, v30, v31
    buffer_load_dwordx4 v251, s[48:51], s85 offen lds
    v_max_f32 v40, v40, v42
    v_mul_f32 v40, s72, v40
    v_pk_fma_f32 v[16:17], v[16:17], s[72:73], v[40:41] op_sel_hi:[1,0,0] neg_lo:[0,0,1] neg_hi:[0,0,1]
    v_pk_fma_f32 v[18:19], v[18:19], s[72:73], v[40:41] op_sel_hi:[1,0,0] neg_lo:[0,0,1] neg_hi:[0,0,1]
    v_pk_fma_f32 v[20:21], v[20:21], s[72:73], v[40:41] op_sel_hi:[1,0,0] neg_lo:[0,0,1] neg_hi:[0,0,1]
    v_cvt_pk_bf16_f32 v36, v136, v137
    v_cvt_pk_bf16_f32 v37, v138, v139
    v_cvt_pk_bf16_f32 v38, v140, v141
    v_cvt_pk_bf16_f32 v39, v142, v143
    v_pk_fma_f32 v[22:23], v[22:23], s[72:73], v[40:41] op_sel_hi:[1,0,0] neg_lo:[0,0,1] neg_hi:[0,0,1]
    v_pk_fma_f32 v[24:25], v[24:25], s[72:73], v[40:41] op_sel_hi:[1,0,0] neg_lo:[0,0,1] neg_hi:[0,0,1]
    v_pk_fma_f32 v[26:27], v[26:27], s[72:73], v[40:41] op_sel_hi:[1,0,0] neg_lo:[0,0,1] neg_hi:[0,0,1]
    v_pk_fma_f32 v[28:29], v[28:29], s[72:73], v[40:41] op_sel_hi:[1,0,0] neg_lo:[0,0,1] neg_hi:[0,0,1]
    v_pk_fma_f32 v[30:31], v[30:31], s[72:73], v[40:41] op_sel_hi:[1,0,0] neg_lo:[0,0,1] neg_hi:[0,0,1]
    v_exp_f32 v16, v16
    buffer_load_dwordx4 v252, s[48:51], s85 offen offset:1024 lds
    v_exp_f32 v17, v17
    v_exp_f32 v18, v18
    v_permlane16_swap_b32 v36, v38
    v_permlane16_swap_b32 v37, v39
    v_exp_f32 v19, v19
    v_exp_f32 v20, v20
    v_exp_f32 v21, v21
    v_pk_add_f32 v[42:43], v[16:17], v[18:19]
    v_exp_f32 v22, v22
    buffer_load_dwordx4 v253, s[48:51], s85 offen offset:2048 lds
    v_exp_f32 v23, v23
    v_pk_add_f32 v[42:43], v[42:43], v[20:21]
    v_exp_f32 v24, v24
    v_exp_f32 v25, v25
    v_pk_add_f32 v[42:43], v[42:43], v[22:23]
    v_exp_f32 v26, v26
    v_exp_f32 v27, v27
    v_pk_add_f32 v[42:43], v[42:43], v[24:25]
    v_exp_f32 v28, v28
    buffer_load_dwordx4 v254, s[48:51], s85 offen offset:3072 lds
    s_waitcnt lgkmcnt(0)
    v_exp_f32 v29, v29
    v_add_u32 v245, 0x10000, v245
    v_add_u32 v246, 0x10000, v246
    v_pk_add_f32 v[42:43], v[42:43], v[26:27]
    v_add_u32 v247, 0x10000, v247
    v_add_u32 v248, 0x10000, v248
    v_exp_f32 v30, v30
    ds_read_b64_tr_b16 a[44:45], v245 offset:0
    v_exp_f32 v31, v31
    ds_read_b64_tr_b16 a[46:47], v245 offset:512
    ds_read_b64_tr_b16 a[108:109], v246 offset:0
    v_pk_add_f32 v[42:43], v[42:43], v[28:29]
    ds_read_b64_tr_b16 a[110:111], v246 offset:512
    ds_read_b64_tr_b16 a[172:173], v247 offset:0
    v_pk_add_f32 v[42:43], v[42:43], v[30:31]
    ds_read_b64_tr_b16 a[174:175], v247 offset:512
    ds_read_b64_tr_b16 a[236:237], v248 offset:0
    v_add_f32 v42, v42, v43
    ds_read_b64_tr_b16 a[238:239], v248 offset:512
    s_add_u32 m0, s97, 49152
    v_rcp_f32 v42, v42
    buffer_load_dwordx4 v251, s[48:51], s86 offen lds
    v_pk_mul_f32 v[16:17], v[16:17], v[42:43] op_sel_hi:[1,0]
    v_cvt_pk_bf16_f32 v120, v16, v17
    v_pk_mul_f32 v[18:19], v[18:19], v[42:43] op_sel_hi:[1,0]
    v_cvt_pk_bf16_f32 v121, v18, v19
    v_pk_mul_f32 v[20:21], v[20:21], v[42:43] op_sel_hi:[1,0]
    v_cvt_pk_bf16_f32 v122, v20, v21
    v_pk_mul_f32 v[22:23], v[22:23], v[42:43] op_sel_hi:[1,0]
    v_cvt_pk_bf16_f32 v123, v22, v23
    v_pk_mul_f32 v[24:25], v[24:25], v[42:43] op_sel_hi:[1,0]
    v_cvt_pk_bf16_f32 v124, v24, v25
    v_pk_mul_f32 v[26:27], v[26:27], v[42:43] op_sel_hi:[1,0]
    v_cvt_pk_bf16_f32 v125, v26, v27
    v_pk_mul_f32 v[28:29], v[28:29], v[42:43] op_sel_hi:[1,0]
    v_cvt_pk_bf16_f32 v126, v28, v29
    v_pk_mul_f32 v[30:31], v[30:31], v[42:43] op_sel_hi:[1,0]
    buffer_load_dwordx4 v252, s[48:51], s86 offen offset:1024 lds
    v_cvt_pk_bf16_f32 v127, v30, v31
    v_mfma_f32_32x32x16_bf16 v[16:31], v[172:175], v[36:39], 0
    s_waitcnt vmcnt(7)
    v_cmp_ne_u32 vcc, v243, v241
    s_mov_b32 s101, 65536
    s_nop 3
    s_cbranch_vccz L_ok7
L_spin7:
    buffer_load_dword v241, v235, s[40:43], s22 offen sc1
    s_sub_u32 s101, s101, 1
    s_cmp_eq_u32 s101, 0
    s_cbranch_scc1 L_ok7
    s_waitcnt vmcnt(0)
    v_cmp_ne_u32 vcc, v243, v241
    s_nop 4
    s_cbranch_vccnz L_spin7
L_ok7:
    buffer_load_dwordx4 v[44:47], v244, s[40:43], s23 offen sc1
    buffer_load_dwordx4 v[48:51], v244, s[40:43], s23 offen offset:1024 sc1
    buffer_load_dwordx4 v[52:55], v244, s[40:43], s23 offen offset:2048 sc1
    v_max3_f32 v40, v0, v1, v2
    buffer_load_dwordx4 v253, s[48:51], s86 offen offset:2048 lds
    v_max3_f32 v42, v3, v4, v5
    v_max3_f32 v40, v40, v6, v7
    v_max3_f32 v42, v42, v8, v9
    v_max3_f32 v40, v40, v10, v11
    v_max3_f32 v42, v42, v12, v13
    v_max3_f32 v40, v40, v14, v15
    v_max_f32 v40, v40, v42
    v_mul_f32 v40, s72, v40
    v_pk_fma_f32 v[0:1], v[0:1], s[72:73], v[40:41] op_sel_hi:[1,0,0] neg_lo:[0,0,1] neg_hi:[0,0,1]
    v_pk_fma_f32 v[2:3], v[2:3], s[72:73], v[40:41] op_sel_hi:[1,0,0] neg_lo:[0,0,1] neg_hi:[0,0,1]
    v_pk_fma_f32 v[4:5], v[4:5], s[72:73], v[40:41] op_sel_hi:[1,0,0] neg_lo:[0,0,1] neg_hi:[0,0,1]
    v_pk_fma_f32 v[6:7], v[6:7], s[72:73], v[40:41] op_sel_hi:[1,0,0] neg_lo:[0,0,1] neg_hi:[0,0,1]
    v_pk_fma_f32 v[8:9], v[8:9], s[72:73], v[40:41] op_sel_hi:[1,0,0] neg_lo:[0,0,1] neg_hi:[0,0,1]
    v_pk_fma_f32 v[10:11], v[10:11], s[72:73], v[40:41] op_sel_hi:[1,0,0] neg_lo:[0,0,1] neg_hi:[0,0,1]
    v_pk_fma_f32 v[12:13], v[12:13], s[72:73], v[40:41] op_sel_hi:[1,0,0] neg_lo:[0,0,1] neg_hi:[0,0,1]
    buffer_load_dwordx4 v254, s[48:51], s86 offen offset:3072 lds
    s_waitcnt lgkmcnt(0)
    v_pk_fma_f32 v[14:15], v[14:15], s[72:73], v[40:41] op_sel_hi:[1,0,0] neg_lo:[0,0,1] neg_hi:[0,0,1]
    ds_read_b64_tr_b16 a[8:9], v245 offset:16384
    v_exp_f32 v0, v0
    ds_read_b64_tr_b16 a[10:11], v245 offset:16896
    ds_read_b64_tr_b16 a[72:73], v246 offset:16384
    v_exp_f32 v1, v1
    ds_read_b64_tr_b16 a[74:75], v246 offset:16896
    ds_read_b64_tr_b16 a[136:137], v247 offset:16384
    v_exp_f32 v2, v2
    ds_read_b64_tr_b16 a[138:139], v247 offset:16896
    ds_read_b64_tr_b16 a[200:201], v248 offset:16384
    v_exp_f32 v3, v3
    ds_read_b64_tr_b16 a[202:203], v248 offset:16896
    s_add_u32 m0, s97, 65536
    v_exp_f32 v4, v4
    buffer_load_dwordx4 v251, s[52:55], s88 offen lds
    v_exp_f32 v5, v5
    v_pk_add_f32 v[42:43], v[0:1], v[2:3]
    v_exp_f32 v6, v6
    v_exp_f32 v7, v7
    v_pk_add_f32 v[42:43], v[42:43], v[4:5]
    v_exp_f32 v8, v8
    v_exp_f32 v9, v9
    v_pk_add_f32 v[42:43], v[42:43], v[6:7]
    v_exp_f32 v10, v10
    buffer_load_dwordx4 v252, s[52:55], s88 offen offset:1024 lds
    v_exp_f32 v11, v11
    v_pk_add_f32 v[42:43], v[42:43], v[8:9]
    v_exp_f32 v12, v12
    v_exp_f32 v13, v13
    v_pk_add_f32 v[42:43], v[42:43], v[10:11]
    v_exp_f32 v14, v14
    v_exp_f32 v15, v15
    v_pk_add_f32 v[42:43], v[42:43], v[12:13]
    v_pk_add_f32 v[42:43], v[42:43], v[14:15]
    v_add_f32 v42, v42, v43
    buffer_load_dwordx4 v253, s[52:55], s88 offen offset:2048 lds
    v_rcp_f32 v42, v42
    s_nop 0
    v_pk_mul_f32 v[0:1], v[0:1], v[42:43] op_sel_hi:[1,0]
    v_cvt_pk_bf16_f32 v96, v0, v1
    v_pk_mul_f32 v[2:3], v[2:3], v[42:43] op_sel_hi:[1,0]
    v_cvt_pk_bf16_f32 v97, v2, v3
    v_pk_mul_f32 v[4:5], v[4:5], v[42:43] op_sel_hi:[1,0]
    v_cvt_pk_bf16_f32 v98, v4, v5
    v_pk_mul_f32 v[6:7], v[6:7], v[42:43] op_sel_hi:[1,0]
    v_cvt_pk_bf16_f32 v99, v6, v7
    v_pk_mul_f32 v[8:9], v[8:9], v[42:43] op_sel_hi:[1,0]
    v_cvt_pk_bf16_f32 v100, v8, v9
    v_pk_mul_f32 v[10:11], v[10:11], v[42:43] op_sel_hi:[1,0]
    v_cvt_pk_bf16_f32 v101, v10, v11
    v_pk_mul_f32 v[12:13], v[12:13], v[42:43] op_sel_hi:[1,0]
    buffer_load_dwordx4 v254, s[52:55], s88 offen offset:3072 lds
    s_waitcnt lgkmcnt(0)
    v_cvt_pk_bf16_f32 v102, v12, v13
    ds_read_b64_tr_b16 a[12:13], v245 offset:32768
    v_pk_mul_f32 v[14:15], v[14:15], v[42:43] op_sel_hi:[1,0]
    ds_read_b64_tr_b16 a[14:15], v245 offset:33280
    ds_read_b64_tr_b16 a[76:77], v246 offset:32768
    v_cvt_pk_bf16_f32 v103, v14, v15
    ds_read_b64_tr_b16 a[78:79], v246 offset:33280
    ds_read_b64_tr_b16 a[140:141], v247 offset:32768
    s_waitcnt vmcnt(8)
    v_cvt_pk_bf16_f32 v44, v44, v45
    v_cvt_pk_bf16_f32 v45, v46, v47
    ds_write_b64 v230, v[44:45] offset:0
    s_waitcnt vmcnt(7)
    v_cvt_pk_bf16_f32 v48, v48, v49
    v_cvt_pk_bf16_f32 v49, v50, v51
    ds_write_b64 v230, v[48:49] offset:512
    s_waitcnt vmcnt(6)
    v_cvt_pk_bf16_f32 v52, v52, v53
    v_cvt_pk_bf16_f32 v53, v54, v55
    ds_write_b64 v230, v[52:53] offset:1024
    s_waitcnt lgkmcnt(0)
    s_barrier
    ds_read_b128 v[56:59], v231 offset:0
    ds_read_b128 v[60:63], v231 offset:16
    ds_read_b128 v[64:67], v231 offset:1536
    ds_read_b128 v[68:71], v231 offset:1552
    buffer_load_dword v239, v235, s[40:43], s19 offen offset:2048 sc1
    v_max3_f32 v40, v16, v17, v18
    ds_read_b64_tr_b16 a[142:143], v247 offset:33280
    ds_read_b64_tr_b16 a[204:205], v248 offset:32768
    v_max3_f32 v42, v19, v20, v21
    ds_read_b64_tr_b16 a[206:207], v248 offset:33280
    s_add_u32 m0, s97, 81920
    v_max3_f32 v40, v40, v22, v23
    buffer_load_dwordx4 v251, s[52:55], s89 offen lds
    v_max3_f32 v42, v42, v24, v25
    v_max3_f32 v40, v40, v26, v27
    v_max3_f32 v42, v42, v28, v29
    v_max3_f32 v40, v40, v30, v31
    v_max_f32 v40, v40, v42
    v_mul_f32 v40, s72, v40
    v_pk_fma_f32 v[16:17], v[16:17], s[72:73], v[40:41] op_sel_hi:[1,0,0] neg_lo:[0,0,1] neg_hi:[0,0,1]
    v_pk_fma_f32 v[18:19], v[18:19], s[72:73], v[40:41] op_sel_hi:[1,0,0] neg_lo:[0,0,1] neg_hi:[0,0,1]
    v_pk_fma_f32 v[20:21], v[20:21], s[72:73], v[40:41] op_sel_hi:[1,0,0] neg_lo:[0,0,1] neg_hi:[0,0,1]
    v_pk_fma_f32 v[22:23], v[22:23], s[72:73], v[40:41] op_sel_hi:[1,0,0] neg_lo:[0,0,1] neg_hi:[0,0,1]
    v_pk_fma_f32 v[24:25], v[24:25], s[72:73], v[40:41] op_sel_hi:[1,0,0] neg_lo:[0,0,1] neg_hi:[0,0,1]
    v_pk_fma_f32 v[26:27], v[26:27], s[72:73], v[40:41] op_sel_hi:[1,0,0] neg_lo:[0,0,1] neg_hi:[0,0,1]
    v_pk_fma_f32 v[28:29], v[28:29], s[72:73], v[40:41] op_sel_hi:[1,0,0] neg_lo:[0,0,1] neg_hi:[0,0,1]
    v_pk_fma_f32 v[30:31], v[30:31], s[72:73], v[40:41] op_sel_hi:[1,0,0] neg_lo:[0,0,1] neg_hi:[0,0,1]
    v_exp_f32 v16, v16
    buffer_load_dwordx4 v252, s[52:55], s89 offen offset:1024 lds
    v_exp_f32 v17, v17
    v_exp_f32 v18, v18
    v_exp_f32 v19, v19
    v_exp_f32 v20, v20
    v_exp_f32 v21, v21
    v_pk_add_f32 v[42:43], v[16:17], v[18:19]
    v_exp_f32 v22, v22
    v_exp_f32 v23, v23
    buffer_load_dwordx4 v253, s[52:55], s89 offen offset:2048 lds
    v_pk_add_f32 v[42:43], v[42:43], v[20:21]
    v_exp_f32 v24, v24
    v_exp_f32 v25, v25
    v_pk_add_f32 v[42:43], v[42:43], v[22:23]
    v_exp_f32 v26, v26
    v_exp_f32 v27, v27
    v_pk_add_f32 v[42:43], v[42:43], v[24:25]
    v_exp_f32 v28, v28
    v_exp_f32 v29, v29
    buffer_load_dwordx4 v254, s[52:55], s89 offen offset:3072 lds
    s_waitcnt lgkmcnt(0)
    v_pk_add_f32 v[42:43], v[42:43], v[26:27]
    s_add_u32 m0, s97, 98304
    v_exp_f32 v30, v30
    v_exp_f32 v31, v31
    v_pk_add_f32 v[42:43], v[42:43], v[28:29]
    v_pk_add_f32 v[42:43], v[42:43], v[30:31]
    v_add_f32 v42, v42, v43
    v_rcp_f32 v42, v42
    s_nop 0
    v_pk_mul_f32 v[16:17], v[16:17], v[42:43] op_sel_hi:[1,0]
    v_cvt_pk_bf16_f32 v104, v16, v17
    v_pk_mul_f32 v[18:19], v[18:19], v[42:43] op_sel_hi:[1,0]
    buffer_load_dwordx4 v251, s[52:55], s90 offen lds
    v_cvt_pk_bf16_f32 v105, v18, v19
    v_pk_mul_f32 v[20:21], v[20:21], v[42:43] op_sel_hi:[1,0]
    v_cvt_pk_bf16_f32 v106, v20, v21
    v_pk_mul_f32 v[22:23], v[22:23], v[42:43] op_sel_hi:[1,0]
    v_cvt_pk_bf16_f32 v107, v22, v23
    v_pk_mul_f32 v[24:25], v[24:25], v[42:43] op_sel_hi:[1,0]
    v_cvt_pk_bf16_f32 v108, v24, v25
    v_pk_mul_f32 v[26:27], v[26:27], v[42:43] op_sel_hi:[1,0]
    v_cvt_pk_bf16_f32 v109, v26, v27
    v_pk_mul_f32 v[28:29], v[28:29], v[42:43] op_sel_hi:[1,0]
    v_cvt_pk_bf16_f32 v110, v28, v29
    v_pk_mul_f32 v[30:31], v[30:31], v[42:43] op_sel_hi:[1,0]
    v_cvt_pk_bf16_f32 v111, v30, v31
    v_mfma_f32_32x32x16_bf16 v[0:15], v[56:59], v[112:115], 0
    buffer_load_dwordx4 v252, s[52:55], s90 offen offset:1024 lds
    v_mfma_f32_32x32x16_bf16 v[0:15], v[60:63], v[116:119], v[0:15]
    v_mfma_f32_32x32x16_bf16 v[72:87], v[56:59], v[120:123], 0
    v_mfma_f32_32x32x16_bf16 v[72:87], v[60:63], v[124:127], v[72:87]
    v_mfma_f32_32x32x16_bf16 v[32:47], v[64:67], v[96:99], 0
    v_mfma_f32_32x32x16_bf16 v[32:47], v[68:71], v[100:103], v[32:47]
    v_mfma_f32_32x32x16_bf16 v[16:31], v[64:67], v[104:107], 0
    v_mfma_f32_32x32x16_bf16 v[16:31], v[68:71], v[108:111], v[16:31]
    s_nop 5
    v_add_f32 v8, 0x358637bd, v8
    v_rcp_f32 v8, v8
    s_nop 0
    v_pk_mul_f32 v[0:1], v[0:1], v[8:9] op_sel_hi:[1,0]
    v_pk_mul_f32 v[2:3], v[2:3], v[8:9] op_sel_hi:[1,0]
    v_pk_mul_f32 v[4:5], v[4:5], v[8:9] op_sel_hi:[1,0]
    v_pk_mul_f32 v[6:7], v[6:7], v[8:9] op_sel_hi:[1,0]
    v_cvt_pk_bf16_f32 v12, v0, v1
    v_cvt_pk_bf16_f32 v13, v2, v3
    v_cvt_pk_bf16_f32 v14, v4, v5
    v_cvt_pk_bf16_f32 v15, v6, v7
    buffer_store_dwordx4 v[12:15], v244, s[40:43], s24 offen sc1
    v_add_f32 v80, 0x358637bd, v80
    v_rcp_f32 v80, v80
    s_nop 0
    v_pk_mul_f32 v[72:73], v[72:73], v[80:81] op_sel_hi:[1,0]
    v_pk_mul_f32 v[74:75], v[74:75], v[80:81] op_sel_hi:[1,0]
    v_pk_mul_f32 v[76:77], v[76:77], v[80:81] op_sel_hi:[1,0]
    v_pk_mul_f32 v[78:79], v[78:79], v[80:81] op_sel_hi:[1,0]
    v_cvt_pk_bf16_f32 v84, v72, v73
    v_cvt_pk_bf16_f32 v85, v74, v75
    v_cvt_pk_bf16_f32 v86, v76, v77
    v_cvt_pk_bf16_f32 v87, v78, v79
    buffer_store_dwordx4 v[84:87], v244, s[40:43], s25 offen sc1
    v_add_f32 v40, 0x358637bd, v40
    v_rcp_f32 v40, v40
    s_nop 0
    v_pk_mul_f32 v[32:33], v[32:33], v[40:41] op_sel_hi:[1,0]
    v_pk_mul_f32 v[34:35], v[34:35], v[40:41] op_sel_hi:[1,0]
    v_pk_mul_f32 v[36:37], v[36:37], v[40:41] op_sel_hi:[1,0]
    v_pk_mul_f32 v[38:39], v[38:39], v[40:41] op_sel_hi:[1,0]
    v_cvt_pk_bf16_f32 v44, v32, v33
    v_cvt_pk_bf16_f32 v45, v34, v35
    v_cvt_pk_bf16_f32 v46, v36, v37
    v_cvt_pk_bf16_f32 v47, v38, v39
    buffer_store_dwordx4 v[44:47], v244, s[40:43], s24 offen offset:1024 sc1
    v_add_f32 v24, 0x358637bd, v24
    v_rcp_f32 v24, v24
    s_nop 0
    v_pk_mul_f32 v[16:17], v[16:17], v[24:25] op_sel_hi:[1,0]
    v_pk_mul_f32 v[18:19], v[18:19], v[24:25] op_sel_hi:[1,0]
    v_pk_mul_f32 v[20:21], v[20:21], v[24:25] op_sel_hi:[1,0]
    v_pk_mul_f32 v[22:23], v[22:23], v[24:25] op_sel_hi:[1,0]
    v_cvt_pk_bf16_f32 v28, v16, v17
    v_cvt_pk_bf16_f32 v29, v18, v19
    v_cvt_pk_bf16_f32 v30, v20, v21
    v_cvt_pk_bf16_f32 v31, v22, v23
    buffer_store_dwordx4 v[28:31], v244, s[40:43], s25 offen offset:1024 sc1
    buffer_load_dwordx4 v253, s[52:55], s90 offen offset:2048 lds
    buffer_load_dwordx4 v254, s[52:55], s90 offen offset:3072 lds
    s_waitcnt vmcnt(12)
    v_cmp_ne_u32 vcc, v243, v239
    s_mov_b32 s101, 65536
    s_nop 3
    s_cbranch_vccz L_ok8
L_spin8:
    buffer_load_dword v239, v235, s[40:43], s19 offen offset:2048 sc1
    s_sub_u32 s101, s101, 1
    s_cmp_eq_u32 s101, 0
    s_cbranch_scc1 L_ok8
    s_waitcnt vmcnt(0)
    v_cmp_ne_u32 vcc, v243, v239
    s_nop 4
    s_cbranch_vccnz L_spin8
L_ok8:
    buffer_load_dwordx4 v[128:131], v234, s[56:59], s4 offen sc1
    ds_read_b64_tr_b16 a[16:17], v245 offset:49152
    ds_read_b64_tr_b16 a[18:19], v245 offset:49664
    ds_read_b64_tr_b16 a[80:81], v246 offset:49152
    ds_read_b64_tr_b16 a[82:83], v246 offset:49664
    ds_read_b64_tr_b16 a[144:145], v247 offset:49152
    buffer_load_dwordx4 v[132:135], v234, s[56:59], s4 offen offset:256 sc1
    ds_read_b64_tr_b16 a[146:147], v247 offset:49664
    ds_read_b64_tr_b16 a[208:209], v248 offset:49152
    ds_read_b64_tr_b16 a[210:211], v248 offset:49664
    v_add_u32 v245, 0x10000, v245
    v_add_u32 v246, 0x10000, v246
    buffer_load_dwordx4 v[136:139], v234, s[60:63], s4 offen sc1
    v_add_u32 v247, 0x10000, v247
    v_add_u32 v248, 0x10000, v248
    ds_read_b64_tr_b16 a[20:21], v245 offset:0
    ds_read_b64_tr_b16 a[22:23], v245 offset:512
    buffer_load_dwordx4 v[140:143], v234, s[60:63], s4 offen offset:256 sc1
    ds_read_b64_tr_b16 a[84:85], v246 offset:0
    ds_read_b64_tr_b16 a[86:87], v246 offset:512
    ds_read_b64_tr_b16 a[148:149], v247 offset:0
    ds_read_b64_tr_b16 a[150:151], v247 offset:512
    ds_read_b64_tr_b16 a[212:213], v248 offset:0
    buffer_load_dwordx4 v[144:147], v234, s[56:59], s5 offen sc1
    ds_read_b64_tr_b16 a[214:215], v248 offset:512
    v_add_u32 v245, 0xfffe0000, v245
    v_add_u32 v246, 0xfffe0000, v246
    v_add_u32 v247, 0xfffe0000, v247
    v_add_u32 v248, 0xfffe0000, v248
    buffer_load_dwordx4 v[148:151], v234, s[56:59], s5 offen offset:256 sc1
    ds_read_b64_tr_b16 a[24:25], v245 offset:0
    ds_read_b64_tr_b16 a[26:27], v245 offset:512
    ds_read_b64_tr_b16 a[88:89], v246 offset:0
    ds_read_b64_tr_b16 a[90:91], v246 offset:512
    buffer_load_dwordx4 v[152:155], v234, s[60:63], s5 offen sc1
    ds_read_b64_tr_b16 a[152:153], v247 offset:0
    ds_read_b64_tr_b16 a[154:155], v247 offset:512
    ds_read_b64_tr_b16 a[216:217], v248 offset:0
    ds_read_b64_tr_b16 a[218:219], v248 offset:512
    buffer_load_dwordx4 v[156:159], v234, s[60:63], s5 offen offset:256 sc1
    ds_read_b64_tr_b16 a[32:33], v245 offset:16384
    ds_read_b64_tr_b16 a[34:35], v245 offset:16896
    ds_read_b64_tr_b16 a[96:97], v246 offset:16384
    ds_read_b64_tr_b16 a[98:99], v246 offset:16896
    ds_read_b64_tr_b16 a[160:161], v247 offset:16384
    buffer_load_dwordx4 v[160:163], v234, s[56:59], s6 offen sc1
    ds_read_b64_tr_b16 a[162:163], v247 offset:16896
    ds_read_b64_tr_b16 a[224:225], v248 offset:16384
    ds_read_b64_tr_b16 a[226:227], v248 offset:16896
    ds_read_b64_tr_b16 a[36:37], v245 offset:32768
    buffer_load_dwordx4 v[164:167], v234, s[56:59], s6 offen offset:256 sc1
    ds_read_b64_tr_b16 a[38:39], v245 offset:33280
    ds_read_b64_tr_b16 a[100:101], v246 offset:32768
    ds_read_b64_tr_b16 a[102:103], v246 offset:33280
    ds_read_b64_tr_b16 a[164:165], v247 offset:32768
    ds_read_b64_tr_b16 a[166:167], v247 offset:33280
    buffer_load_dwordx4 v[168:171], v234, s[60:63], s6 offen sc1
    ds_read_b64_tr_b16 a[228:229], v248 offset:32768
    ds_read_b64_tr_b16 a[230:231], v248 offset:33280
    ds_read_b64_tr_b16 a[40:41], v245 offset:49152
    ds_read_b64_tr_b16 a[42:43], v245 offset:49664
    buffer_load_dwordx4 v[172:175], v234, s[60:63], s6 offen offset:256 sc1
    ds_read_b64_tr_b16 a[104:105], v246 offset:49152
    ds_read_b64_tr_b16 a[106:107], v246 offset:49664
    ds_read_b64_tr_b16 a[168:169], v247 offset:49152
    ds_read_b64_tr_b16 a[170:171], v247 offset:49664
    ds_read_b64_tr_b16 a[232:233], v248 offset:49152
    ds_read_b64_tr_b16 a[234:235], v248 offset:49664
    v_add_u32 v245, 0x10000, v245
    v_add_u32 v246, 0x10000, v246
    v_add_u32 v247, 0x10000, v247
    v_add_u32 v248, 0x10000, v248
    ds_read_b64_tr_b16 a[48:49], v245 offset:0
    ds_read_b64_tr_b16 a[50:51], v245 offset:512
    ds_read_b64_tr_b16 a[112:113], v246 offset:0
    ds_read_b64_tr_b16 a[114:115], v246 offset:512
    ds_read_b64_tr_b16 a[176:177], v247 offset:0
    ds_read_b64_tr_b16 a[178:179], v247 offset:512
    ds_read_b64_tr_b16 a[240:241], v248 offset:0
    ds_read_b64_tr_b16 a[242:243], v248 offset:512
    s_waitcnt vmcnt(20)
    ds_read_b64_tr_b16 a[52:53], v245 offset:16384
    ds_read_b64_tr_b16 a[54:55], v245 offset:16896
    ds_read_b64_tr_b16 a[116:117], v246 offset:16384
    ds_read_b64_tr_b16 a[118:119], v246 offset:16896
    ds_read_b64_tr_b16 a[180:181], v247 offset:16384
    ds_read_b64_tr_b16 a[182:183], v247 offset:16896
    ds_read_b64_tr_b16 a[244:245], v248 offset:16384
    ds_read_b64_tr_b16 a[246:247], v248 offset:16896
    s_waitcnt vmcnt(12)
    ds_read_b64_tr_b16 a[56:57], v245 offset:32768
    ds_read_b64_tr_b16 a[58:59], v245 offset:33280
    ds_read_b64_tr_b16 a[120:121], v246 offset:32768
    ds_read_b64_tr_b16 a[122:123], v246 offset:33280
    ds_read_b64_tr_b16 a[184:185], v247 offset:32768
    ds_read_b64_tr_b16 a[186:187], v247 offset:33280
    ds_read_b64_tr_b16 a[248:249], v248 offset:32768
    ds_read_b64_tr_b16 a[250:251], v248 offset:33280
    buffer_store_dword v243, v237, s[40:43], s26 offen sc1
    s_waitcnt vmcnt(12)
    v_mfma_f32_16x16x32_bf16 v[0:3], a[0:3], v[128:131], 0
    v_mfma_f32_16x16x32_bf16 v[4:7], a[64:67], v[128:131], 0
    v_mfma_f32_16x16x32_bf16 v[8:11], a[128:131], v[128:131], 0
    v_mfma_f32_16x16x32_bf16 v[12:15], a[192:195], v[128:131], 0
    buffer_load_dwordx4 v[176:179], v234, s[56:59], s7 offen sc1
    s_waitcnt vmcnt(12)
    v_mfma_f32_16x16x32_bf16 v[16:19], a[0:3], v[132:135], 0
    buffer_load_dword v228, v236, s[40:43], s21 offen offset:0 sc1
    buffer_load_dword v229, v236, s[40:43], s21 offen offset:64 sc1
    v_mfma_f32_16x16x32_bf16 v[20:23], a[64:67], v[132:135], 0
    buffer_load_dword v232, v236, s[40:43], s21 offen offset:128 sc1
    buffer_load_dword v233, v236, s[40:43], s21 offen offset:192 sc1
    v_mfma_f32_16x16x32_bf16 v[24:27], a[128:131], v[132:135], 0
    v_mfma_f32_16x16x32_bf16 v[28:31], a[192:195], v[132:135], 0
    buffer_load_dwordx4 v[180:183], v234, s[56:59], s7 offen offset:256 sc1
    s_waitcnt vmcnt(16)
    v_mfma_f32_16x16x32_bf16 v[32:35], a[0:3], v[136:139], 0
    v_mfma_f32_16x16x32_bf16 v[36:39], a[64:67], v[136:139], 0
    v_mfma_f32_16x16x32_bf16 v[40:43], a[128:131], v[136:139], 0
    v_mfma_f32_16x16x32_bf16 v[44:47], a[192:195], v[136:139], 0
    buffer_load_dwordx4 v[184:187], v234, s[60:63], s7 offen sc1
    s_waitcnt vmcnt(16)
    v_mfma_f32_16x16x32_bf16 v[48:51], a[0:3], v[140:143], 0
    v_mfma_f32_16x16x32_bf16 v[52:55], a[64:67], v[140:143], 0
    v_mfma_f32_16x16x32_bf16 v[56:59], a[128:131], v[140:143], 0
    v_mfma_f32_16x16x32_bf16 v[60:63], a[192:195], v[140:143], 0
    buffer_load_dwordx4 v[188:191], v234, s[60:63], s7 offen offset:256 sc1
    s_waitcnt vmcnt(16)
    v_mfma_f32_16x16x32_bf16 v[0:3], a[4:7], v[144:147], v[0:3]
    v_mfma_f32_16x16x32_bf16 v[4:7], a[68:71], v[144:147], v[4:7]
    v_mfma_f32_16x16x32_bf16 v[8:11], a[132:135], v[144:147], v[8:11]
    v_mfma_f32_16x16x32_bf16 v[12:15], a[196:199], v[144:147], v[12:15]
    buffer_load_dwordx4 v[192:195], v234, s[56:59], s8 offen sc1
    s_waitcnt vmcnt(16)
    v_mfma_f32_16x16x32_bf16 v[16:19], a[4:7], v[148:151], v[16:19]
    v_mfma_f32_16x16x32_bf16 v[20:23], a[68:71], v[148:151], v[20:23]
    v_mfma_f32_16x16x32_bf16 v[24:27], a[132:135], v[148:151], v[24:27]
    v_mfma_f32_16x16x32_bf16 v[28:31], a[196:199], v[148:151], v[28:31]
    buffer_load_dwordx4 v[196:199], v234, s[56:59], s8 offen offset:256 sc1
    s_waitcnt vmcnt(16)
    v_mfma_f32_16x16x32_bf16 v[32:35], a[4:7], v[152:155], v[32:35]
    v_mfma_f32_16x16x32_bf16 v[36:39], a[68:71], v[152:155], v[36:39]
    v_mfma_f32_16x16x32_bf16 v[40:43], a[132:135], v[152:155], v[40:43]
    v_mfma_f32_16x16x32_bf16 v[44:47], a[196:199], v[152:155], v[44:47]
    buffer_load_dwordx4 v[200:203], v234, s[60:63], s8 offen sc1
    v_bfe_u32 v240, v255, 4, 1
    v_lshlrev_b32 v240, 5, v240
    v_xor_b32 v251, v251, v240
    s_lshl_b32 s101, s91, 13
    v_add_u32 v251, s101, v251
    s_mov_b32 s74, 0x8000
    v_add_u32 v242, s74, v234
    s_waitcnt vmcnt(16)
    v_mfma_f32_16x16x32_bf16 v[48:51], a[4:7], v[156:159], v[48:51]
    v_mfma_f32_16x16x32_bf16 v[52:55], a[68:71], v[156:159], v[52:55]
    v_mfma_f32_16x16x32_bf16 v[56:59], a[132:135], v[156:159], v[56:59]
    v_mfma_f32_16x16x32_bf16 v[60:63], a[196:199], v[156:159], v[60:63]
    buffer_load_dwordx4 v[204:207], v234, s[60:63], s8 offen offset:256 sc1
    s_waitcnt vmcnt(16)
    v_mfma_f32_16x16x32_bf16 v[0:3], a[8:11], v[160:163], v[0:3]
    v_mfma_f32_16x16x32_bf16 v[4:7], a[72:75], v[160:163], v[4:7]
    v_mfma_f32_16x16x32_bf16 v[8:11], a[136:139], v[160:163], v[8:11]
    v_mfma_f32_16x16x32_bf16 v[12:15], a[200:203], v[160:163], v[12:15]
    buffer_load_dword v239, v235, s[40:43], s19 offen sc1
    buffer_load_dwordx4 v[208:211], v234, s[56:59], s9 offen sc1
    s_waitcnt vmcnt(17)
    v_mfma_f32_16x16x32_bf16 v[16:19], a[8:11], v[164:167], v[16:19]
    v_mfma_f32_16x16x32_bf16 v[20:23], a[72:75], v[164:167], v[20:23]
    v_mfma_f32_16x16x32_bf16 v[24:27], a[136:139], v[164:167], v[24:27]
    v_mfma_f32_16x16x32_bf16 v[28:31], a[200:203], v[164:167], v[28:31]
    buffer_load_dwordx4 v[212:215], v234, s[56:59], s9 offen offset:256 sc1
    s_waitcnt vmcnt(17)
    v_mfma_f32_16x16x32_bf16 v[32:35], a[8:11], v[168:171], v[32:35]
    v_mfma_f32_16x16x32_bf16 v[36:39], a[72:75], v[168:171], v[36:39]
    v_mfma_f32_16x16x32_bf16 v[40:43], a[136:139], v[168:171], v[40:43]
    v_mfma_f32_16x16x32_bf16 v[44:47], a[200:203], v[168:171], v[44:47]
    buffer_load_dwordx4 v[216:219], v234, s[60:63], s9 offen sc1
    s_waitcnt vmcnt(17)
    v_mfma_f32_16x16x32_bf16 v[48:51], a[8:11], v[172:175], v[48:51]
    v_mfma_f32_16x16x32_bf16 v[52:55], a[72:75], v[172:175], v[52:55]
    v_mfma_f32_16x16x32_bf16 v[56:59], a[136:139], v[172:175], v[56:59]
    v_mfma_f32_16x16x32_bf16 v[60:63], a[200:203], v[172:175], v[60:63]
    buffer_load_dwordx4 v[220:223], v234, s[60:63], s9 offen offset:256 sc1
    s_waitcnt vmcnt(16)
    v_mfma_f32_16x16x32_bf16 v[0:3], a[12:15], v[176:179], v[0:3]
    v_mfma_f32_16x16x32_bf16 v[4:7], a[76:79], v[176:179], v[4:7]
L_pad_qg_3:
    s_cbranch_execz L_walked_qg
    v_mfma_f32_16x16x32_bf16 v[8:11], a[140:143], v[176:179], v[8:11]
    v_mfma_f32_16x16x32_bf16 v[12:15], a[204:207], v[176:179], v[12:15]
    buffer_load_dwordx4 v[128:131], v234, s[56:59], s10 offen sc1
    s_waitcnt vmcnt(12)
    v_mfma_f32_16x16x32_bf16 v[16:19], a[12:15], v[180:183], v[16:19]
    v_mfma_f32_16x16x32_bf16 v[20:23], a[76:79], v[180:183], v[20:23]
    v_mfma_f32_16x16x32_bf16 v[24:27], a[140:143], v[180:183], v[24:27]
    v_mfma_f32_16x16x32_bf16 v[28:31], a[204:207], v[180:183], v[28:31]
    buffer_load_dwordx4 v[132:135], v234, s[56:59], s10 offen offset:256 sc1
    s_waitcnt vmcnt(12)
    v_mfma_f32_16x16x32_bf16 v[32:35], a[12:15], v[184:187], v[32:35]
    v_mfma_f32_16x16x32_bf16 v[36:39], a[76:79], v[184:187], v[36:39]
    v_mfma_f32_16x16x32_bf16 v[40:43], a[140:143], v[184:187], v[40:43]
    v_mfma_f32_16x16x32_bf16 v[44:47], a[204:207], v[184:187], v[44:47]
    buffer_load_dwordx4 v[136:139], v234, s[60:63], s10 offen sc1
    s_waitcnt vmcnt(12)
    v_mfma_f32_16x16x32_bf16 v[48:51], a[12:15], v[188:191], v[48:51]
    v_mfma_f32_16x16x32_bf16 v[52:55], a[76:79], v[188:191], v[52:55]
    v_mfma_f32_16x16x32_bf16 v[56:59], a[140:143], v[188:191], v[56:59]
    v_mfma_f32_16x16x32_bf16 v[60:63], a[204:207], v[188:191], v[60:63]
    buffer_load_dwordx4 v[140:143], v234, s[60:63], s10 offen offset:256 sc1
    s_waitcnt vmcnt(12) lgkmcnt(0)
    v_mfma_f32_16x16x32_bf16 v[0:3], a[16:19], v[192:195], v[0:3]
    v_mfma_f32_16x16x32_bf16 v[4:7], a[80:83], v[192:195], v[4:7]
    v_mfma_f32_16x16x32_bf16 v[8:11], a[144:147], v[192:195], v[8:11]
    v_mfma_f32_16x16x32_bf16 v[12:15], a[208:211], v[192:195], v[12:15]
    s_waitcnt vmcnt(8)
    v_cmp_ne_u32 vcc, v243, v239
    s_mov_b32 s101, 65536
    s_nop 3
    s_cbranch_vccz L_ok9
L_spin9:
    buffer_load_dword v239, v235, s[40:43], s19 offen sc1
    s_sub_u32 s101, s101, 1
    s_cmp_eq_u32 s101, 0
    s_cbranch_scc1 L_ok9
    s_waitcnt vmcnt(0)
    v_cmp_ne_u32 vcc, v243, v239
    s_nop 4
    s_cbranch_vccnz L_spin9
L_ok9:
    buffer_load_dwordx4 v[144:147], v234, s[56:59], s11 offen sc1
    v_mfma_f32_16x16x32_bf16 v[16:19], a[16:19], v[196:199], v[16:19]
    v_mfma_f32_16x16x32_bf16 v[20:23], a[80:83], v[196:199], v[20:23]
    v_mfma_f32_16x16x32_bf16 v[24:27], a[144:147], v[196:199], v[24:27]
    v_mfma_f32_16x16x32_bf16 v[28:31], a[208:211], v[196:199], v[28:31]
    buffer_load_dwordx4 v[148:151], v234, s[56:59], s11 offen offset:256 sc1
    v_mfma_f32_16x16x32_bf16 v[32:35], a[16:19], v[200:203], v[32:35]
    v_mfma_f32_16x16x32_bf16 v[36:39], a[80:83], v[200:203], v[36:39]
    v_mfma_f32_16x16x32_bf16 v[40:43], a[144:147], v[200:203], v[40:43]
    v_mfma_f32_16x16x32_bf16 v[44:47], a[208:211], v[200:203], v[44:47]
    buffer_load_dwordx4 v[152:155], v234, s[60:63], s11 offen sc1
    v_mfma_f32_16x16x32_bf16 v[48:51], a[16:19], v[204:207], v[48:51]
    v_mfma_f32_16x16x32_bf16 v[52:55], a[80:83], v[204:207], v[52:55]
    v_mfma_f32_16x16x32_bf16 v[56:59], a[144:147], v[204:207], v[56:59]
    v_mfma_f32_16x16x32_bf16 v[60:63], a[208:211], v[204:207], v[60:63]
    buffer_load_dwordx4 v[156:159], v234, s[60:63], s11 offen offset:256 sc1
    s_waitcnt vmcnt(11)
    v_mfma_f32_16x16x32_bf16 v[0:3], a[20:23], v[208:211], v[0:3]
    v_mfma_f32_16x16x32_bf16 v[4:7], a[84:87], v[208:211], v[4:7]
    v_mfma_f32_16x16x32_bf16 v[8:11], a[148:151], v[208:211], v[8:11]
    v_mfma_f32_16x16x32_bf16 v[12:15], a[212:215], v[208:211], v[12:15]
    buffer_load_dwordx4 v[160:163], v234, s[56:59], s12 offen sc1
    s_waitcnt vmcnt(11)
    v_mfma_f32_16x16x32_bf16 v[16:19], a[20:23], v[212:215], v[16:19]
    v_mfma_f32_16x16x32_bf16 v[20:23], a[84:87], v[212:215], v[20:23]
    v_mfma_f32_16x16x32_bf16 v[24:27], a[148:151], v[212:215], v[24:27]
    v_mfma_f32_16x16x32_bf16 v[28:31], a[212:215], v[212:215], v[28:31]
    buffer_load_dwordx4 v[164:167], v234, s[56:59], s12 offen offset:256 sc1
    s_waitcnt vmcnt(11)
    v_mfma_f32_16x16x32_bf16 v[32:35], a[20:23], v[216:219], v[32:35]
    v_mfma_f32_16x16x32_bf16 v[36:39], a[84:87], v[216:219], v[36:39]
    v_mfma_f32_16x16x32_bf16 v[40:43], a[148:151], v[216:219], v[40:43]
    v_mfma_f32_16x16x32_bf16 v[44:47], a[212:215], v[216:219], v[44:47]
    buffer_load_dwordx4 v[168:171], v234, s[60:63], s12 offen sc1
    s_waitcnt vmcnt(11)
    v_mfma_f32_16x16x32_bf16 v[48:51], a[20:23], v[220:223], v[48:51]
    v_mfma_f32_16x16x32_bf16 v[52:55], a[84:87], v[220:223], v[52:55]
    v_mfma_f32_16x16x32_bf16 v[56:59], a[148:151], v[220:223], v[56:59]
    v_mfma_f32_16x16x32_bf16 v[60:63], a[212:215], v[220:223], v[60:63]
    buffer_load_dwordx4 v[172:175], v234, s[60:63], s12 offen offset:256 sc1
    s_waitcnt vmcnt(11)
    v_mfma_f32_16x16x32_bf16 v[0:3], a[24:27], v[128:131], v[0:3]
    v_mfma_f32_16x16x32_bf16 v[4:7], a[88:91], v[128:131], v[4:7]
    v_mfma_f32_16x16x32_bf16 v[8:11], a[152:155], v[128:131], v[8:11]
    v_mfma_f32_16x16x32_bf16 v[12:15], a[216:219], v[128:131], v[12:15]
    buffer_load_dword v239, v235, s[40:43], s20 offen sc1
    buffer_load_dwordx4 v[176:179], v234, s[56:59], s13 offen sc1
    s_waitcnt vmcnt(12)
    v_mfma_f32_16x16x32_bf16 v[16:19], a[24:27], v[132:135], v[16:19]
    v_mfma_f32_16x16x32_bf16 v[20:23], a[88:91], v[132:135], v[20:23]
    v_mfma_f32_16x16x32_bf16 v[24:27], a[152:155], v[132:135], v[24:27]
    v_mfma_f32_16x16x32_bf16 v[28:31], a[216:219], v[132:135], v[28:31]
    buffer_load_dwordx4 v[180:183], v234, s[56:59], s13 offen offset:256 sc1
    s_waitcnt vmcnt(12)
    v_mfma_f32_16x16x32_bf16 v[32:35], a[24:27], v[136:139], v[32:35]
    v_mfma_f32_16x16x32_bf16 v[36:39], a[88:91], v[136:139], v[36:39]
    v_mfma_f32_16x16x32_bf16 v[40:43], a[152:155], v[136:139], v[40:43]
    v_mfma_f32_16x16x32_bf16 v[44:47], a[216:219], v[136:139], v[44:47]
    buffer_load_dwordx4 v[184:187], v234, s[60:63], s13 offen sc1
    s_waitcnt vmcnt(12)
    v_mfma_f32_16x16x32_bf16 v[48:51], a[24:27], v[140:143], v[48:51]
    v_mfma_f32_16x16x32_bf16 v[52:55], a[88:91], v[140:143], v[52:55]
    v_mfma_f32_16x16x32_bf16 v[56:59], a[152:155], v[140:143], v[56:59]
    v_mfma_f32_16x16x32_bf16 v[60:63], a[216:219], v[140:143], v[60:63]
    buffer_load_dwordx4 v[188:191], v234, s[60:63], s13 offen offset:256 sc1
    s_waitcnt vmcnt(12)
    v_mfma_f32_16x16x32_bf16 v[0:3], a[28:31], v[144:147], v[0:3]
    v_mfma_f32_16x16x32_bf16 v[4:7], a[92:95], v[144:147], v[4:7]
    v_mfma_f32_16x16x32_bf16 v[8:11], a[156:159], v[144:147], v[8:11]
    v_mfma_f32_16x16x32_bf16 v[12:15], a[220:223], v[144:147], v[12:15]
    buffer_load_dwordx4 v[192:195], v234, s[56:59], s14 offen sc1
    s_waitcnt vmcnt(12)
    v_mfma_f32_16x16x32_bf16 v[16:19], a[28:31], v[148:151], v[16:19]
    v_mfma_f32_16x16x32_bf16 v[20:23], a[92:95], v[148:151], v[20:23]
    v_mfma_f32_16x16x32_bf16 v[24:27], a[156:159], v[148:151], v[24:27]
    v_mfma_f32_16x16x32_bf16 v[28:31], a[220:223], v[148:151], v[28:31]
    buffer_load_dwordx4 v[196:199], v234, s[56:59], s14 offen offset:256 sc1
    s_waitcnt vmcnt(12)
    v_mfma_f32_16x16x32_bf16 v[32:35], a[28:31], v[152:155], v[32:35]
    v_mfma_f32_16x16x32_bf16 v[36:39], a[92:95], v[152:155], v[36:39]
    v_mfma_f32_16x16x32_bf16 v[40:43], a[156:159], v[152:155], v[40:43]
    v_mfma_f32_16x16x32_bf16 v[44:47], a[220:223], v[152:155], v[44:47]
    buffer_load_dwordx4 v[200:203], v234, s[60:63], s14 offen sc1
    v_sub_f32 v230, 1.0, v228
    v_sub_f32 v231, 1.0, v229
    v_sub_f32 v249, 1.0, v232
    v_sub_f32 v250, 1.0, v233
    s_waitcnt vmcnt(12)
    v_mfma_f32_16x16x32_bf16 v[48:51], a[28:31], v[156:159], v[48:51]
    v_mfma_f32_16x16x32_bf16 v[52:55], a[92:95], v[156:159], v[52:55]
    v_mfma_f32_16x16x32_bf16 v[56:59], a[156:159], v[156:159], v[56:59]
    v_mfma_f32_16x16x32_bf16 v[60:63], a[220:223], v[156:159], v[60:63]
    buffer_load_dwordx4 v[204:207], v234, s[60:63], s14 offen offset:256 sc1
    s_waitcnt vmcnt(12)
    v_mfma_f32_16x16x32_bf16 v[0:3], a[32:35], v[160:163], v[0:3]
    v_mfma_f32_16x16x32_bf16 v[4:7], a[96:99], v[160:163], v[4:7]
    v_mfma_f32_16x16x32_bf16 v[8:11], a[160:163], v[160:163], v[8:11]
    v_mfma_f32_16x16x32_bf16 v[12:15], a[224:227], v[160:163], v[12:15]
    s_waitcnt vmcnt(8)
    v_cmp_ne_u32 vcc, v243, v239
    s_mov_b32 s101, 65536
    s_nop 3
    s_cbranch_vccz L_ok10
L_spin10:
    buffer_load_dword v239, v235, s[40:43], s20 offen sc1
    s_sub_u32 s101, s101, 1
    s_cmp_eq_u32 s101, 0
    s_cbranch_scc1 L_ok10
    s_waitcnt vmcnt(0)
    v_cmp_ne_u32 vcc, v243, v239
    s_nop 4
    s_cbranch_vccnz L_spin10
L_ok10:
    buffer_load_dwordx4 v[208:211], v234, s[40:43], s15 offen sc1
    v_mfma_f32_16x16x32_bf16 v[16:19], a[32:35], v[164:167], v[16:19]
    v_mfma_f32_16x16x32_bf16 v[20:23], a[96:99], v[164:167], v[20:23]
    v_mfma_f32_16x16x32_bf16 v[24:27], a[160:163], v[164:167], v[24:27]
    v_mfma_f32_16x16x32_bf16 v[28:31], a[224:227], v[164:167], v[28:31]
    buffer_load_dwordx4 v[212:215], v234, s[40:43], s15 offen offset:256 sc1
    v_mfma_f32_16x16x32_bf16 v[32:35], a[32:35], v[168:171], v[32:35]
    v_mfma_f32_16x16x32_bf16 v[36:39], a[96:99], v[168:171], v[36:39]
    v_mfma_f32_16x16x32_bf16 v[40:43], a[160:163], v[168:171], v[40:43]
    v_mfma_f32_16x16x32_bf16 v[44:47], a[224:227], v[168:171], v[44:47]
    buffer_load_dwordx4 v[216:219], v234, s[40:43], s16 offen sc1
    v_and_b32 v241, 15, v255
    v_lshl_add_u32 v240, v241, 8, s97
    v_lshrrev_b32 v247, 4, v255
    v_and_b32 v248, 7, v255
    v_xor_b32 v246, v247, v248
    v_lshlrev_b32 v245, 4, v246
    v_add_u32 v226, v240, v245
    v_xor_b32 v227, 64, v226
    v_mfma_f32_16x16x32_bf16 v[48:51], a[32:35], v[172:175], v[48:51]
    v_mfma_f32_16x16x32_bf16 v[52:55], a[96:99], v[172:175], v[52:55]
    v_mfma_f32_16x16x32_bf16 v[56:59], a[160:163], v[172:175], v[56:59]
    v_mfma_f32_16x16x32_bf16 v[60:63], a[224:227], v[172:175], v[60:63]
    buffer_load_dwordx4 v[220:223], v234, s[40:43], s16 offen offset:256 sc1
    s_waitcnt vmcnt(11)
    v_mfma_f32_16x16x32_bf16 v[0:3], a[36:39], v[176:179], v[0:3]
    v_mfma_f32_16x16x32_bf16 v[4:7], a[100:103], v[176:179], v[4:7]
    v_mfma_f32_16x16x32_bf16 v[8:11], a[164:167], v[176:179], v[8:11]
    v_mfma_f32_16x16x32_bf16 v[12:15], a[228:231], v[176:179], v[12:15]
    buffer_load_dwordx4 v[128:131], v234, s[40:43], s17 offen sc1
    s_waitcnt vmcnt(11)
    v_mfma_f32_16x16x32_bf16 v[16:19], a[36:39], v[180:183], v[16:19]
    v_mfma_f32_16x16x32_bf16 v[20:23], a[100:103], v[180:183], v[20:23]
    v_mfma_f32_16x16x32_bf16 v[24:27], a[164:167], v[180:183], v[24:27]
    v_mfma_f32_16x16x32_bf16 v[28:31], a[228:231], v[180:183], v[28:31]
    buffer_load_dwordx4 v[132:135], v234, s[40:43], s17 offen offset:256 sc1
    s_waitcnt vmcnt(11)
    v_mfma_f32_16x16x32_bf16 v[32:35], a[36:39], v[184:187], v[32:35]
    v_mfma_f32_16x16x32_bf16 v[36:39], a[100:103], v[184:187], v[36:39]
    v_mfma_f32_16x16x32_bf16 v[40:43], a[164:167], v[184:187], v[40:43]
    v_mfma_f32_16x16x32_bf16 v[44:47], a[228:231], v[184:187], v[44:47]
    buffer_load_dwordx4 v[136:139], v234, s[40:43], s18 offen sc1
    s_waitcnt vmcnt(11)
    v_mfma_f32_16x16x32_bf16 v[48:51], a[36:39], v[188:191], v[48:51]
    v_mfma_f32_16x16x32_bf16 v[52:55], a[100:103], v[188:191], v[52:55]
    v_mfma_f32_16x16x32_bf16 v[56:59], a[164:167], v[188:191], v[56:59]
    v_mfma_f32_16x16x32_bf16 v[60:63], a[228:231], v[188:191], v[60:63]
    buffer_load_dwordx4 v[140:143], v234, s[40:43], s18 offen offset:256 sc1
    s_waitcnt vmcnt(11)
    v_mfma_f32_16x16x32_bf16 v[0:3], a[40:43], v[192:195], v[0:3]
    v_mfma_f32_16x16x32_bf16 v[4:7], a[104:107], v[192:195], v[4:7]
    v_mfma_f32_16x16x32_bf16 v[8:11], a[168:171], v[192:195], v[8:11]
    v_mfma_f32_16x16x32_bf16 v[12:15], a[232:235], v[192:195], v[12:15]
    buffer_load_dwordx4 v[144:147], v242, s[40:43], s15 offen sc1
    s_waitcnt vmcnt(11)
    v_mfma_f32_16x16x32_bf16 v[16:19], a[40:43], v[196:199], v[16:19]
    v_mfma_f32_16x16x32_bf16 v[20:23], a[104:107], v[196:199], v[20:23]
    s_nop 0
    v_mul_f32 v0, v0, v230
    v_mul_f32 v1, v1, v230
    v_mfma_f32_16x16x32_bf16 v[24:27], a[168:171], v[196:199], v[24:27]
    v_mul_f32 v2, v2, v230
    v_mul_f32 v3, v3, v230
    v_mfma_f32_16x16x32_bf16 v[28:31], a[232:235], v[196:199], v[28:31]
    buffer_load_dwordx4 v[148:151], v242, s[40:43], s15 offen offset:256 sc1
    s_waitcnt vmcnt(11)
    v_mfma_f32_16x16x32_bf16 v[32:35], a[40:43], v[200:203], v[32:35]
    v_mul_f32 v4, v4, v230
    v_mul_f32 v5, v5, v230
    v_mfma_f32_16x16x32_bf16 v[36:39], a[104:107], v[200:203], v[36:39]
    v_mul_f32 v6, v6, v230
    v_mul_f32 v7, v7, v230
    v_mfma_f32_16x16x32_bf16 v[40:43], a[168:171], v[200:203], v[40:43]
    v_mul_f32 v8, v8, v230
    v_mul_f32 v9, v9, v230
    v_mfma_f32_16x16x32_bf16 v[44:47], a[232:235], v[200:203], v[44:47]
    buffer_load_dwordx4 v[152:155], v242, s[40:43], s16 offen sc1
    s_waitcnt vmcnt(11)
    v_mfma_f32_16x16x32_bf16 v[48:51], a[40:43], v[204:207], v[48:51]
    v_mul_f32 v10, v10, v230
    v_mul_f32 v11, v11, v230
    v_mfma_f32_16x16x32_bf16 v[52:55], a[104:107], v[204:207], v[52:55]
    v_mul_f32 v12, v12, v230
    v_mul_f32 v13, v13, v230
    v_mfma_f32_16x16x32_bf16 v[56:59], a[168:171], v[204:207], v[56:59]
    v_mul_f32 v14, v14, v230
    v_mul_f32 v15, v15, v230
    v_mfma_f32_16x16x32_bf16 v[60:63], a[232:235], v[204:207], v[60:63]
    buffer_load_dwordx4 v[156:159], v242, s[40:43], s16 offen offset:256 sc1
    s_waitcnt vmcnt(11)
    v_mfma_f32_16x16x32_bf16 v[64:67], a[44:47], v[208:211], 0
    v_mul_f32 v16, v16, v231
    v_mul_f32 v17, v17, v231
    v_mfma_f32_16x16x32_bf16 v[68:71], a[108:111], v[208:211], 0
    buffer_load_dwordx4 v[160:163], v242, s[40:43], s17 offen sc1
    v_mul_f32 v18, v18, v231
    v_mul_f32 v19, v19, v231
    s_waitcnt vmcnt(11)
    v_mfma_f32_16x16x32_bf16 v[80:83], a[44:47], v[212:215], 0
    v_mul_f32 v20, v20, v231
    v_mul_f32 v21, v21, v231
    v_mfma_f32_16x16x32_bf16 v[84:87], a[108:111], v[212:215], 0
    buffer_load_dwordx4 v[164:167], v242, s[40:43], s17 offen offset:256 sc1
    v_mul_f32 v22, v22, v231
    v_mul_f32 v23, v23, v231
    s_waitcnt vmcnt(11)
    v_mfma_f32_16x16x32_bf16 v[64:67], a[48:51], v[216:219], v[64:67]
    v_mul_f32 v24, v24, v231
    v_mul_f32 v25, v25, v231
    v_mfma_f32_16x16x32_bf16 v[68:71], a[112:115], v[216:219], v[68:71]
    buffer_load_dwordx4 v[168:171], v242, s[40:43], s18 offen sc1
    v_mul_f32 v26, v26, v231
    v_mul_f32 v27, v27, v231
    s_waitcnt vmcnt(11)
    v_mfma_f32_16x16x32_bf16 v[80:83], a[48:51], v[220:223], v[80:83]
    v_mul_f32 v28, v28, v231
    v_mul_f32 v29, v29, v231
    v_mfma_f32_16x16x32_bf16 v[84:87], a[112:115], v[220:223], v[84:87]
    buffer_load_dwordx4 v[172:175], v242, s[40:43], s18 offen offset:256 sc1
    v_mul_f32 v30, v30, v231
    v_mul_f32 v31, v31, v231
    s_waitcnt vmcnt(11)
    v_mfma_f32_16x16x32_bf16 v[64:67], a[52:55], v[128:131], v[64:67]
    v_mul_f32 v32, v32, v249
    v_mul_f32 v33, v33, v249
    v_mfma_f32_16x16x32_bf16 v[68:71], a[116:119], v[128:131], v[68:71]
    v_mul_f32 v34, v34, v249
    v_mul_f32 v35, v35, v249
    s_waitcnt vmcnt(10)
    v_mfma_f32_16x16x32_bf16 v[80:83], a[52:55], v[132:135], v[80:83]
    v_mul_f32 v36, v36, v249
    v_mul_f32 v37, v37, v249
    v_mfma_f32_16x16x32_bf16 v[84:87], a[116:119], v[132:135], v[84:87]
    v_mul_f32 v38, v38, v249
    v_mul_f32 v39, v39, v249
    s_waitcnt vmcnt(9)
    v_mfma_f32_16x16x32_bf16 v[64:67], a[56:59], v[136:139], v[64:67]
    v_mul_f32 v40, v40, v249
    v_mul_f32 v41, v41, v249
    v_mfma_f32_16x16x32_bf16 v[68:71], a[120:123], v[136:139], v[68:71]
    v_mul_f32 v42, v42, v249
    v_mul_f32 v43, v43, v249
    s_waitcnt vmcnt(8)
    v_mfma_f32_16x16x32_bf16 v[80:83], a[56:59], v[140:143], v[80:83]
    v_mul_f32 v44, v44, v249
    v_mul_f32 v45, v45, v249
    v_mfma_f32_16x16x32_bf16 v[84:87], a[120:123], v[140:143], v[84:87]
    v_mfma_f32_16x16x32_bf16 v[72:75], a[172:175], v[208:211], 0
    v_mul_f32 v46, v46, v249
    v_mul_f32 v47, v47, v249
    v_mfma_f32_16x16x32_bf16 v[76:79], a[236:239], v[208:211], 0
    v_mul_f32 v48, v48, v250
    v_mul_f32 v49, v49, v250
    v_mfma_f32_16x16x32_bf16 v[88:91], a[172:175], v[212:215], 0
    v_mul_f32 v50, v50, v250
    v_mul_f32 v51, v51, v250
    v_mfma_f32_16x16x32_bf16 v[92:95], a[236:239], v[212:215], 0
    v_fmac_f32 v0, v64, v228
    v_fmac_f32 v1, v65, v228
    v_mfma_f32_16x16x32_bf16 v[72:75], a[176:179], v[216:219], v[72:75]
    v_fmac_f32 v2, v66, v228
    v_fmac_f32 v3, v67, v228
    v_mfma_f32_16x16x32_bf16 v[76:79], a[240:243], v[216:219], v[76:79]
    ds_write_b128 v226, v[0:3] offset:0
    v_fmac_f32 v4, v68, v228
    v_mfma_f32_16x16x32_bf16 v[88:91], a[176:179], v[220:223], v[88:91]
    v_fmac_f32 v5, v69, v228
    v_fmac_f32 v6, v70, v228
    v_mfma_f32_16x16x32_bf16 v[92:95], a[240:243], v[220:223], v[92:95]
    v_fmac_f32 v7, v71, v228
    ds_write_b128 v227, v[4:7] offset:0
    v_mfma_f32_16x16x32_bf16 v[72:75], a[180:183], v[128:131], v[72:75]
    v_fmac_f32 v16, v80, v229
    v_fmac_f32 v17, v81, v229
    v_mfma_f32_16x16x32_bf16 v[76:79], a[244:247], v[128:131], v[76:79]
    v_fmac_f32 v18, v82, v229
    v_fmac_f32 v19, v83, v229
    v_mfma_f32_16x16x32_bf16 v[88:91], a[180:183], v[132:135], v[88:91]
    ds_write_b128 v226, v[16:19] offset:16384
    v_fmac_f32 v20, v84, v229
    v_mfma_f32_16x16x32_bf16 v[92:95], a[244:247], v[132:135], v[92:95]
    v_fmac_f32 v21, v85, v229
    v_fmac_f32 v22, v86, v229
    v_mfma_f32_16x16x32_bf16 v[72:75], a[184:187], v[136:139], v[72:75]
    v_fmac_f32 v23, v87, v229
    ds_write_b128 v227, v[20:23] offset:16384
    v_mfma_f32_16x16x32_bf16 v[76:79], a[248:251], v[136:139], v[76:79]
    v_mul_f32 v52, v52, v250
    v_mul_f32 v53, v53, v250
    v_mfma_f32_16x16x32_bf16 v[88:91], a[184:187], v[140:143], v[88:91]
    v_mul_f32 v54, v54, v250
    v_mul_f32 v55, v55, v250
    v_mfma_f32_16x16x32_bf16 v[92:95], a[248:251], v[140:143], v[92:95]
    s_waitcnt vmcnt(7)
    v_mfma_f32_16x16x32_bf16 v[96:99], a[44:47], v[144:147], 0
    v_mul_f32 v56, v56, v250
    v_mul_f32 v57, v57, v250
    v_mfma_f32_16x16x32_bf16 v[100:103], a[108:111], v[144:147], 0
    v_mul_f32 v58, v58, v250
    v_mul_f32 v59, v59, v250
    s_waitcnt vmcnt(6)
    v_mfma_f32_16x16x32_bf16 v[112:115], a[44:47], v[148:151], 0
    v_mul_f32 v60, v60, v250
    v_mul_f32 v61, v61, v250
    v_mfma_f32_16x16x32_bf16 v[116:119], a[108:111], v[148:151], 0
    v_mul_f32 v62, v62, v250
    v_mul_f32 v63, v63, v250
    s_waitcnt vmcnt(5)
    v_mfma_f32_16x16x32_bf16 v[96:99], a[48:51], v[152:155], v[96:99]
    v_fmac_f32 v8, v72, v228
    v_fmac_f32 v9, v73, v228
    v_mfma_f32_16x16x32_bf16 v[100:103], a[112:115], v[152:155], v[100:103]
    v_fmac_f32 v10, v74, v228
    v_fmac_f32 v11, v75, v228
    s_waitcnt vmcnt(4)
    v_mfma_f32_16x16x32_bf16 v[112:115], a[48:51], v[156:159], v[112:115]
    ds_write_b128 v226, v[8:11] offset:128
    v_fmac_f32 v12, v76, v228
    v_mfma_f32_16x16x32_bf16 v[116:119], a[112:115], v[156:159], v[116:119]
    v_fmac_f32 v13, v77, v228
    v_fmac_f32 v14, v78, v228
    s_waitcnt vmcnt(3)
    v_mfma_f32_16x16x32_bf16 v[96:99], a[52:55], v[160:163], v[96:99]
    v_fmac_f32 v15, v79, v228
    ds_write_b128 v227, v[12:15] offset:128
    v_mfma_f32_16x16x32_bf16 v[100:103], a[116:119], v[160:163], v[100:103]
    v_fmac_f32 v24, v88, v229
    v_fmac_f32 v25, v89, v229
    s_waitcnt vmcnt(2)
    v_mfma_f32_16x16x32_bf16 v[112:115], a[52:55], v[164:167], v[112:115]
    v_fmac_f32 v26, v90, v229
    v_fmac_f32 v27, v91, v229
    v_mfma_f32_16x16x32_bf16 v[116:119], a[116:119], v[164:167], v[116:119]
    ds_write_b128 v226, v[24:27] offset:16512
    v_fmac_f32 v28, v92, v229
    s_waitcnt vmcnt(1)
    v_mfma_f32_16x16x32_bf16 v[96:99], a[56:59], v[168:171], v[96:99]
    v_fmac_f32 v29, v93, v229
    v_fmac_f32 v30, v94, v229
    v_mfma_f32_16x16x32_bf16 v[100:103], a[120:123], v[168:171], v[100:103]
    v_fmac_f32 v31, v95, v229
    ds_write_b128 v227, v[28:31] offset:16512
    s_waitcnt vmcnt(0)
    v_mfma_f32_16x16x32_bf16 v[112:115], a[56:59], v[172:175], v[112:115]
    v_mfma_f32_16x16x32_bf16 v[116:119], a[120:123], v[172:175], v[116:119]
    v_mfma_f32_16x16x32_bf16 v[104:107], a[172:175], v[144:147], 0
    s_waitcnt lgkmcnt(0)
    s_barrier
    v_mfma_f32_16x16x32_bf16 v[108:111], a[236:239], v[144:147], 0
    ds_read_b128 v[176:179], v224 offset:0
    ds_read_b128 v[180:183], v225 offset:0
    v_mfma_f32_16x16x32_bf16 v[120:123], a[172:175], v[148:151], 0
    v_fmac_f32 v32, v96, v232
    v_fmac_f32 v33, v97, v232
    v_mfma_f32_16x16x32_bf16 v[124:127], a[236:239], v[148:151], 0
    v_fmac_f32 v34, v98, v232
    v_fmac_f32 v35, v99, v232
    v_mfma_f32_16x16x32_bf16 v[104:107], a[176:179], v[152:155], v[104:107]
    ds_write_b128 v226, v[32:35] offset:32768
    v_fmac_f32 v36, v100, v232
    v_mfma_f32_16x16x32_bf16 v[108:111], a[240:243], v[152:155], v[108:111]
    v_fmac_f32 v37, v101, v232
    v_fmac_f32 v38, v102, v232
    v_mfma_f32_16x16x32_bf16 v[120:123], a[176:179], v[156:159], v[120:123]
    v_fmac_f32 v39, v103, v232
    ds_write_b128 v227, v[36:39] offset:32768
    v_mfma_f32_16x16x32_bf16 v[124:127], a[240:243], v[156:159], v[124:127]
    ds_read_b128 v[184:187], v224 offset:4096
    ds_read_b128 v[188:191], v225 offset:4096
    v_mfma_f32_16x16x32_bf16 v[104:107], a[180:183], v[160:163], v[104:107]
    ds_read_b128 v[192:195], v224 offset:8192
    ds_read_b128 v[196:199], v225 offset:8192
    v_mfma_f32_16x16x32_bf16 v[108:111], a[244:247], v[160:163], v[108:111]
    ds_read_b128 v[200:203], v224 offset:12288
    ds_read_b128 v[204:207], v225 offset:12288
    v_mfma_f32_16x16x32_bf16 v[120:123], a[180:183], v[164:167], v[120:123]
    v_fmac_f32 v48, v112, v233
    v_fmac_f32 v49, v113, v233
    v_mfma_f32_16x16x32_bf16 v[124:127], a[244:247], v[164:167], v[124:127]
    v_fmac_f32 v50, v114, v233
    v_fmac_f32 v51, v115, v233
    v_mfma_f32_16x16x32_bf16 v[104:107], a[184:187], v[168:171], v[104:107]
    ds_write_b128 v226, v[48:51] offset:49152
    v_fmac_f32 v52, v116, v233
    v_mfma_f32_16x16x32_bf16 v[108:111], a[248:251], v[168:171], v[108:111]
    v_fmac_f32 v53, v117, v233
    v_fmac_f32 v54, v118, v233
    v_mfma_f32_16x16x32_bf16 v[120:123], a[184:187], v[172:175], v[120:123]
    v_fmac_f32 v55, v119, v233
    ds_write_b128 v227, v[52:55] offset:49152
    v_mfma_f32_16x16x32_bf16 v[124:127], a[248:251], v[172:175], v[124:127]
    s_waitcnt lgkmcnt(7)
    v_pk_add_f32 v[176:177], v[176:177], v[184:185]
    v_pk_add_f32 v[178:179], v[178:179], v[186:187]
    s_waitcnt lgkmcnt(6)
    v_pk_add_f32 v[180:181], v[180:181], v[188:189]
    v_pk_add_f32 v[182:183], v[182:183], v[190:191]
    s_waitcnt lgkmcnt(3)
    v_pk_add_f32 v[192:193], v[192:193], v[200:201]
    v_pk_add_f32 v[194:195], v[194:195], v[202:203]
    s_waitcnt lgkmcnt(2)
    v_pk_add_f32 v[196:197], v[196:197], v[204:205]
    v_pk_add_f32 v[198:199], v[198:199], v[206:207]
    v_pk_add_f32 v[176:177], v[176:177], v[192:193]
    v_pk_add_f32 v[178:179], v[178:179], v[194:195]
    v_pk_add_f32 v[180:181], v[180:181], v[196:197]
    v_pk_add_f32 v[182:183], v[182:183], v[198:199]
    v_cvt_pk_bf16_f32 v184, v176, v177
    v_cvt_pk_bf16_f32 v185, v178, v179
    v_cvt_pk_bf16_f32 v186, v180, v181
    v_cvt_pk_bf16_f32 v187, v182, v183
    buffer_store_dwordx4 v[184:187], v251, s[64:67], 0 offen sc1
    v_pk_fma_f32 v[40:41], v[104:105], v[232:233], v[40:41] op_sel:[0,0,0] op_sel_hi:[1,0,1]
    v_pk_fma_f32 v[42:43], v[106:107], v[232:233], v[42:43] op_sel:[0,0,0] op_sel_hi:[1,0,1]
    ds_write_b128 v226, v[40:43] offset:32896
    v_pk_fma_f32 v[44:45], v[108:109], v[232:233], v[44:45] op_sel:[0,0,0] op_sel_hi:[1,0,1]
    v_pk_fma_f32 v[46:47], v[110:111], v[232:233], v[46:47] op_sel:[0,0,0] op_sel_hi:[1,0,1]
    ds_write_b128 v227, v[44:47] offset:32896
    v_pk_fma_f32 v[56:57], v[120:121], v[232:233], v[56:57] op_sel:[0,1,0] op_sel_hi:[1,1,1]
    v_pk_fma_f32 v[58:59], v[122:123], v[232:233], v[58:59] op_sel:[0,1,0] op_sel_hi:[1,1,1]
    ds_write_b128 v226, v[56:59] offset:49280
    v_pk_fma_f32 v[60:61], v[124:125], v[232:233], v[60:61] op_sel:[0,1,0] op_sel_hi:[1,1,1]
    v_pk_fma_f32 v[62:63], v[126:127], v[232:233], v[62:63] op_sel:[0,1,0] op_sel_hi:[1,1,1]
    ds_write_b128 v227, v[60:63] offset:49280
    s_waitcnt lgkmcnt(0)
    s_barrier
    ds_read_b128 v[128:131], v224 offset:32768
    ds_read_b128 v[132:135], v225 offset:32768
    ds_read_b128 v[136:139], v224 offset:36864
    ds_read_b128 v[140:143], v225 offset:36864
    ds_read_b128 v[144:147], v224 offset:40960
    ds_read_b128 v[148:151], v225 offset:40960
    ds_read_b128 v[152:155], v224 offset:45056
    ds_read_b128 v[156:159], v225 offset:45056
    s_waitcnt lgkmcnt(5)
    v_pk_add_f32 v[128:129], v[128:129], v[136:137]
    v_pk_add_f32 v[130:131], v[130:131], v[138:139]
    s_waitcnt lgkmcnt(4)
    v_pk_add_f32 v[132:133], v[132:133], v[140:141]
    v_pk_add_f32 v[134:135], v[134:135], v[142:143]
    s_waitcnt lgkmcnt(1)
    v_pk_add_f32 v[144:145], v[144:145], v[152:153]
    v_pk_add_f32 v[146:147], v[146:147], v[154:155]
    s_waitcnt lgkmcnt(0)
    v_pk_add_f32 v[148:149], v[148:149], v[156:157]
    v_pk_add_f32 v[150:151], v[150:151], v[158:159]
    v_pk_add_f32 v[128:129], v[128:129], v[144:145]
    v_pk_add_f32 v[130:131], v[130:131], v[146:147]
    v_pk_add_f32 v[132:133], v[132:133], v[148:149]
    v_pk_add_f32 v[134:135], v[134:135], v[150:151]
    v_cvt_pk_bf16_f32 v136, v128, v129
    v_cvt_pk_bf16_f32 v137, v130, v131
    v_cvt_pk_bf16_f32 v138, v132, v133
    v_cvt_pk_bf16_f32 v139, v134, v135
    buffer_store_dwordx4 v[136:139], v251, s[64:67], s74 offen sc1
    s_endpgm
    .p2align 12
L_body_kv:
    s_lshl_b32 s101, s93, 1
    v_lshrrev_b32 v31, 4, v255
    v_bfe_u32 v32, v255, 2, 2
    v_lshl_add_u32 v30, v31, 3, v32
    v_and_b32 v34, 3, v255
    v_lshlrev_b32 v33, 3, v34
    v_lshl_add_u32 v29, v30, 7, v33
    v_add_u32 v28, 0x10000, v29
    v_lshrrev_b32 v38, 1, v32
    v_lshl_add_u32 v37, v15, 1, v38
    v_xor_b32 v36, s101, v37
    v_lshlrev_b32 v35, 5, v36
    v_add_u32 v214, v28, v35
    v_xor_b32 v215, 32, v214
    s_add_u32 s101, s97, 32768
    v_and_b32 v40, 15, v255
    v_lshl_add_u32 v39, v40, 5, s101
    v_lshrrev_b32 v43, 5, v255
    v_bfe_u32 v44, v255, 2, 1
    v_xor_b32 v42, v43, v44
    v_lshlrev_b32 v41, 4, v42
    v_add_u32 v219, v39, v41
    v_xor_b32 v45, 1, v15
    v_lshlrev_b32 v220, 9, v45
    v_mov_b32 v239, 151552
    v_cmp_eq_u32 vcc, 0, v220
    s_nop 1
    v_cndmask_b32 v219, v219, v239, vcc
    v_mov_b32 v4, 0x3f803f80
    v_mov_b32 v5, 0x3f803f80
    v_mov_b32 v6, 0x3f803f80
    v_mov_b32 v7, 0x3f803f80
    v_mov_b32 v240, 151552
    ds_write_b128 v240, v[4:7]
    s_add_u32 s14, s96, 2
    s_and_b32 s14, s14, 7
    s_mul_i32 s14, s14, 196608
    s_add_u32 s15, s96, 3
    s_and_b32 s15, s15, 7
    s_mul_i32 s15, s15, 196608
    s_add_u32 s16, s96, 4
    s_and_b32 s16, s16, 7
    s_mul_i32 s16, s16, 196608
    s_add_u32 s17, s96, 5
    s_and_b32 s17, s17, 7
    s_mul_i32 s17, s17, 196608
    s_add_u32 s18, s96, 6
    s_and_b32 s18, s18, 7
    s_mul_i32 s18, s18, 196608
    s_add_u32 s19, s96, 7
    s_and_b32 s19, s19, 7
    s_mul_i32 s19, s19, 196608
    s_add_u32 s6, s96, 2
    s_and_b32 s6, s6, 7
    s_mul_i32 s6, s6, 128
    s_add_u32 s7, s96, 3
    s_and_b32 s7, s7, 7
    s_mul_i32 s7, s7, 128
    s_add_u32 s8, s96, 4
    s_and_b32 s8, s8, 7
    s_mul_i32 s8, s8, 128
    s_add_u32 s9, s96, 5
    s_and_b32 s9, s9, 7
    s_mul_i32 s9, s9, 128
    s_add_u32 s10, s96, 6
    s_and_b32 s10, s10, 7
    s_mul_i32 s10, s10, 128
    s_add_u32 s11, s96, 7
    s_and_b32 s11, s11, 7
    s_mul_i32 s11, s11, 128
    s_lshl_b32 s101, s92, 13
    v_lshl_add_u32 v46, v40, 7, s101
    v_lshrrev_b32 v49, 1, v40
    v_xor_b32 v48, v31, v49
    v_lshlrev_b32 v47, 4, v48
    v_add_u32 v200, v46, v47
    v_xor_b32 v201, 64, v200
    s_mov_b64 s[48:49], s[62:63]
    s_mov_b64 s[52:53], s[54:55]
    s_mov_b64 s[64:65], s[66:67]
    s_mov_b32 s50, 0x158000
    s_mov_b32 s51, 0x20000
    s_mov_b32 s54, 0x80000
    s_mov_b32 s55, 0x20000
    s_mov_b32 s58, 0x15800
    s_mov_b32 s59, 0x20000
    s_mov_b32 s62, 0x15800
    s_mov_b32 s63, 0x20000
    s_mov_b32 s66, 0x10000
    s_mov_b32 s67, 0x20000
    s_mul_i32 s101, s98, 176128
    s_add_u32 s56, s40, s101
    s_addc_u32 s57, s41, 0
    s_add_u32 s60, s56, 88064
    s_addc_u32 s61, s57, 0
    s_lshl_b32 s101, s98, 16
    s_add_u32 s64, s64, s101
    s_addc_u32 s65, s65, 0
    s_lshl_b32 s101, s2, 2
    s_add_u32 s101, s101, s91
    s_mul_i32 s3, s101, 1408
    s_lshl_b32 s101, s101, 9
    v_min_u32 v50, 10, v255
    v_lshl_add_u32 v152, v50, 7, s3
    v_min_u32 v51, 3, v255
    v_lshl_add_u32 v153, v51, 7, s101
    s_mov_b64 exec, 0
    s_cmp_eq_u32 s91, 0
    s_cbranch_scc1 L_pad_kv_0
    s_cmp_eq_u32 s91, 1
    s_cbranch_scc1 L_pad_kv_1
    s_cmp_eq_u32 s91, 2
    s_cbranch_scc1 L_pad_kv_2
    s_cmp_eq_u32 s91, 3
    s_cbranch_scc1 L_pad_kv_3
L_walked_kv:
    s_mov_b64 exec, -1
    s_waitcnt lgkmcnt(0)
    s_waitcnt vmcnt(9)
    s_barrier
    ds_read_b128 a[0:3], v200 offset:0
    ds_read_b128 a[64:67], v200 offset:2048
    ds_read_b64_tr_b16 v[128:129], v214 offset:0
    ds_read_b64_tr_b16 v[130:131], v214 offset:512
    s_add_u32 m0, s97, 32768
    s_waitcnt lgkmcnt(0)
    v_mfma_f32_16x16x32_bf16 v[0:3], v[128:131], a[0:3], 0
    ds_read_b128 a[128:131], v200 offset:4096
    ds_read_b128 a[192:195], v200 offset:6144
    v_mfma_f32_16x16x32_bf16 v[4:7], v[128:131], a[64:67], 0
    buffer_load_dwordx4 v226, s[28:31], s6 offen lds
    s_lshl_b32 s101, s91, 10
    s_add_u32 s101, s101, 147456
    s_waitcnt lgkmcnt(1)
    v_mfma_f32_16x16x32_bf16 v[8:11], v[128:131], a[128:131], 0
    ds_read_b64_tr_b16 v[132:133], v214 offset:8192
    ds_read_b64_tr_b16 v[134:135], v214 offset:8704
    s_waitcnt lgkmcnt(2)
    v_mfma_f32_16x16x32_bf16 v[12:15], v[128:131], a[192:195], 0
    buffer_load_dwordx4 v227, s[28:31], s6 offen offset:1024 lds
    v_lshrrev_b32 v82, 5, v255
    v_bfe_u32 v83, v255, 2, 2
    s_waitcnt lgkmcnt(0)
    v_mfma_f32_16x16x32_bf16 v[32:35], a[0:3], v[132:135], 0
    ds_read_b64_tr_b16 v[136:137], v215 offset:0
    ds_read_b64_tr_b16 v[138:139], v215 offset:512
    v_mfma_f32_16x16x32_bf16 v[36:39], a[64:67], v[132:135], 0
    buffer_load_dwordx4 v228, s[28:31], s6 offen offset:2048 lds
    v_lshl_add_u32 v81, v82, 3, v83
    v_lshl_add_u32 v80, v81, 5, s101
    v_mfma_f32_16x16x32_bf16 v[40:43], a[128:131], v[132:135], 0
    ds_read_b64_tr_b16 v[140:141], v215 offset:8192
    ds_read_b64_tr_b16 v[142:143], v215 offset:8704
    v_mfma_f32_16x16x32_bf16 v[44:47], a[192:195], v[132:135], 0
    buffer_load_dwordx4 v229, s[28:31], s6 offen offset:3072 lds
    v_bfe_u32 v86, v255, 4, 1
    v_and_b32 v88, 3, v255
    s_waitcnt lgkmcnt(2)
    v_mfma_f32_16x16x32_bf16 v[16:19], v[136:139], a[0:3], 0
    ds_read_b128 a[4:7], v201 offset:0
    ds_read_b128 a[68:71], v201 offset:2048
    v_mfma_f32_16x16x32_bf16 v[20:23], v[136:139], a[64:67], 0
    s_add_u32 m0, s97, 98304
    s_nop 0
    buffer_load_dwordx4 v68, s[32:35], s14 offen lds
    v_lshrrev_b32 v87, 1, v88
    v_mfma_f32_16x16x32_bf16 v[24:27], v[136:139], a[128:131], 0
    ds_read_b64_tr_b16 v[144:145], v214 offset:4096
    ds_read_b64_tr_b16 v[146:147], v214 offset:4608
    v_mfma_f32_16x16x32_bf16 v[28:31], v[136:139], a[192:195], 0
    buffer_load_dwordx4 v69, s[32:35], s14 offen offset:1024 lds
    v_lshl_add_u32 v85, v86, 1, v87
    v_lshlrev_b32 v84, 3, v85
    s_waitcnt lgkmcnt(4)
    v_mfma_f32_16x16x32_bf16 v[48:51], a[0:3], v[140:143], 0
    ds_read_b128 a[132:135], v201 offset:4096
    ds_read_b128 a[196:199], v201 offset:6144
    v_mfma_f32_16x16x32_bf16 v[52:55], a[64:67], v[140:143], 0
    buffer_load_dwordx4 v70, s[32:35], s14 offen offset:2048 lds
    v_add_u32 v77, v80, v84
    v_bfe_u32 v89, v255, 2, 1
    v_mfma_f32_16x16x32_bf16 v[56:59], a[128:131], v[140:143], 0
    ds_read_b64_tr_b16 v[148:149], v214 offset:12288
    ds_read_b64_tr_b16 v[150:151], v214 offset:12800
    v_mfma_f32_16x16x32_bf16 v[60:63], a[192:195], v[140:143], 0
    buffer_load_dwordx4 v71, s[32:35], s14 offen offset:3072 lds
    v_lshlrev_b32 v78, 15, v89
    v_lshl_or_b32 v78, v78, 16, v78
    s_waitcnt lgkmcnt(4)
    v_mfma_f32_16x16x32_bf16 v[0:3], v[144:147], a[4:7], v[0:3]
    ds_read_b64_tr_b16 v[128:129], v215 offset:4096
    ds_read_b64_tr_b16 v[130:131], v215 offset:4608
    v_mfma_f32_16x16x32_bf16 v[4:7], v[144:147], a[68:71], v[4:7]
    s_add_u32 m0, s97, 49152
    s_nop 0
    buffer_load_dwordx4 v226, s[28:31], s7 offen lds
    s_mov_b32 s72, 0x3fb8aa3b
    s_waitcnt lgkmcnt(5)
    v_mfma_f32_16x16x32_bf16 v[8:11], v[144:147], a[132:135], v[8:11]
    ds_read_b64_tr_b16 v[132:133], v215 offset:12288
    ds_read_b64_tr_b16 v[134:135], v215 offset:12800
    s_waitcnt lgkmcnt(6)
    v_mfma_f32_16x16x32_bf16 v[12:15], v[144:147], a[196:199], v[12:15]
    buffer_load_dwordx4 v227, s[28:31], s7 offen offset:1024 lds
    s_add_u32 s20, s96, 0
    s_and_b32 s20, s20, 7
    s_waitcnt lgkmcnt(4)
    v_mfma_f32_16x16x32_bf16 v[32:35], a[4:7], v[148:151], v[32:35]
    buffer_load_dwordx4 v228, s[28:31], s7 offen offset:2048 lds
    s_mul_i32 s20, s20, 176128
    v_mfma_f32_16x16x32_bf16 v[36:39], a[68:71], v[148:151], v[36:39]
    s_add_u32 s21, s96, 1
    s_and_b32 s21, s21, 7
    s_mul_i32 s21, s21, 176128
    v_mfma_f32_16x16x32_bf16 v[40:43], a[132:135], v[148:151], v[40:43]
    buffer_load_dwordx4 v229, s[28:31], s7 offen offset:3072 lds
    s_add_u32 s22, s96, 2
    v_mfma_f32_16x16x32_bf16 v[44:47], a[196:199], v[148:151], v[44:47]
    s_and_b32 s22, s22, 7
    s_mul_i32 s22, s22, 176128
    s_add_u32 s23, s96, 3
    s_waitcnt lgkmcnt(2)
    v_mfma_f32_16x16x32_bf16 v[16:19], v[128:131], a[4:7], v[16:19]
    s_add_u32 m0, s97, 114688
    s_nop 0
    buffer_load_dwordx4 v68, s[32:35], s15 offen lds
    v_mfma_f32_16x16x32_bf16 v[20:23], v[128:131], a[68:71], v[20:23]
    s_and_b32 s23, s23, 7
    s_mul_i32 s23, s23, 176128
    s_add_u32 s24, s96, 4
    v_mfma_f32_16x16x32_bf16 v[24:27], v[128:131], a[132:135], v[24:27]
    v_mfma_f32_16x16x32_bf16 v[28:31], v[128:131], a[196:199], v[28:31]
    s_waitcnt lgkmcnt(0)
    s_waitcnt vmcnt(13)
    s_barrier
    ds_read_b128 a[8:11], v200 offset:16384
    ds_read_b128 a[72:75], v200 offset:18432
    buffer_load_dwordx4 v69, s[32:35], s15 offen offset:1024 lds
    v_mfma_f32_16x16x32_bf16 v[48:51], a[4:7], v[132:135], v[48:51]
    ds_read_b64_tr_b16 v[136:137], v214 offset:16384
    ds_read_b64_tr_b16 v[138:139], v214 offset:16896
    v_mfma_f32_16x16x32_bf16 v[52:55], a[68:71], v[132:135], v[52:55]
    buffer_load_dwordx4 v70, s[32:35], s15 offen offset:2048 lds
    s_and_b32 s24, s24, 7
    s_mul_i32 s24, s24, 176128
    v_mfma_f32_16x16x32_bf16 v[56:59], a[132:135], v[132:135], v[56:59]
    ds_read_b128 a[136:139], v200 offset:20480
    ds_read_b128 a[200:203], v200 offset:22528
    v_mfma_f32_16x16x32_bf16 v[60:63], a[196:199], v[132:135], v[60:63]
    buffer_load_dwordx4 v71, s[32:35], s15 offen offset:3072 lds
    s_add_u32 s25, s96, 5
    s_and_b32 s25, s25, 7
    s_waitcnt lgkmcnt(2)
    v_mfma_f32_16x16x32_bf16 v[0:3], v[136:139], a[8:11], v[0:3]
    ds_read_b64_tr_b16 v[140:141], v214 offset:24576
    ds_read_b64_tr_b16 v[142:143], v214 offset:25088
    v_mfma_f32_16x16x32_bf16 v[4:7], v[136:139], a[72:75], v[4:7]
    s_add_u32 m0, s97, 0
    s_nop 0
    buffer_load_dwordx4 v226, s[28:31], s8 offen lds
    s_mul_i32 s25, s25, 176128
    s_waitcnt lgkmcnt(3)
    v_mfma_f32_16x16x32_bf16 v[8:11], v[136:139], a[136:139], v[8:11]
    ds_read_b64_tr_b16 v[144:145], v215 offset:16384
    ds_read_b64_tr_b16 v[146:147], v215 offset:16896
    s_waitcnt lgkmcnt(4)
    v_mfma_f32_16x16x32_bf16 v[12:15], v[136:139], a[200:203], v[12:15]
    buffer_load_dwordx4 v227, s[28:31], s8 offen offset:1024 lds
    s_add_u32 s26, s96, 6
    s_and_b32 s26, s26, 7
    s_waitcnt lgkmcnt(2)
    v_mfma_f32_16x16x32_bf16 v[32:35], a[8:11], v[140:143], v[32:35]
    ds_read_b64_tr_b16 v[148:149], v215 offset:24576
    ds_read_b64_tr_b16 v[150:151], v215 offset:25088
    v_mfma_f32_16x16x32_bf16 v[36:39], a[72:75], v[140:143], v[36:39]
    s_mul_i32 s26, s26, 176128
    s_add_u32 s27, s96, 7
    s_and_b32 s27, s27, 7
    v_mfma_f32_16x16x32_bf16 v[40:43], a[136:139], v[140:143], v[40:43]
    ds_read_b128 a[12:15], v201 offset:16384
    ds_read_b128 a[76:79], v201 offset:18432
    v_mfma_f32_16x16x32_bf16 v[44:47], a[200:203], v[140:143], v[44:47]
    buffer_load_dwordx4 v228, s[28:31], s8 offen offset:2048 lds
    s_mul_i32 s27, s27, 176128
    s_mul_i32 s101, s92, 88064
    s_waitcnt lgkmcnt(4)
    v_mfma_f32_16x16x32_bf16 v[16:19], v[144:147], a[8:11], v[16:19]
    ds_read_b64_tr_b16 v[128:129], v214 offset:20480
    ds_read_b64_tr_b16 v[130:131], v214 offset:20992
    v_mfma_f32_16x16x32_bf16 v[20:23], v[144:147], a[72:75], v[20:23]
    s_lshl_b32 s3, s95, 7
    s_add_u32 s101, s101, s3
    v_lshrrev_b32 v92, 3, v255
    v_mfma_f32_16x16x32_bf16 v[24:27], v[144:147], a[136:139], v[24:27]
    ds_read_b128 a[140:143], v201 offset:20480
    ds_read_b128 a[204:207], v201 offset:22528
    v_mfma_f32_16x16x32_bf16 v[28:31], v[144:147], a[200:203], v[28:31]
    buffer_load_dwordx4 v229, s[28:31], s8 offen offset:3072 lds
    v_mul_u32_u24 v91, 0xac0, v92
    v_add_u32 v90, s101, v91
    s_waitcnt lgkmcnt(6)
    v_mfma_f32_16x16x32_bf16 v[48:51], a[8:11], v[148:151], v[48:51]
    ds_read_b64_tr_b16 v[132:133], v214 offset:28672
    ds_read_b64_tr_b16 v[134:135], v214 offset:29184
    v_mfma_f32_16x16x32_bf16 v[52:55], a[72:75], v[148:151], v[52:55]
    s_add_u32 m0, s97, 65536
    v_and_b32 v96, 7, v255
    v_lshrrev_b32 v95, 1, v96
    v_mfma_f32_16x16x32_bf16 v[56:59], a[136:139], v[148:151], v[56:59]
    ds_read_b64_tr_b16 v[136:137], v215 offset:20480
    ds_read_b64_tr_b16 v[138:139], v215 offset:20992
    v_mfma_f32_16x16x32_bf16 v[60:63], a[200:203], v[148:151], v[60:63]
    buffer_load_dwordx4 v68, s[32:35], s16 offen lds
    v_xor_b32 v94, v95, v86
    v_and_b32 v98, 1, v255
    s_waitcnt lgkmcnt(6)
    v_mfma_f32_16x16x32_bf16 v[0:3], v[128:131], a[12:15], v[0:3]
    ds_read_b64_tr_b16 v[140:141], v215 offset:28672
    ds_read_b64_tr_b16 v[142:143], v215 offset:29184
    v_mfma_f32_16x16x32_bf16 v[4:7], v[128:131], a[76:79], v[4:7]
    v_lshlrev_b32 v97, 4, v98
    v_lshl_add_u32 v93, v94, 5, v97
    v_add_u32 v210, v90, v93
    s_waitcnt lgkmcnt(7)
    v_mfma_f32_16x16x32_bf16 v[8:11], v[128:131], a[140:143], v[8:11]
    buffer_load_dwordx4 v69, s[32:35], s16 offen offset:1024 lds
    v_add_u32 v100, 0x5200, v91
    s_waitcnt lgkmcnt(6)
    v_mfma_f32_16x16x32_bf16 v[12:15], v[128:131], a[204:207], v[12:15]
    v_add_u32 v99, s101, v100
    v_xor_b32 v102, 2, v94
    v_lshl_add_u32 v101, v102, 5, v97
    s_waitcnt lgkmcnt(4)
    v_mfma_f32_16x16x32_bf16 v[32:35], a[12:15], v[132:135], v[32:35]
    buffer_load_dwordx4 v70, s[32:35], s16 offen offset:2048 lds
    v_add_u32 v211, v99, v101
    v_mfma_f32_16x16x32_bf16 v[36:39], a[76:79], v[132:135], v[36:39]
    v_add_u32 v104, 0xa400, v91
    v_add_u32 v103, s101, v104
    v_add_u32 v212, v103, v93
    v_mfma_f32_16x16x32_bf16 v[40:43], a[140:143], v[132:135], v[40:43]
    v_add_u32 v106, 0xf600, v91
    v_add_u32 v105, s101, v106
    v_mfma_f32_16x16x32_bf16 v[44:47], a[204:207], v[132:135], v[44:47]
    v_add_u32 v213, v105, v101
    s_lshl_b32 s101, s93, 14
    s_lshl_b32 s3, s92, 12
    s_waitcnt lgkmcnt(0)
    v_mfma_f32_16x16x32_bf16 v[16:19], v[136:139], a[12:15], v[16:19]
    buffer_load_dwordx4 v71, s[32:35], s16 offen offset:3072 lds
    s_add_u32 s101, s101, s3
    v_mfma_f32_16x16x32_bf16 v[20:23], v[136:139], a[76:79], v[20:23]
    v_and_b32 v108, 31, v255
    v_lshl_add_u32 v107, v108, 6, s101
    v_lshlrev_b32 v111, 1, v82
    v_mfma_f32_16x16x32_bf16 v[24:27], v[136:139], a[140:143], v[24:27]
    v_mfma_f32_16x16x32_bf16 v[28:31], v[136:139], a[204:207], v[28:31]
    s_waitcnt vmcnt(16)
    s_barrier
    ds_read_b64_tr_b16 v[160:161], v77 offset:0
    ds_read_b64_tr_b16 v[162:163], v77 offset:128
    ds_read_b64_tr_b16 v[164:165], v77 offset:512
    ds_read_b64_tr_b16 v[166:167], v77 offset:640
    s_add_u32 s1, s2, s91
    s_cmp_lg_u32 s1, 0
    s_cbranch_scc1 L_ep12
    v_add_u32 v241, 0x9e3779b8, v241
    v_or_b32 v241, 1, v241
    s_mov_b32 s1, 8077312
    buffer_store_dword v241, v237, s[44:47], 0 offen sc1
    buffer_store_dword v241, v237, s[40:43], s1 offen sc1
L_ep12:
    s_cmp_lg_u32 s94, 0
    s_cbranch_scc1 L_nz2
    v_mov_b32 v239, 1
    buffer_store_dword v239, v237, s[44:47], s73 offen offset:32 sc1
L_nz2:
    ds_read_b128 a[16:19], v200 offset:32768
    ds_read_b128 a[80:83], v200 offset:34816
    v_mfma_f32_16x16x32_bf16 v[48:51], a[12:15], v[140:143], v[48:51]
    ds_read_b64_tr_b16 v[144:145], v214 offset:32768
    ds_read_b64_tr_b16 v[146:147], v214 offset:33280
    v_mfma_f32_16x16x32_bf16 v[52:55], a[76:79], v[140:143], v[52:55]
    s_add_u32 m0, s97, 16384
    s_nop 0
    buffer_load_dwordx4 v226, s[28:31], s9 offen lds
    v_bfe_u32 v112, v108, 1, 2
    v_mfma_f32_16x16x32_bf16 v[56:59], a[140:143], v[140:143], v[56:59]
    ds_read_b128 a[144:147], v200 offset:36864
    ds_read_b128 a[208:211], v200 offset:38912
    v_mfma_f32_16x16x32_bf16 v[60:63], a[204:207], v[140:143], v[60:63]
    v_xor_b32 v110, v111, v112
    v_lshlrev_b32 v109, 4, v110
    v_add_u32 v216, v107, v109
    s_waitcnt lgkmcnt(2)
    v_mfma_f32_16x16x32_bf16 v[0:3], v[144:147], a[16:19], v[0:3]
    ds_read_b64_tr_b16 v[148:149], v214 offset:40960
    ds_read_b64_tr_b16 v[150:151], v214 offset:41472
    v_mfma_f32_16x16x32_bf16 v[4:7], v[144:147], a[80:83], v[4:7]
    buffer_load_dwordx4 v227, s[28:31], s9 offen offset:1024 lds
    v_lshl_add_u32 v113, v108, 6, s101
    v_xor_b32 v115, 1, v110
    s_waitcnt lgkmcnt(3)
    v_mfma_f32_16x16x32_bf16 v[8:11], v[144:147], a[144:147], v[8:11]
    ds_read_b64_tr_b16 v[128:129], v215 offset:32768
    ds_read_b64_tr_b16 v[130:131], v215 offset:33280
    s_waitcnt lgkmcnt(4)
    v_mfma_f32_16x16x32_bf16 v[12:15], v[144:147], a[208:211], v[12:15]
    v_lshlrev_b32 v114, 4, v115
    v_add_u32 v217, v113, v114
    s_lshl_b32 s101, s93, 13
    s_waitcnt lgkmcnt(2)
    v_mfma_f32_16x16x32_bf16 v[32:35], a[16:19], v[148:151], v[32:35]
    ds_read_b64_tr_b16 v[132:133], v215 offset:40960
    ds_read_b64_tr_b16 v[134:135], v215 offset:41472
    v_mfma_f32_16x16x32_bf16 v[36:39], a[80:83], v[148:151], v[36:39]
    buffer_load_dwordx4 v228, s[28:31], s9 offen offset:2048 lds
    s_lshl_b32 s3, s92, 11
    s_add_u32 s101, s101, s3
    v_mfma_f32_16x16x32_bf16 v[40:43], a[144:147], v[148:151], v[40:43]
    ds_read_b128 a[20:23], v201 offset:32768
    ds_read_b128 a[84:87], v201 offset:34816
    v_mfma_f32_16x16x32_bf16 v[44:47], a[208:211], v[148:151], v[44:47]
    buffer_load_dwordx4 v229, s[28:31], s9 offen offset:3072 lds
    s_add_u32 s101, s101, 32768
    v_and_b32 v117, 15, v255
    s_waitcnt lgkmcnt(4)
    v_mfma_f32_16x16x32_bf16 v[16:19], v[128:131], a[16:19], v[16:19]
    ds_read_b64_tr_b16 v[136:137], v214 offset:36864
    ds_read_b64_tr_b16 v[138:139], v214 offset:37376
    v_mfma_f32_16x16x32_bf16 v[20:23], v[128:131], a[80:83], v[20:23]
    s_add_u32 m0, s97, 81920
    v_lshl_add_u32 v116, v117, 5, s101
    v_lshrrev_b32 v120, 4, v255
    v_mfma_f32_16x16x32_bf16 v[24:27], v[128:131], a[144:147], v[24:27]
    ds_read_b128 a[148:151], v201 offset:36864
    ds_read_b128 a[212:215], v201 offset:38912
    v_mfma_f32_16x16x32_bf16 v[28:31], v[128:131], a[208:211], v[28:31]
    buffer_load_dwordx4 v68, s[32:35], s17 offen lds
    v_lshrrev_b32 v122, 1, v255
    v_and_b32 v121, 2, v122
    s_waitcnt lgkmcnt(6)
    v_mfma_f32_16x16x32_bf16 v[48:51], a[16:19], v[132:135], v[48:51]
    ds_read_b64_tr_b16 v[140:141], v214 offset:45056
    ds_read_b64_tr_b16 v[142:143], v214 offset:45568
    v_mfma_f32_16x16x32_bf16 v[52:55], a[80:83], v[132:135], v[52:55]
    v_xor_b32 v119, v120, v121
    v_lshlrev_b32 v118, 3, v119
    v_add_u32 v218, v116, v118
    v_mfma_f32_16x16x32_bf16 v[56:59], a[144:147], v[132:135], v[56:59]
    ds_read_b64_tr_b16 v[144:145], v215 offset:36864
    ds_read_b64_tr_b16 v[146:147], v215 offset:37376
    v_mfma_f32_16x16x32_bf16 v[60:63], a[208:211], v[132:135], v[60:63]
    buffer_load_dwordx4 v69, s[32:35], s17 offen offset:1024 lds
    s_lshl_b32 s101, s91, 13
    v_lshl_add_u32 v123, v81, 6, s101
    s_waitcnt lgkmcnt(6)
    v_mfma_f32_16x16x32_bf16 v[0:3], v[136:139], a[20:23], v[0:3]
    ds_read_b64_tr_b16 v[148:149], v215 offset:45056
    ds_read_b64_tr_b16 v[150:151], v215 offset:45568
    v_mfma_f32_16x16x32_bf16 v[4:7], v[136:139], a[84:87], v[4:7]
    v_lshrrev_b32 v170, 1, v83
    v_xor_b32 v169, v85, v170
    v_and_b32 v172, 1, v88
    s_waitcnt lgkmcnt(7)
    v_mfma_f32_16x16x32_bf16 v[8:11], v[136:139], a[148:151], v[8:11]
    buffer_load_dwordx4 v70, s[32:35], s17 offen offset:2048 lds
    v_lshlrev_b32 v171, 3, v172
    s_waitcnt lgkmcnt(6)
    v_mfma_f32_16x16x32_bf16 v[12:15], v[136:139], a[212:215], v[12:15]
    v_lshl_add_u32 v168, v169, 4, v171
    v_add_u32 v208, v123, v168
    v_xor_b32 v209, 32, v208
    s_waitcnt lgkmcnt(4)
    v_mfma_f32_16x16x32_bf16 v[32:35], a[20:23], v[140:143], v[32:35]
    buffer_load_dwordx4 v71, s[32:35], s17 offen offset:3072 lds
    v_lshlrev_b32 v173, 2, v108
    v_mfma_f32_16x16x32_bf16 v[36:39], a[84:87], v[140:143], v[36:39]
    v_lshl_add_u32 v222, v82, 9, v173
    v_lshl_add_u32 v223, v82, 31, v173
    s_lshl_b32 s101, s94, 2
    v_mfma_f32_16x16x32_bf16 v[40:43], a[148:151], v[140:143], v[40:43]
    s_lshl_b32 s3, s92, 1
    s_add_u32 s101, s101, s3
    v_mfma_f32_16x16x32_bf16 v[44:47], a[212:215], v[140:143], v[44:47]
    s_mul_i32 s101, s101, 88064
    s_lshl_b32 s3, s95, 12
    s_add_u32 s101, s101, s3
    s_waitcnt lgkmcnt(0)
    v_mfma_f32_16x16x32_bf16 v[16:19], v[144:147], a[20:23], v[16:19]
    s_lshl_b32 s3, s93, 11
    s_add_u32 s68, s101, s3
    v_mfma_f32_16x16x32_bf16 v[20:23], v[144:147], a[84:87], v[20:23]
    s_add_u32 s69, s68, 88064
    s_lshl_b32 s101, s73, 9
    s_lshl_b32 s3, s94, 7
    v_mfma_f32_16x16x32_bf16 v[24:27], v[144:147], a[148:151], v[24:27]
    v_mfma_f32_16x16x32_bf16 v[28:31], v[144:147], a[212:215], v[28:31]
    s_waitcnt vmcnt(16)
    s_barrier
    buffer_load_dword v152, v152, s[48:51], 0 offen
    buffer_load_dword v153, v153, s[52:55], 0 offen
    ds_read_b128 a[24:27], v200 offset:49152
    ds_read_b128 a[88:91], v200 offset:51200
    v_mfma_f32_16x16x32_bf16 v[48:51], a[20:23], v[148:151], v[48:51]
    ds_read_b64_tr_b16 v[128:129], v214 offset:49152
    ds_read_b64_tr_b16 v[130:131], v214 offset:49664
    v_mfma_f32_16x16x32_bf16 v[52:55], a[84:87], v[148:151], v[52:55]
    s_add_u32 m0, s97, 32768
    s_nop 0
    buffer_load_dwordx4 v226, s[28:31], s10 offen lds
    s_add_u32 s101, s101, s3
    v_mfma_f32_16x16x32_bf16 v[56:59], a[148:151], v[148:151], v[56:59]
    ds_read_b128 a[152:155], v200 offset:53248
    ds_read_b128 a[216:219], v200 offset:55296
    v_mfma_f32_16x16x32_bf16 v[60:63], a[212:215], v[148:151], v[60:63]
    buffer_load_dwordx4 v227, s[28:31], s10 offen offset:1024 lds
    s_add_u32 s74, s101, 7946240
    s_lshl_b32 s101, s94, 1
    s_waitcnt lgkmcnt(2)
    v_mfma_f32_16x16x32_bf16 v[0:3], v[128:131], a[24:27], v[0:3]
    ds_read_b64_tr_b16 v[132:133], v214 offset:57344
    ds_read_b64_tr_b16 v[134:135], v214 offset:57856
    v_mfma_f32_16x16x32_bf16 v[4:7], v[128:131], a[88:91], v[4:7]
    s_add_u32 s101, s101, s92
    s_lshl_b32 s101, s101, 12
    s_lshl_b32 s3, s95, 8
    s_waitcnt lgkmcnt(3)
    v_mfma_f32_16x16x32_bf16 v[8:11], v[128:131], a[152:155], v[8:11]
    ds_read_b64_tr_b16 v[136:137], v215 offset:49152
    ds_read_b64_tr_b16 v[138:139], v215 offset:49664
    s_waitcnt lgkmcnt(4)
    v_mfma_f32_16x16x32_bf16 v[12:15], v[128:131], a[216:219], v[12:15]
    buffer_load_dwordx4 v228, s[28:31], s10 offen offset:2048 lds
    s_add_u32 s101, s101, s3
    s_lshl_b32 s3, s93, 7
    s_waitcnt lgkmcnt(2)
    v_mfma_f32_16x16x32_bf16 v[32:35], a[24:27], v[132:135], v[32:35]
    ds_read_b64_tr_b16 v[140:141], v215 offset:57344
    ds_read_b64_tr_b16 v[142:143], v215 offset:57856
    v_mfma_f32_16x16x32_bf16 v[36:39], a[88:91], v[132:135], v[36:39]
    s_add_u32 s101, s101, s3
    s_add_u32 s70, s101, 7815168
    s_lshr_b32 s101, s2, 3
    v_mfma_f32_16x16x32_bf16 v[40:43], a[152:155], v[132:135], v[40:43]
    ds_read_b128 a[28:31], v201 offset:49152
    ds_read_b128 a[92:95], v201 offset:51200
    v_mfma_f32_16x16x32_bf16 v[44:47], a[216:219], v[132:135], v[44:47]
    buffer_load_dwordx4 v229, s[28:31], s10 offen offset:3072 lds
    s_and_b32 s101, s101, 15
    s_lshl_b32 s101, s101, 2
    s_waitcnt lgkmcnt(4)
    v_mfma_f32_16x16x32_bf16 v[16:19], v[136:139], a[24:27], v[16:19]
    ds_read_b64_tr_b16 v[144:145], v214 offset:53248
    ds_read_b64_tr_b16 v[146:147], v214 offset:53760
    v_mfma_f32_16x16x32_bf16 v[20:23], v[136:139], a[88:91], v[20:23]
    s_add_u32 m0, s97, 98304
    s_add_u32 s101, s101, s91
    s_mul_i32 s71, s101, 22528
    v_mfma_f32_16x16x32_bf16 v[24:27], v[136:139], a[152:155], v[24:27]
    ds_read_b128 a[156:159], v201 offset:53248
    ds_read_b128 a[220:223], v201 offset:55296
    v_mfma_f32_16x16x32_bf16 v[28:31], v[136:139], a[216:219], v[28:31]
    buffer_load_dwordx4 v68, s[32:35], s18 offen lds
    s_lshl_b32 s101, s101, 13
    s_sub_u32 s101, s101, s71
    s_waitcnt lgkmcnt(6)
    v_mfma_f32_16x16x32_bf16 v[48:51], a[24:27], v[140:143], v[48:51]
    ds_read_b64_tr_b16 v[148:149], v214 offset:61440
    ds_read_b64_tr_b16 v[150:151], v214 offset:61952
    v_mfma_f32_16x16x32_bf16 v[52:55], a[88:91], v[140:143], v[52:55]
    buffer_load_dwordx4 v69, s[32:35], s18 offen offset:1024 lds
    v_lshrrev_b32 v174, 2, v255
    v_lshlrev_b32 v176, 7, v88
    v_mfma_f32_16x16x32_bf16 v[56:59], a[152:155], v[140:143], v[56:59]
    ds_read_b64_tr_b16 v[128:129], v215 offset:53248
    ds_read_b64_tr_b16 v[130:131], v215 offset:53760
    v_mfma_f32_16x16x32_bf16 v[60:63], a[216:219], v[140:143], v[60:63]
    v_add_u32 v175, 0x200, v176
    v_lshl_add_u32 v156, v174, 10, v175
    v_add_u32 v178, 40, v255
    s_waitcnt lgkmcnt(6)
    v_mfma_f32_16x16x32_bf16 v[0:3], v[144:147], a[28:31], v[0:3]
    ds_read_b64_tr_b16 v[132:133], v215 offset:61440
    ds_read_b64_tr_b16 v[134:135], v215 offset:61952
    v_mfma_f32_16x16x32_bf16 v[4:7], v[144:147], a[92:95], v[4:7]
    buffer_load_dwordx4 v70, s[32:35], s18 offen offset:2048 lds
    v_lshrrev_b32 v177, 6, v178
    v_lshlrev_b32 v181, 10, v174
    s_waitcnt lgkmcnt(7)
    v_mfma_f32_16x16x32_bf16 v[8:11], v[144:147], a[156:159], v[8:11]
    v_xor_b32 v160, v160, v78
    v_xor_b32 v161, v161, v78
    s_waitcnt lgkmcnt(6)
    v_mfma_f32_16x16x32_bf16 v[12:15], v[144:147], a[220:223], v[12:15]
    v_xor_b32 v162, v162, v78
    v_add_u32 v180, 0x4000, v181
    v_add_u32 v179, v180, v175
    s_waitcnt lgkmcnt(4)
    v_mfma_f32_16x16x32_bf16 v[32:35], a[28:31], v[148:151], v[32:35]
    v_xor_b32 v163, v163, v78
    v_xor_b32 v164, v164, v78
    v_mfma_f32_16x16x32_bf16 v[36:39], a[92:95], v[148:151], v[36:39]
    v_xor_b32 v165, v165, v78
    buffer_load_dwordx4 v71, s[32:35], s18 offen offset:3072 lds
    v_lshl_add_u32 v157, v177, 31, v179
    v_mfma_f32_16x16x32_bf16 v[40:43], a[156:159], v[148:151], v[40:43]
    v_xor_b32 v166, v166, v78
    v_xor_b32 v167, v167, v78
    v_mfma_f32_16x16x32_bf16 v[44:47], a[220:223], v[148:151], v[44:47]
    v_lshl_add_u32 v182, v82, 31, s101
    v_add_u32 v183, v181, v175
    v_add_u32 v158, v182, v183
    s_waitcnt lgkmcnt(0)
    v_mfma_f32_16x16x32_bf16 v[16:19], v[128:131], a[28:31], v[16:19]
    s_mul_i32 s101, s99, 7
    s_lshr_b32 s101, s101, 3
    v_mfma_f32_16x16x32_bf16 v[20:23], v[128:131], a[92:95], v[20:23]
    s_mul_i32 s3, s100, 7
    s_lshr_b32 s3, s3, 2
    s_add_u32 s90, s101, s3
    v_mfma_f32_16x16x32_bf16 v[24:27], v[128:131], a[156:159], v[24:27]
    v_mfma_f32_16x16x32_bf16 v[28:31], v[128:131], a[220:223], v[28:31]
    s_waitcnt vmcnt(18)
    s_barrier
    ds_read_b128 a[32:35], v200 offset:0
    ds_read_b128 a[96:99], v200 offset:2048
    s_sub_u32 s101, s90, 7
    v_mfma_f32_16x16x32_bf16 v[48:51], a[28:31], v[132:135], v[48:51]
    ds_read_b64_tr_b16 v[136:137], v214 offset:0
    ds_read_b64_tr_b16 v[138:139], v214 offset:512
    v_mfma_f32_16x16x32_bf16 v[52:55], a[92:95], v[132:135], v[52:55]
    s_add_u32 m0, s97, 49152
    s_nop 0
    buffer_load_dwordx4 v226, s[28:31], s11 offen lds
    s_min_u32 s90, s90, s101
    v_mfma_f32_16x16x32_bf16 v[56:59], a[156:159], v[132:135], v[56:59]
    ds_read_b128 a[160:163], v200 offset:4096
    ds_read_b128 a[224:227], v200 offset:6144
    v_mfma_f32_16x16x32_bf16 v[60:63], a[220:223], v[132:135], v[60:63]
    buffer_load_dwordx4 v227, s[28:31], s11 offen offset:1024 lds
    s_mul_i32 s3, s91, 7
    s_add_u32 s3, s3, 16
    s_waitcnt lgkmcnt(2)
    v_mfma_f32_16x16x32_bf16 v[0:3], v[136:139], a[32:35], v[0:3]
    ds_read_b64_tr_b16 v[140:141], v214 offset:8192
L_pad_kv_0:
    s_cbranch_execz L_walked_kv
    ds_read_b64_tr_b16 v[142:143], v214 offset:8704
    v_mfma_f32_16x16x32_bf16 v[4:7], v[136:139], a[96:99], v[4:7]
    s_add_u32 s76, s90, 0
    s_sub_u32 s101, s76, 7
    s_min_u32 s76, s76, s101
    s_waitcnt lgkmcnt(3)
    v_mfma_f32_16x16x32_bf16 v[8:11], v[136:139], a[160:163], v[8:11]
    ds_read_b64_tr_b16 v[144:145], v215 offset:0
    ds_read_b64_tr_b16 v[146:147], v215 offset:512
    s_waitcnt lgkmcnt(4)
    v_mfma_f32_16x16x32_bf16 v[12:15], v[136:139], a[224:227], v[12:15]
    buffer_load_dwordx4 v228, s[28:31], s11 offen offset:2048 lds
    s_add_u32 s76, s76, s3
    s_lshl_b32 s76, s76, 15
    s_waitcnt lgkmcnt(2)
    v_mfma_f32_16x16x32_bf16 v[32:35], a[32:35], v[140:143], v[32:35]
    ds_read_b64_tr_b16 v[148:149], v215 offset:8192
    ds_read_b64_tr_b16 v[150:151], v215 offset:8704
    v_mfma_f32_16x16x32_bf16 v[36:39], a[96:99], v[140:143], v[36:39]
    s_add_u32 s77, s90, 1
    s_sub_u32 s101, s77, 7
    s_min_u32 s77, s77, s101
    v_mfma_f32_16x16x32_bf16 v[40:43], a[160:163], v[140:143], v[40:43]
    ds_read_b128 a[36:39], v201 offset:0
    ds_read_b128 a[100:103], v201 offset:2048
    v_mfma_f32_16x16x32_bf16 v[44:47], a[224:227], v[140:143], v[44:47]
    buffer_load_dwordx4 v229, s[28:31], s11 offen offset:3072 lds
    s_add_u32 s77, s77, s3
    s_lshl_b32 s77, s77, 15
    s_waitcnt lgkmcnt(4)
    v_mfma_f32_16x16x32_bf16 v[16:19], v[144:147], a[32:35], v[16:19]
    ds_read_b64_tr_b16 v[128:129], v214 offset:4096
    ds_read_b64_tr_b16 v[130:131], v214 offset:4608
    v_mfma_f32_16x16x32_bf16 v[20:23], v[144:147], a[96:99], v[20:23]
    s_add_u32 m0, s97, 114688
    s_add_u32 s78, s90, 2
    s_sub_u32 s101, s78, 7
    v_mfma_f32_16x16x32_bf16 v[24:27], v[144:147], a[160:163], v[24:27]
    ds_read_b128 a[164:167], v201 offset:4096
    ds_read_b128 a[228:231], v201 offset:6144
    v_mfma_f32_16x16x32_bf16 v[28:31], v[144:147], a[224:227], v[28:31]
    buffer_load_dwordx4 v68, s[32:35], s19 offen lds
    s_min_u32 s78, s78, s101
    s_add_u32 s78, s78, s3
    s_waitcnt lgkmcnt(6)
    v_mfma_f32_16x16x32_bf16 v[48:51], a[32:35], v[148:151], v[48:51]
    ds_read_b64_tr_b16 v[132:133], v214 offset:12288
    ds_read_b64_tr_b16 v[134:135], v214 offset:12800
    v_mfma_f32_16x16x32_bf16 v[52:55], a[96:99], v[148:151], v[52:55]
    buffer_load_dwordx4 v69, s[32:35], s19 offen offset:1024 lds
    s_lshl_b32 s78, s78, 15
    s_add_u32 s79, s90, 3
    v_mfma_f32_16x16x32_bf16 v[56:59], a[160:163], v[148:151], v[56:59]
    ds_read_b64_tr_b16 v[136:137], v215 offset:4096
    ds_read_b64_tr_b16 v[138:139], v215 offset:4608
    v_mfma_f32_16x16x32_bf16 v[60:63], a[224:227], v[148:151], v[60:63]
    s_sub_u32 s101, s79, 7
    s_min_u32 s79, s79, s101
    s_add_u32 s79, s79, s3
    s_waitcnt lgkmcnt(6)
    v_mfma_f32_16x16x32_bf16 v[0:3], v[128:131], a[36:39], v[0:3]
    ds_read_b64_tr_b16 v[140:141], v215 offset:12288
    ds_read_b64_tr_b16 v[142:143], v215 offset:12800
    v_mfma_f32_16x16x32_bf16 v[4:7], v[128:131], a[100:103], v[4:7]
    buffer_load_dwordx4 v70, s[32:35], s19 offen offset:2048 lds
    s_lshl_b32 s79, s79, 15
    s_add_u32 s80, s90, 4
    s_waitcnt lgkmcnt(7)
    v_mfma_f32_16x16x32_bf16 v[8:11], v[128:131], a[164:167], v[8:11]
    s_sub_u32 s101, s80, 7
    s_min_u32 s80, s80, s101
    s_waitcnt lgkmcnt(6)
    v_mfma_f32_16x16x32_bf16 v[12:15], v[128:131], a[228:231], v[12:15]
    s_add_u32 s80, s80, s3
    s_lshl_b32 s80, s80, 15
    s_add_u32 s81, s90, 5
    s_waitcnt lgkmcnt(4)
    v_mfma_f32_16x16x32_bf16 v[32:35], a[36:39], v[132:135], v[32:35]
    buffer_load_dwordx4 v71, s[32:35], s19 offen offset:3072 lds
    s_sub_u32 s101, s81, 7
    v_mfma_f32_16x16x32_bf16 v[36:39], a[100:103], v[132:135], v[36:39]
    s_min_u32 s81, s81, s101
    s_add_u32 s81, s81, s3
    s_lshl_b32 s81, s81, 15
    v_mfma_f32_16x16x32_bf16 v[40:43], a[164:167], v[132:135], v[40:43]
    s_add_u32 s82, s90, 6
    s_sub_u32 s101, s82, 7
    v_mfma_f32_16x16x32_bf16 v[44:47], a[228:231], v[132:135], v[44:47]
    s_min_u32 s82, s82, s101
    s_add_u32 s82, s82, s3
    s_lshl_b32 s82, s82, 15
    s_waitcnt lgkmcnt(0)
    v_mfma_f32_16x16x32_bf16 v[16:19], v[136:139], a[36:39], v[16:19]
    s_lshr_b32 s101, s99, 1
    s_add_u32 s101, s101, s100
    v_mfma_f32_16x16x32_bf16 v[20:23], v[136:139], a[100:103], v[20:23]
    s_lshl_b32 s3, s91, 2
    s_add_u32 s87, s101, 0
    s_and_b32 s87, s87, 3
    v_mfma_f32_16x16x32_bf16 v[24:27], v[136:139], a[164:167], v[24:27]
    v_mfma_f32_16x16x32_bf16 v[28:31], v[136:139], a[228:231], v[28:31]
    s_waitcnt vmcnt(18)
    s_barrier
    ds_read_b128 a[40:43], v200 offset:16384
    ds_read_b128 a[104:107], v200 offset:18432
    s_add_u32 s87, s87, s3
    v_mfma_f32_16x16x32_bf16 v[48:51], a[36:39], v[140:143], v[48:51]
    ds_read_b64_tr_b16 v[144:145], v214 offset:16384
    ds_read_b64_tr_b16 v[146:147], v214 offset:16896
    v_mfma_f32_16x16x32_bf16 v[52:55], a[100:103], v[140:143], v[52:55]
    s_add_u32 m0, s97, 65536
    s_nop 0
    buffer_load_dwordx4 v210, s[36:39], s20 offen lds
    s_lshl_b32 s87, s87, 15
    v_mfma_f32_16x16x32_bf16 v[56:59], a[164:167], v[140:143], v[56:59]
    ds_read_b128 a[168:171], v200 offset:20480
    ds_read_b128 a[232:235], v200 offset:22528
    v_mfma_f32_16x16x32_bf16 v[60:63], a[228:231], v[140:143], v[60:63]
    s_mov_b32 s83, s87
    s_add_u32 s88, s101, 1
    s_and_b32 s88, s88, 3
    s_waitcnt lgkmcnt(2)
    v_mfma_f32_16x16x32_bf16 v[0:3], v[144:147], a[40:43], v[0:3]
    ds_read_b64_tr_b16 v[148:149], v214 offset:24576
    ds_read_b64_tr_b16 v[150:151], v214 offset:25088
    v_mfma_f32_16x16x32_bf16 v[4:7], v[144:147], a[104:107], v[4:7]
    s_add_u32 s88, s88, s3
    s_lshl_b32 s88, s88, 15
    s_mov_b32 s84, s88
    s_waitcnt lgkmcnt(3)
    v_mfma_f32_16x16x32_bf16 v[8:11], v[144:147], a[168:171], v[8:11]
    ds_read_b64_tr_b16 v[128:129], v215 offset:16384
    ds_read_b64_tr_b16 v[130:131], v215 offset:16896
    s_waitcnt lgkmcnt(4)
    v_mfma_f32_16x16x32_bf16 v[12:15], v[144:147], a[232:235], v[12:15]
    buffer_load_dwordx4 v211, s[36:39], s20 offen offset:1024 lds
    s_add_u32 s89, s101, 2
    s_and_b32 s89, s89, 3
    s_waitcnt lgkmcnt(2)
    v_mfma_f32_16x16x32_bf16 v[32:35], a[40:43], v[148:151], v[32:35]
    ds_read_b64_tr_b16 v[132:133], v215 offset:24576
    ds_read_b64_tr_b16 v[134:135], v215 offset:25088
    v_mfma_f32_16x16x32_bf16 v[36:39], a[104:107], v[148:151], v[36:39]
    s_add_u32 s89, s89, s3
    s_lshl_b32 s89, s89, 15
    s_mov_b32 s85, s89
    v_mfma_f32_16x16x32_bf16 v[40:43], a[168:171], v[148:151], v[40:43]
    ds_read_b128 a[44:47], v201 offset:16384
    ds_read_b128 a[108:111], v201 offset:18432
    v_mfma_f32_16x16x32_bf16 v[44:47], a[232:235], v[148:151], v[44:47]
    s_add_u32 s90, s101, 3
    s_and_b32 s90, s90, 3
    s_add_u32 s90, s90, s3
    s_waitcnt lgkmcnt(4)
    v_mfma_f32_16x16x32_bf16 v[16:19], v[128:131], a[40:43], v[16:19]
    ds_read_b64_tr_b16 v[136:137], v214 offset:20480
    ds_read_b64_tr_b16 v[138:139], v214 offset:20992
    v_mfma_f32_16x16x32_bf16 v[20:23], v[128:131], a[104:107], v[20:23]
    s_lshl_b32 s90, s90, 15
    s_mov_b32 s86, s90
    s_lshl_b32 s101, s99, 7
    v_mfma_f32_16x16x32_bf16 v[24:27], v[128:131], a[168:171], v[24:27]
    ds_read_b128 a[172:175], v201 offset:20480
    ds_read_b128 a[236:239], v201 offset:22528
    v_mfma_f32_16x16x32_bf16 v[28:31], v[128:131], a[232:235], v[28:31]
    buffer_load_dwordx4 v212, s[36:39], s20 offen offset:2048 lds
    v_lshl_add_u32 v184, v92, 10, s101
    v_add_u32 v251, v184, v93
    s_waitcnt lgkmcnt(6)
    v_mfma_f32_16x16x32_bf16 v[48:51], a[40:43], v[132:135], v[48:51]
    ds_read_b64_tr_b16 v[140:141], v214 offset:28672
    ds_read_b64_tr_b16 v[142:143], v214 offset:29184
    v_mfma_f32_16x16x32_bf16 v[52:55], a[104:107], v[132:135], v[52:55]
    v_lshlrev_b32 v187, 10, v92
    v_add_u32 v186, 0x1c00, v187
    v_add_u32 v185, s101, v186
    v_mfma_f32_16x16x32_bf16 v[56:59], a[168:171], v[132:135], v[56:59]
    ds_read_b64_tr_b16 v[144:145], v215 offset:20480
    ds_read_b64_tr_b16 v[146:147], v215 offset:20992
    v_mfma_f32_16x16x32_bf16 v[60:63], a[232:235], v[132:135], v[60:63]
    v_add_u32 v252, v185, v101
    v_add_u32 v189, 0x3800, v187
    v_add_u32 v188, s101, v189
    s_waitcnt lgkmcnt(6)
    v_mfma_f32_16x16x32_bf16 v[0:3], v[136:139], a[44:47], v[0:3]
    ds_read_b64_tr_b16 v[148:149], v215 offset:28672
    ds_read_b64_tr_b16 v[150:151], v215 offset:29184
    v_mfma_f32_16x16x32_bf16 v[4:7], v[136:139], a[108:111], v[4:7]
    buffer_load_dwordx4 v213, s[36:39], s20 offen offset:3072 lds
    v_add_u32 v253, v188, v93
    v_add_u32 v191, 0x5400, v187
    s_waitcnt lgkmcnt(7)
    v_mfma_f32_16x16x32_bf16 v[8:11], v[136:139], a[172:175], v[8:11]
    v_add_u32 v190, s101, v191
    v_add_u32 v254, v190, v101
    s_waitcnt lgkmcnt(6)
    v_mfma_f32_16x16x32_bf16 v[12:15], v[136:139], a[236:239], v[12:15]
    s_waitcnt lgkmcnt(4)
    v_mfma_f32_16x16x32_bf16 v[32:35], a[44:47], v[140:143], v[32:35]
    v_mfma_f32_16x16x32_bf16 v[36:39], a[108:111], v[140:143], v[36:39]
    v_mfma_f32_16x16x32_bf16 v[40:43], a[172:175], v[140:143], v[40:43]
    v_mfma_f32_16x16x32_bf16 v[44:47], a[236:239], v[140:143], v[44:47]
    s_waitcnt lgkmcnt(2)
    v_mfma_f32_16x16x32_bf16 v[16:19], v[144:147], a[44:47], v[16:19]
    v_mfma_f32_16x16x32_bf16 v[20:23], v[144:147], a[108:111], v[20:23]
    v_mfma_f32_16x16x32_bf16 v[24:27], v[144:147], a[172:175], v[24:27]
    v_mfma_f32_16x16x32_bf16 v[28:31], v[144:147], a[236:239], v[28:31]
    s_waitcnt lgkmcnt(0)
    s_waitcnt vmcnt(12)
    s_barrier
    v_mov_b32 v240, 0
    buffer_load_dword v243, v240, s[44:47], 0 offen sc1
    buffer_load_dword v239, v240, s[44:47], s73 offen offset:32 sc1
    ds_read_b128 a[48:51], v200 offset:32768
    ds_read_b128 a[112:115], v200 offset:34816
    v_mfma_f32_16x16x32_bf16 v[48:51], a[44:47], v[148:151], v[48:51]
    ds_read_b64_tr_b16 v[128:129], v214 offset:32768
    ds_read_b64_tr_b16 v[130:131], v214 offset:33280
    v_mfma_f32_16x16x32_bf16 v[52:55], a[108:111], v[148:151], v[52:55]
    s_add_u32 m0, s97, 81920
    s_nop 0
    buffer_load_dwordx4 v210, s[36:39], s21 offen lds
    v_mfma_f32_16x16x32_bf16 v[56:59], a[172:175], v[148:151], v[56:59]
    ds_read_b128 a[176:179], v200 offset:36864
    ds_read_b128 a[240:243], v200 offset:38912
    v_mfma_f32_16x16x32_bf16 v[60:63], a[236:239], v[148:151], v[60:63]
    s_waitcnt lgkmcnt(2)
    v_mfma_f32_16x16x32_bf16 v[0:3], v[128:131], a[48:51], v[0:3]
    ds_read_b64_tr_b16 v[132:133], v214 offset:40960
    ds_read_b64_tr_b16 v[134:135], v214 offset:41472
    v_mfma_f32_16x16x32_bf16 v[4:7], v[128:131], a[112:115], v[4:7]
    s_waitcnt lgkmcnt(3)
    v_mfma_f32_16x16x32_bf16 v[8:11], v[128:131], a[176:179], v[8:11]
    ds_read_b64_tr_b16 v[136:137], v215 offset:32768
    ds_read_b64_tr_b16 v[138:139], v215 offset:33280
    s_waitcnt lgkmcnt(4)
    v_mfma_f32_16x16x32_bf16 v[12:15], v[128:131], a[240:243], v[12:15]
    buffer_load_dwordx4 v211, s[36:39], s21 offen offset:1024 lds
    s_waitcnt lgkmcnt(2)
    v_mfma_f32_16x16x32_bf16 v[32:35], a[48:51], v[132:135], v[32:35]
    ds_read_b64_tr_b16 v[140:141], v215 offset:40960
    ds_read_b64_tr_b16 v[142:143], v215 offset:41472
    v_mfma_f32_16x16x32_bf16 v[36:39], a[112:115], v[132:135], v[36:39]
    v_mfma_f32_16x16x32_bf16 v[40:43], a[176:179], v[132:135], v[40:43]
    ds_read_b128 a[52:55], v201 offset:32768
    ds_read_b128 a[116:119], v201 offset:34816
    v_mfma_f32_16x16x32_bf16 v[44:47], a[240:243], v[132:135], v[44:47]
    s_waitcnt lgkmcnt(4)
    v_mfma_f32_16x16x32_bf16 v[16:19], v[136:139], a[48:51], v[16:19]
    ds_read_b64_tr_b16 v[144:145], v214 offset:36864
    ds_read_b64_tr_b16 v[146:147], v214 offset:37376
    v_mfma_f32_16x16x32_bf16 v[20:23], v[136:139], a[112:115], v[20:23]
    v_mfma_f32_16x16x32_bf16 v[24:27], v[136:139], a[176:179], v[24:27]
    ds_read_b128 a[180:183], v201 offset:36864
    ds_read_b128 a[244:247], v201 offset:38912
    v_mfma_f32_16x16x32_bf16 v[28:31], v[136:139], a[240:243], v[28:31]
    buffer_load_dwordx4 v212, s[36:39], s21 offen offset:2048 lds
    s_waitcnt lgkmcnt(6)
    v_mfma_f32_16x16x32_bf16 v[48:51], a[48:51], v[140:143], v[48:51]
    ds_read_b64_tr_b16 v[148:149], v214 offset:45056
    ds_read_b64_tr_b16 v[150:151], v214 offset:45568
    v_mfma_f32_16x16x32_bf16 v[52:55], a[112:115], v[140:143], v[52:55]
    v_mfma_f32_16x16x32_bf16 v[56:59], a[176:179], v[140:143], v[56:59]
    ds_read_b64_tr_b16 v[128:129], v215 offset:36864
    ds_read_b64_tr_b16 v[130:131], v215 offset:37376
    v_mfma_f32_16x16x32_bf16 v[60:63], a[240:243], v[140:143], v[60:63]
    s_waitcnt lgkmcnt(6)
    v_mfma_f32_16x16x32_bf16 v[0:3], v[144:147], a[52:55], v[0:3]
    ds_read_b64_tr_b16 v[132:133], v215 offset:45056
    ds_read_b64_tr_b16 v[134:135], v215 offset:45568
    v_mfma_f32_16x16x32_bf16 v[4:7], v[144:147], a[116:119], v[4:7]
    buffer_load_dwordx4 v213, s[36:39], s21 offen offset:3072 lds
    s_waitcnt lgkmcnt(7)
    v_mfma_f32_16x16x32_bf16 v[8:11], v[144:147], a[180:183], v[8:11]
    s_waitcnt lgkmcnt(6)
    v_mfma_f32_16x16x32_bf16 v[12:15], v[144:147], a[244:247], v[12:15]
    s_waitcnt lgkmcnt(4)
    v_mfma_f32_16x16x32_bf16 v[32:35], a[52:55], v[148:151], v[32:35]
    v_mfma_f32_16x16x32_bf16 v[36:39], a[116:119], v[148:151], v[36:39]
    v_mfma_f32_16x16x32_bf16 v[40:43], a[180:183], v[148:151], v[40:43]
    v_mfma_f32_16x16x32_bf16 v[44:47], a[244:247], v[148:151], v[44:47]
    s_waitcnt lgkmcnt(2)
    v_mfma_f32_16x16x32_bf16 v[16:19], v[128:131], a[52:55], v[16:19]
    v_mfma_f32_16x16x32_bf16 v[20:23], v[128:131], a[116:119], v[20:23]
    v_mfma_f32_16x16x32_bf16 v[24:27], v[128:131], a[180:183], v[24:27]
    v_mfma_f32_16x16x32_bf16 v[28:31], v[128:131], a[244:247], v[28:31]
    s_waitcnt lgkmcnt(0)
    s_waitcnt vmcnt(10)
    s_barrier
    ds_read_b128 a[56:59], v200 offset:49152
    ds_read_b128 a[120:123], v200 offset:51200
    v_mfma_f32_16x16x32_bf16 v[48:51], a[52:55], v[132:135], v[48:51]
    ds_read_b64_tr_b16 v[136:137], v214 offset:49152
    ds_read_b64_tr_b16 v[138:139], v214 offset:49664
    v_mfma_f32_16x16x32_bf16 v[52:55], a[116:119], v[132:135], v[52:55]
    s_add_u32 m0, s97, 98304
    s_nop 0
    buffer_load_dwordx4 v210, s[36:39], s22 offen lds
    v_mfma_f32_16x16x32_bf16 v[56:59], a[180:183], v[132:135], v[56:59]
    ds_read_b128 a[184:187], v200 offset:53248
    ds_read_b128 a[248:251], v200 offset:55296
    v_mfma_f32_16x16x32_bf16 v[60:63], a[244:247], v[132:135], v[60:63]
    s_waitcnt lgkmcnt(2)
    v_mfma_f32_16x16x32_bf16 v[0:3], v[136:139], a[56:59], v[0:3]
    ds_read_b64_tr_b16 v[140:141], v214 offset:57344
    ds_read_b64_tr_b16 v[142:143], v214 offset:57856
    v_mfma_f32_16x16x32_bf16 v[4:7], v[136:139], a[120:123], v[4:7]
    s_waitcnt lgkmcnt(3)
    v_mfma_f32_16x16x32_bf16 v[8:11], v[136:139], a[184:187], v[8:11]
    ds_read_b64_tr_b16 v[144:145], v215 offset:49152
    ds_read_b64_tr_b16 v[146:147], v215 offset:49664
    s_waitcnt lgkmcnt(4)
    v_mfma_f32_16x16x32_bf16 v[12:15], v[136:139], a[248:251], v[12:15]
    buffer_load_dwordx4 v211, s[36:39], s22 offen offset:1024 lds
    s_waitcnt lgkmcnt(2)
    v_mfma_f32_16x16x32_bf16 v[32:35], a[56:59], v[140:143], v[32:35]
    ds_read_b64_tr_b16 v[148:149], v215 offset:57344
    ds_read_b64_tr_b16 v[150:151], v215 offset:57856
    v_mfma_f32_16x16x32_bf16 v[36:39], a[120:123], v[140:143], v[36:39]
    v_mfma_f32_16x16x32_bf16 v[40:43], a[184:187], v[140:143], v[40:43]
    ds_read_b128 a[60:63], v201 offset:49152
    ds_read_b128 a[124:127], v201 offset:51200
    v_mfma_f32_16x16x32_bf16 v[44:47], a[248:251], v[140:143], v[44:47]
    s_waitcnt lgkmcnt(4)
    v_mfma_f32_16x16x32_bf16 v[16:19], v[144:147], a[56:59], v[16:19]
    ds_read_b64_tr_b16 v[128:129], v214 offset:53248
    ds_read_b64_tr_b16 v[130:131], v214 offset:53760
    v_mfma_f32_16x16x32_bf16 v[20:23], v[144:147], a[120:123], v[20:23]
    v_mfma_f32_16x16x32_bf16 v[24:27], v[144:147], a[184:187], v[24:27]
    ds_read_b128 a[188:191], v201 offset:53248
    ds_read_b128 a[252:255], v201 offset:55296
    v_mfma_f32_16x16x32_bf16 v[28:31], v[144:147], a[248:251], v[28:31]
    buffer_load_dwordx4 v212, s[36:39], s22 offen offset:2048 lds
    s_waitcnt lgkmcnt(6)
    v_mfma_f32_16x16x32_bf16 v[48:51], a[56:59], v[148:151], v[48:51]
    ds_read_b64_tr_b16 v[132:133], v214 offset:61440
    ds_read_b64_tr_b16 v[134:135], v214 offset:61952
    v_mfma_f32_16x16x32_bf16 v[52:55], a[120:123], v[148:151], v[52:55]
    v_mfma_f32_16x16x32_bf16 v[56:59], a[184:187], v[148:151], v[56:59]
    ds_read_b64_tr_b16 v[136:137], v215 offset:53248
    ds_read_b64_tr_b16 v[138:139], v215 offset:53760
    v_mfma_f32_16x16x32_bf16 v[60:63], a[248:251], v[148:151], v[60:63]
    s_waitcnt lgkmcnt(6)
    v_mfma_f32_16x16x32_bf16 v[0:3], v[128:131], a[60:63], v[0:3]
    ds_read_b64_tr_b16 v[140:141], v215 offset:61440
    ds_read_b64_tr_b16 v[142:143], v215 offset:61952
    v_mfma_f32_16x16x32_bf16 v[4:7], v[128:131], a[124:127], v[4:7]
    buffer_load_dwordx4 v213, s[36:39], s22 offen offset:3072 lds
    s_waitcnt lgkmcnt(7)
    v_mfma_f32_16x16x32_bf16 v[8:11], v[128:131], a[188:191], v[8:11]
    s_waitcnt lgkmcnt(6)
    v_mfma_f32_16x16x32_bf16 v[12:15], v[128:131], a[252:255], v[12:15]
    s_waitcnt lgkmcnt(4)
    v_mfma_f32_16x16x32_bf16 v[32:35], a[60:63], v[132:135], v[32:35]
    v_mfma_f32_16x16x32_bf16 v[36:39], a[124:127], v[132:135], v[36:39]
    v_mfma_f32_16x16x32_bf16 v[40:43], a[188:191], v[132:135], v[40:43]
    v_mfma_f32_16x16x32_bf16 v[44:47], a[252:255], v[132:135], v[44:47]
    s_waitcnt lgkmcnt(2)
    v_mfma_f32_16x16x32_bf16 v[16:19], v[136:139], a[60:63], v[16:19]
    v_mfma_f32_16x16x32_bf16 v[20:23], v[136:139], a[124:127], v[20:23]
    v_mfma_f32_16x16x32_bf16 v[24:27], v[136:139], a[188:191], v[24:27]
    v_mfma_f32_16x16x32_bf16 v[28:31], v[136:139], a[252:255], v[28:31]
    s_waitcnt lgkmcnt(0)
    v_mfma_f32_16x16x32_bf16 v[48:51], a[60:63], v[140:143], v[48:51]
    v_mfma_f32_16x16x32_bf16 v[52:55], a[124:127], v[140:143], v[52:55]
    v_mfma_f32_16x16x32_bf16 v[56:59], a[188:191], v[140:143], v[56:59]
    v_mfma_f32_16x16x32_bf16 v[60:63], a[252:255], v[140:143], v[60:63]
    v_cvt_pk_bf16_f32 v80, v0, v1
    v_cvt_pk_bf16_f32 v81, v2, v3
    v_cvt_pk_bf16_f32 v82, v4, v5
    v_cvt_pk_bf16_f32 v83, v6, v7
    v_cvt_pk_bf16_f32 v84, v8, v9
    v_cvt_pk_bf16_f32 v85, v10, v11
    v_cvt_pk_bf16_f32 v86, v12, v13
    v_cvt_pk_bf16_f32 v87, v14, v15
    v_permlane16_swap_b32 v80, v82
    v_permlane16_swap_b32 v81, v83
    v_permlane16_swap_b32 v84, v86
    v_permlane16_swap_b32 v85, v87
    v_cvt_pk_bf16_f32 v32, v32, v33
    v_cvt_pk_bf16_f32 v33, v34, v35
    v_mfma_f32_32x32x16_bf16 v[168:183], v[160:163], v[80:83], 0
    v_cvt_pk_bf16_f32 v34, v36, v37
    v_cvt_pk_bf16_f32 v35, v38, v39
    v_cvt_pk_bf16_f32 v36, v40, v41
    v_cvt_pk_bf16_f32 v37, v42, v43
    v_cvt_pk_bf16_f32 v38, v44, v45
    v_cvt_pk_bf16_f32 v39, v46, v47
    v_mfma_f32_32x32x16_bf16 v[184:199], v[160:163], v[84:87], 0
    ds_write_b64 v218, v[32:33] offset:0
    ds_write_b64 v218, v[34:35] offset:512
    ds_write_b64 v218, v[36:37] offset:1024
    ds_write_b64 v218, v[38:39] offset:1536
    v_cvt_pk_bf16_f32 v48, v48, v49
    v_cvt_pk_bf16_f32 v49, v50, v51
    v_cvt_pk_bf16_f32 v50, v52, v53
    v_cvt_pk_bf16_f32 v51, v54, v55
    v_cvt_pk_bf16_f32 v52, v56, v57
    v_cvt_pk_bf16_f32 v53, v58, v59
    v_cvt_pk_bf16_f32 v54, v60, v61
    v_cvt_pk_bf16_f32 v55, v62, v63
    ds_write_b64 v218, v[48:49] offset:4096
    ds_write_b64 v218, v[50:51] offset:4608
    ds_write_b64 v218, v[52:53] offset:5120
    ds_write_b64 v218, v[54:55] offset:5632
    v_max3_f32 v152, v168, v169, v170
    v_max3_f32 v154, v171, v172, v173
    v_max3_f32 v152, v152, v174, v175
    buffer_load_dword v156, v156, s[48:51], s71 offen
    v_max3_f32 v154, v154, v176, v177
    v_max3_f32 v152, v152, v178, v179
    v_max3_f32 v154, v154, v180, v181
    v_max3_f32 v152, v152, v182, v183
    v_max_f32 v152, v152, v154
    v_mul_f32 v152, s72, v152
    v_pk_fma_f32 v[168:169], v[168:169], s[72:73], v[152:153] op_sel_hi:[1,0,0] neg_lo:[0,0,1] neg_hi:[0,0,1]
    v_pk_fma_f32 v[170:171], v[170:171], s[72:73], v[152:153] op_sel_hi:[1,0,0] neg_lo:[0,0,1] neg_hi:[0,0,1]
    v_pk_fma_f32 v[172:173], v[172:173], s[72:73], v[152:153] op_sel_hi:[1,0,0] neg_lo:[0,0,1] neg_hi:[0,0,1]
    v_cvt_pk_bf16_f32 v80, v16, v17
    v_cvt_pk_bf16_f32 v81, v18, v19
    v_cvt_pk_bf16_f32 v82, v20, v21
    v_cvt_pk_bf16_f32 v83, v22, v23
    v_pk_fma_f32 v[174:175], v[174:175], s[72:73], v[152:153] op_sel_hi:[1,0,0] neg_lo:[0,0,1] neg_hi:[0,0,1]
    v_pk_fma_f32 v[176:177], v[176:177], s[72:73], v[152:153] op_sel_hi:[1,0,0] neg_lo:[0,0,1] neg_hi:[0,0,1]
    v_pk_fma_f32 v[178:179], v[178:179], s[72:73], v[152:153] op_sel_hi:[1,0,0] neg_lo:[0,0,1] neg_hi:[0,0,1]
    v_pk_fma_f32 v[180:181], v[180:181], s[72:73], v[152:153] op_sel_hi:[1,0,0] neg_lo:[0,0,1] neg_hi:[0,0,1]
    v_pk_fma_f32 v[182:183], v[182:183], s[72:73], v[152:153] op_sel_hi:[1,0,0] neg_lo:[0,0,1] neg_hi:[0,0,1]
    v_exp_f32 v168, v168
    v_exp_f32 v169, v169
    v_exp_f32 v170, v170
    v_permlane16_swap_b32 v80, v82
    v_permlane16_swap_b32 v81, v83
    v_exp_f32 v171, v171
    v_exp_f32 v172, v172
    v_exp_f32 v173, v173
    v_pk_add_f32 v[154:155], v[168:169], v[170:171]
    v_exp_f32 v174, v174
    v_exp_f32 v175, v175
    v_pk_add_f32 v[154:155], v[154:155], v[172:173]
    v_exp_f32 v176, v176
    v_exp_f32 v177, v177
    v_pk_add_f32 v[154:155], v[154:155], v[174:175]
    v_exp_f32 v178, v178
    v_exp_f32 v179, v179
    v_pk_add_f32 v[154:155], v[154:155], v[176:177]
    v_exp_f32 v180, v180
    v_exp_f32 v181, v181
    v_pk_add_f32 v[154:155], v[154:155], v[178:179]
    v_exp_f32 v182, v182
    v_exp_f32 v183, v183
    v_pk_add_f32 v[154:155], v[154:155], v[180:181]
    v_pk_add_f32 v[154:155], v[154:155], v[182:183]
    v_add_f32 v154, v154, v155
    v_rcp_f32 v154, v154
    s_nop 0
    v_pk_mul_f32 v[168:169], v[168:169], v[154:155] op_sel_hi:[1,0]
    v_cvt_pk_bf16_f32 v200, v168, v169
    v_pk_mul_f32 v[170:171], v[170:171], v[154:155] op_sel_hi:[1,0]
    v_cvt_pk_bf16_f32 v201, v170, v171
    v_pk_mul_f32 v[172:173], v[172:173], v[154:155] op_sel_hi:[1,0]
    v_cvt_pk_bf16_f32 v202, v172, v173
    v_pk_mul_f32 v[174:175], v[174:175], v[154:155] op_sel_hi:[1,0]
    v_cvt_pk_bf16_f32 v203, v174, v175
    v_pk_mul_f32 v[176:177], v[176:177], v[154:155] op_sel_hi:[1,0]
    v_cvt_pk_bf16_f32 v204, v176, v177
    v_pk_mul_f32 v[178:179], v[178:179], v[154:155] op_sel_hi:[1,0]
    v_cvt_pk_bf16_f32 v205, v178, v179
    v_pk_mul_f32 v[180:181], v[180:181], v[154:155] op_sel_hi:[1,0]
    v_cvt_pk_bf16_f32 v206, v180, v181
    v_pk_mul_f32 v[182:183], v[182:183], v[154:155] op_sel_hi:[1,0]
    v_cvt_pk_bf16_f32 v207, v182, v183
    ds_write_b128 v216, v[200:203] offset:0
    ds_write_b128 v217, v[204:207] offset:0
    v_mfma_f32_32x32x16_bf16 v[168:183], v[164:167], v[80:83], 0
    v_max3_f32 v152, v184, v185, v186
    v_max3_f32 v154, v187, v188, v189
    v_max3_f32 v152, v152, v190, v191
    v_max3_f32 v154, v154, v192, v193
    v_max3_f32 v152, v152, v194, v195
    v_max3_f32 v154, v154, v196, v197
    buffer_load_dword v157, v157, s[48:51], s71 offen
    v_max3_f32 v152, v152, v198, v199
    v_max_f32 v152, v152, v154
    v_mul_f32 v152, s72, v152
    v_pk_fma_f32 v[184:185], v[184:185], s[72:73], v[152:153] op_sel_hi:[1,0,0] neg_lo:[0,0,1] neg_hi:[0,0,1]
    v_pk_fma_f32 v[186:187], v[186:187], s[72:73], v[152:153] op_sel_hi:[1,0,0] neg_lo:[0,0,1] neg_hi:[0,0,1]
    v_pk_fma_f32 v[188:189], v[188:189], s[72:73], v[152:153] op_sel_hi:[1,0,0] neg_lo:[0,0,1] neg_hi:[0,0,1]
    v_cvt_pk_bf16_f32 v84, v24, v25
    v_cvt_pk_bf16_f32 v85, v26, v27
    v_cvt_pk_bf16_f32 v86, v28, v29
    v_cvt_pk_bf16_f32 v87, v30, v31
    v_pk_fma_f32 v[190:191], v[190:191], s[72:73], v[152:153] op_sel_hi:[1,0,0] neg_lo:[0,0,1] neg_hi:[0,0,1]
    v_pk_fma_f32 v[192:193], v[192:193], s[72:73], v[152:153] op_sel_hi:[1,0,0] neg_lo:[0,0,1] neg_hi:[0,0,1]
    v_pk_fma_f32 v[194:195], v[194:195], s[72:73], v[152:153] op_sel_hi:[1,0,0] neg_lo:[0,0,1] neg_hi:[0,0,1]
    v_pk_fma_f32 v[196:197], v[196:197], s[72:73], v[152:153] op_sel_hi:[1,0,0] neg_lo:[0,0,1] neg_hi:[0,0,1]
    v_pk_fma_f32 v[198:199], v[198:199], s[72:73], v[152:153] op_sel_hi:[1,0,0] neg_lo:[0,0,1] neg_hi:[0,0,1]
    v_exp_f32 v184, v184
    v_exp_f32 v185, v185
    v_exp_f32 v186, v186
    v_permlane16_swap_b32 v84, v86
    v_permlane16_swap_b32 v85, v87
    v_exp_f32 v187, v187
    v_exp_f32 v188, v188
    v_exp_f32 v189, v189
    v_pk_add_f32 v[154:155], v[184:185], v[186:187]
    v_exp_f32 v190, v190
    v_exp_f32 v191, v191
    v_pk_add_f32 v[154:155], v[154:155], v[188:189]
    v_exp_f32 v192, v192
    v_exp_f32 v193, v193
    v_pk_add_f32 v[154:155], v[154:155], v[190:191]
    v_exp_f32 v194, v194
    v_exp_f32 v195, v195
    v_pk_add_f32 v[154:155], v[154:155], v[192:193]
    v_exp_f32 v196, v196
    v_exp_f32 v197, v197
    v_pk_add_f32 v[154:155], v[154:155], v[194:195]
    v_exp_f32 v198, v198
    v_exp_f32 v199, v199
    v_pk_add_f32 v[154:155], v[154:155], v[196:197]
    v_pk_add_f32 v[154:155], v[154:155], v[198:199]
    v_add_f32 v154, v154, v155
    v_rcp_f32 v154, v154
    s_nop 0
    v_pk_mul_f32 v[184:185], v[184:185], v[154:155] op_sel_hi:[1,0]
    v_cvt_pk_bf16_f32 v200, v184, v185
    v_pk_mul_f32 v[186:187], v[186:187], v[154:155] op_sel_hi:[1,0]
    v_cvt_pk_bf16_f32 v201, v186, v187
    v_pk_mul_f32 v[188:189], v[188:189], v[154:155] op_sel_hi:[1,0]
    v_cvt_pk_bf16_f32 v202, v188, v189
    v_pk_mul_f32 v[190:191], v[190:191], v[154:155] op_sel_hi:[1,0]
    v_cvt_pk_bf16_f32 v203, v190, v191
    v_pk_mul_f32 v[192:193], v[192:193], v[154:155] op_sel_hi:[1,0]
    v_cvt_pk_bf16_f32 v204, v192, v193
    v_pk_mul_f32 v[194:195], v[194:195], v[154:155] op_sel_hi:[1,0]
    v_cvt_pk_bf16_f32 v205, v194, v195
    v_pk_mul_f32 v[196:197], v[196:197], v[154:155] op_sel_hi:[1,0]
    v_cvt_pk_bf16_f32 v206, v196, v197
    v_pk_mul_f32 v[198:199], v[198:199], v[154:155] op_sel_hi:[1,0]
    v_cvt_pk_bf16_f32 v207, v198, v199
    ds_write_b128 v216, v[200:203] offset:2048
    ds_write_b128 v217, v[204:207] offset:2048
    v_mfma_f32_32x32x16_bf16 v[184:199], v[164:167], v[84:87], 0
    v_max3_f32 v152, v168, v169, v170
    v_max3_f32 v154, v171, v172, v173
    v_max3_f32 v152, v152, v174, v175
    v_max3_f32 v154, v154, v176, v177
    v_max3_f32 v152, v152, v178, v179
    v_max3_f32 v154, v154, v180, v181
    v_max3_f32 v152, v152, v182, v183
    v_max_f32 v152, v152, v154
    v_mul_f32 v152, s72, v152
    buffer_load_dword v158, v158, s[52:55], s71 offen
    v_pk_fma_f32 v[168:169], v[168:169], s[72:73], v[152:153] op_sel_hi:[1,0,0] neg_lo:[0,0,1] neg_hi:[0,0,1]
    v_pk_fma_f32 v[170:171], v[170:171], s[72:73], v[152:153] op_sel_hi:[1,0,0] neg_lo:[0,0,1] neg_hi:[0,0,1]
    v_pk_fma_f32 v[172:173], v[172:173], s[72:73], v[152:153] op_sel_hi:[1,0,0] neg_lo:[0,0,1] neg_hi:[0,0,1]
    v_pk_fma_f32 v[174:175], v[174:175], s[72:73], v[152:153] op_sel_hi:[1,0,0] neg_lo:[0,0,1] neg_hi:[0,0,1]
    v_pk_fma_f32 v[176:177], v[176:177], s[72:73], v[152:153] op_sel_hi:[1,0,0] neg_lo:[0,0,1] neg_hi:[0,0,1]
    v_pk_fma_f32 v[178:179], v[178:179], s[72:73], v[152:153] op_sel_hi:[1,0,0] neg_lo:[0,0,1] neg_hi:[0,0,1]
    v_pk_fma_f32 v[180:181], v[180:181], s[72:73], v[152:153] op_sel_hi:[1,0,0] neg_lo:[0,0,1] neg_hi:[0,0,1]
    v_pk_fma_f32 v[182:183], v[182:183], s[72:73], v[152:153] op_sel_hi:[1,0,0] neg_lo:[0,0,1] neg_hi:[0,0,1]
    v_exp_f32 v168, v168
    v_exp_f32 v169, v169
    v_exp_f32 v170, v170
    v_exp_f32 v171, v171
    v_exp_f32 v172, v172
    v_exp_f32 v173, v173
    v_pk_add_f32 v[154:155], v[168:169], v[170:171]
    v_exp_f32 v174, v174
    v_exp_f32 v175, v175
    v_pk_add_f32 v[154:155], v[154:155], v[172:173]
    v_exp_f32 v176, v176
    v_exp_f32 v177, v177
    v_pk_add_f32 v[154:155], v[154:155], v[174:175]
    v_exp_f32 v178, v178
    v_exp_f32 v179, v179
    v_pk_add_f32 v[154:155], v[154:155], v[176:177]
    v_exp_f32 v180, v180
    v_exp_f32 v181, v181
    v_pk_add_f32 v[154:155], v[154:155], v[178:179]
    v_exp_f32 v182, v182
    v_exp_f32 v183, v183
    v_pk_add_f32 v[154:155], v[154:155], v[180:181]
    v_pk_add_f32 v[154:155], v[154:155], v[182:183]
    v_add_f32 v154, v154, v155
    v_rcp_f32 v154, v154
    s_nop 0
    v_pk_mul_f32 v[168:169], v[168:169], v[154:155] op_sel_hi:[1,0]
    v_cvt_pk_bf16_f32 v200, v168, v169
    v_pk_mul_f32 v[170:171], v[170:171], v[154:155] op_sel_hi:[1,0]
    v_cvt_pk_bf16_f32 v201, v170, v171
    v_pk_mul_f32 v[172:173], v[172:173], v[154:155] op_sel_hi:[1,0]
    v_cvt_pk_bf16_f32 v202, v172, v173
    v_pk_mul_f32 v[174:175], v[174:175], v[154:155] op_sel_hi:[1,0]
    v_cvt_pk_bf16_f32 v203, v174, v175
    v_pk_mul_f32 v[176:177], v[176:177], v[154:155] op_sel_hi:[1,0]
    v_cvt_pk_bf16_f32 v204, v176, v177
    v_pk_mul_f32 v[178:179], v[178:179], v[154:155] op_sel_hi:[1,0]
    v_cvt_pk_bf16_f32 v205, v178, v179
    v_pk_mul_f32 v[180:181], v[180:181], v[154:155] op_sel_hi:[1,0]
    v_cvt_pk_bf16_f32 v206, v180, v181
    v_pk_mul_f32 v[182:183], v[182:183], v[154:155] op_sel_hi:[1,0]
    v_cvt_pk_bf16_f32 v207, v182, v183
    ds_write_b128 v216, v[200:203] offset:8192
    ds_write_b128 v217, v[204:207] offset:8192
    v_max3_f32 v152, v184, v185, v186
    s_add_u32 m0, s97, 131072
    v_max3_f32 v154, v187, v188, v189
    v_max3_f32 v152, v152, v190, v191
L_pad_kv_1:
    s_cbranch_execz L_walked_kv
    v_max3_f32 v154, v154, v192, v193
    v_max3_f32 v152, v152, v194, v195
    v_max3_f32 v154, v154, v196, v197
    v_max3_f32 v152, v152, v198, v199
    v_max_f32 v152, v152, v154
    v_mul_f32 v152, s72, v152
    v_pk_fma_f32 v[184:185], v[184:185], s[72:73], v[152:153] op_sel_hi:[1,0,0] neg_lo:[0,0,1] neg_hi:[0,0,1]
    v_pk_fma_f32 v[186:187], v[186:187], s[72:73], v[152:153] op_sel_hi:[1,0,0] neg_lo:[0,0,1] neg_hi:[0,0,1]
    v_pk_fma_f32 v[188:189], v[188:189], s[72:73], v[152:153] op_sel_hi:[1,0,0] neg_lo:[0,0,1] neg_hi:[0,0,1]
    v_pk_fma_f32 v[190:191], v[190:191], s[72:73], v[152:153] op_sel_hi:[1,0,0] neg_lo:[0,0,1] neg_hi:[0,0,1]
    buffer_load_dwordx4 v251, s[48:51], s76 offen lds
    v_pk_fma_f32 v[192:193], v[192:193], s[72:73], v[152:153] op_sel_hi:[1,0,0] neg_lo:[0,0,1] neg_hi:[0,0,1]
    v_pk_fma_f32 v[194:195], v[194:195], s[72:73], v[152:153] op_sel_hi:[1,0,0] neg_lo:[0,0,1] neg_hi:[0,0,1]
    v_pk_fma_f32 v[196:197], v[196:197], s[72:73], v[152:153] op_sel_hi:[1,0,0] neg_lo:[0,0,1] neg_hi:[0,0,1]
    v_pk_fma_f32 v[198:199], v[198:199], s[72:73], v[152:153] op_sel_hi:[1,0,0] neg_lo:[0,0,1] neg_hi:[0,0,1]
    v_exp_f32 v184, v184
    v_exp_f32 v185, v185
    v_exp_f32 v186, v186
    v_exp_f32 v187, v187
    v_exp_f32 v188, v188
    v_exp_f32 v189, v189
    v_pk_add_f32 v[154:155], v[184:185], v[186:187]
    v_exp_f32 v190, v190
    buffer_load_dwordx4 v252, s[48:51], s76 offen offset:1024 lds
    v_exp_f32 v191, v191
    v_pk_add_f32 v[154:155], v[154:155], v[188:189]
    v_exp_f32 v192, v192
    v_exp_f32 v193, v193
    v_pk_add_f32 v[154:155], v[154:155], v[190:191]
    v_exp_f32 v194, v194
    v_exp_f32 v195, v195
    v_pk_add_f32 v[154:155], v[154:155], v[192:193]
    v_exp_f32 v196, v196
    v_exp_f32 v197, v197
    v_pk_add_f32 v[154:155], v[154:155], v[194:195]
    v_exp_f32 v198, v198
    buffer_load_dwordx4 v253, s[48:51], s76 offen offset:2048 lds
    v_exp_f32 v199, v199
    v_pk_add_f32 v[154:155], v[154:155], v[196:197]
    v_pk_add_f32 v[154:155], v[154:155], v[198:199]
    v_add_f32 v154, v154, v155
    v_rcp_f32 v154, v154
    s_nop 0
    v_pk_mul_f32 v[184:185], v[184:185], v[154:155] op_sel_hi:[1,0]
    v_cvt_pk_bf16_f32 v200, v184, v185
    v_pk_mul_f32 v[186:187], v[186:187], v[154:155] op_sel_hi:[1,0]
    v_cvt_pk_bf16_f32 v201, v186, v187
    v_pk_mul_f32 v[188:189], v[188:189], v[154:155] op_sel_hi:[1,0]
    v_cvt_pk_bf16_f32 v202, v188, v189
    v_pk_mul_f32 v[190:191], v[190:191], v[154:155] op_sel_hi:[1,0]
    buffer_load_dwordx4 v254, s[48:51], s76 offen offset:3072 lds
    v_cvt_pk_bf16_f32 v203, v190, v191
    v_pk_mul_f32 v[192:193], v[192:193], v[154:155] op_sel_hi:[1,0]
    v_cvt_pk_bf16_f32 v204, v192, v193
    v_pk_mul_f32 v[194:195], v[194:195], v[154:155] op_sel_hi:[1,0]
    v_cvt_pk_bf16_f32 v205, v194, v195
    v_pk_mul_f32 v[196:197], v[196:197], v[154:155] op_sel_hi:[1,0]
    v_cvt_pk_bf16_f32 v206, v196, v197
    v_pk_mul_f32 v[198:199], v[198:199], v[154:155] op_sel_hi:[1,0]
    v_cvt_pk_bf16_f32 v207, v198, v199
    ds_write_b128 v216, v[200:203] offset:10240
    ds_write_b128 v217, v[204:207] offset:10240
    s_waitcnt vmcnt(16)
    v_cmp_eq_u32 vcc, 0, v243
    s_mov_b32 s101, 65536
    s_nop 3
    s_cbranch_vccz L_ok13
L_spin13:
    buffer_load_dword v243, v240, s[44:47], 0 offen sc1
    s_sub_u32 s101, s101, 1
    s_cmp_eq_u32 s101, 0
    s_cbranch_scc1 L_ok13
    s_waitcnt vmcnt(0)
    v_cmp_eq_u32 vcc, 0, v243
    s_nop 4
    s_cbranch_vccnz L_spin13
L_ok13:
    s_waitcnt vmcnt(15)
    v_cmp_eq_u32 vcc, 0, v239
    s_mov_b32 s101, 65536
    s_nop 3
    s_cbranch_vccz L_ok14
L_spin14:
    buffer_load_dword v239, v240, s[44:47], s73 offen offset:32 sc1
    s_sub_u32 s101, s101, 1
    s_cmp_eq_u32 s101, 0
    s_cbranch_scc1 L_ok14
    s_waitcnt vmcnt(0)
    v_cmp_eq_u32 vcc, 0, v239
    s_nop 4
    s_cbranch_vccnz L_spin14
L_ok14:
    s_waitcnt lgkmcnt(0)
    s_barrier
    ds_read_b128 v[32:35], v219
    v_add_u32 v219, v219, v220
    ds_read_b64_tr_b16 v[0:1], v208 offset:0
    ds_read_b64_tr_b16 v[2:3], v209 offset:256
    ds_read_b128 v[36:39], v219
    v_add_u32 v219, v219, v220
    ds_read_b64_tr_b16 v[4:5], v208 offset:1024
    ds_read_b64_tr_b16 v[6:7], v209 offset:1280
    ds_read_b128 v[40:43], v219
    v_add_u32 v219, v219, v220
    ds_read_b64_tr_b16 v[8:9], v208 offset:2048
    ds_read_b64_tr_b16 v[10:11], v209 offset:2304
    ds_read_b128 v[44:47], v219
    v_add_u32 v219, v219, v220
    ds_read_b64_tr_b16 v[12:13], v208 offset:3072
    ds_read_b64_tr_b16 v[14:15], v209 offset:3328
    s_waitcnt lgkmcnt(9)
    v_mfma_f32_32x32x16_bf16 v[168:183], v[32:35], v[0:3], 0
    ds_read_b128 v[48:51], v219
    v_add_u32 v219, v219, v220
    ds_read_b64_tr_b16 v[16:17], v208 offset:4096
    ds_read_b64_tr_b16 v[18:19], v209 offset:4352
    s_waitcnt lgkmcnt(9)
    v_mfma_f32_32x32x16_bf16 v[168:183], v[36:39], v[4:7], v[168:183]
    ds_read_b128 v[52:55], v219
    v_add_u32 v219, v219, v220
    ds_read_b64_tr_b16 v[20:21], v208 offset:5120
    ds_read_b64_tr_b16 v[22:23], v209 offset:5376
    s_waitcnt lgkmcnt(9)
    v_mfma_f32_32x32x16_bf16 v[168:183], v[40:43], v[8:11], v[168:183]
    ds_read_b128 v[56:59], v219
    v_add_u32 v219, v219, v220
    ds_read_b64_tr_b16 v[24:25], v208 offset:6144
    ds_read_b64_tr_b16 v[26:27], v209 offset:6400
    s_waitcnt lgkmcnt(9)
    v_mfma_f32_32x32x16_bf16 v[168:183], v[44:47], v[12:15], v[168:183]
    ds_read_b128 v[60:63], v219
    ds_read_b64_tr_b16 v[28:29], v208 offset:7168
    ds_read_b64_tr_b16 v[30:31], v209 offset:7424
    s_waitcnt lgkmcnt(9)
    v_mfma_f32_32x32x16_bf16 v[168:183], v[48:51], v[16:19], v[168:183]
    s_waitcnt lgkmcnt(6)
    v_mfma_f32_32x32x16_bf16 v[168:183], v[52:55], v[20:23], v[168:183]
    s_waitcnt lgkmcnt(3)
    v_mfma_f32_32x32x16_bf16 v[168:183], v[56:59], v[24:27], v[168:183]
    s_waitcnt lgkmcnt(0)
    v_mfma_f32_32x32x16_bf16 v[168:183], v[60:63], v[28:31], v[168:183]
    ds_read_b64_tr_b16 v[128:129], v214 offset:0
    ds_read_b64_tr_b16 v[130:131], v214 offset:512
    s_waitcnt lgkmcnt(0)
    v_mfma_f32_16x16x32_bf16 v[64:67], v[128:131], a[0:3], 0
    ds_read_b64_tr_b16 v[132:133], v214 offset:8192
    ds_read_b64_tr_b16 v[134:135], v214 offset:8704
    v_mfma_f32_16x16x32_bf16 v[68:71], v[128:131], a[64:67], 0
    s_add_u32 m0, s97, 114688
    s_nop 0
    buffer_load_dwordx4 v210, s[36:39], s23 offen lds
    v_mfma_f32_16x16x32_bf16 v[80:83], v[128:131], a[128:131], 0
    ds_read_b64_tr_b16 v[136:137], v215 offset:0
    ds_read_b64_tr_b16 v[138:139], v215 offset:512
    v_mfma_f32_16x16x32_bf16 v[84:87], v[128:131], a[192:195], 0
    buffer_load_dwordx4 v211, s[36:39], s23 offen offset:1024 lds
    s_waitcnt lgkmcnt(2)
    v_mfma_f32_16x16x32_bf16 v[72:75], v[132:135], a[0:3], 0
    ds_read_b64_tr_b16 v[140:141], v215 offset:8192
    ds_read_b64_tr_b16 v[142:143], v215 offset:8704
    v_mfma_f32_16x16x32_bf16 v[76:79], v[132:135], a[64:67], 0
    buffer_load_dwordx4 v212, s[36:39], s23 offen offset:2048 lds
    v_mfma_f32_16x16x32_bf16 v[88:91], v[132:135], a[128:131], 0
    ds_read_b64_tr_b16 v[144:145], v214 offset:4096
    ds_read_b64_tr_b16 v[146:147], v214 offset:4608
    v_mfma_f32_16x16x32_bf16 v[92:95], v[132:135], a[192:195], 0
    buffer_load_dwordx4 v213, s[36:39], s23 offen offset:3072 lds
    s_waitcnt lgkmcnt(4)
    v_mfma_f32_16x16x32_bf16 v[96:99], v[136:139], a[0:3], 0
    ds_read_b64_tr_b16 v[148:149], v214 offset:12288
    ds_read_b64_tr_b16 v[150:151], v214 offset:12800
    v_mfma_f32_16x16x32_bf16 v[100:103], v[136:139], a[64:67], 0
    s_add_u32 m0, s97, 49152
    s_nop 0
    buffer_load_dwordx4 v251, s[48:51], s77 offen lds
    v_mfma_f32_16x16x32_bf16 v[112:115], v[136:139], a[128:131], 0
    ds_read_b64_tr_b16 v[128:129], v215 offset:4096
    ds_read_b64_tr_b16 v[130:131], v215 offset:4608
    v_mfma_f32_16x16x32_bf16 v[116:119], v[136:139], a[192:195], 0
    buffer_atomic_add_f32 v168, v222, s[40:43], s75 offen
    buffer_atomic_add_f32 v169, v222, s[40:43], s75 offen offset:128
    s_waitcnt lgkmcnt(6)
    v_mfma_f32_16x16x32_bf16 v[104:107], v[140:143], a[0:3], 0
    ds_read_b64_tr_b16 v[132:133], v215 offset:12288
    ds_read_b64_tr_b16 v[134:135], v215 offset:12800
    v_mfma_f32_16x16x32_bf16 v[108:111], v[140:143], a[64:67], 0
    buffer_load_dwordx4 v252, s[48:51], s77 offen offset:1024 lds
    buffer_atomic_add_f32 v170, v222, s[40:43], s75 offen offset:256
    v_mfma_f32_16x16x32_bf16 v[120:123], v[140:143], a[128:131], 0
    v_add_u32 v214, 0x4000, v214
    v_add_u32 v215, 0x4000, v215
    v_mfma_f32_16x16x32_bf16 v[124:127], v[140:143], a[192:195], 0
    buffer_atomic_add_f32 v171, v222, s[40:43], s75 offen offset:384
    buffer_atomic_add_f32 v172, v222, s[40:43], s75 offen offset:1024
    s_waitcnt lgkmcnt(6)
    v_mfma_f32_16x16x32_bf16 v[64:67], v[144:147], a[4:7], v[64:67]
    buffer_load_dwordx4 v253, s[48:51], s77 offen offset:2048 lds
    buffer_atomic_add_f32 v173, v222, s[40:43], s75 offen offset:1152
    v_mfma_f32_16x16x32_bf16 v[68:71], v[144:147], a[68:71], v[68:71]
    buffer_atomic_add_f32 v174, v222, s[40:43], s75 offen offset:1280
    buffer_atomic_add_f32 v175, v222, s[40:43], s75 offen offset:1408
    v_mfma_f32_16x16x32_bf16 v[80:83], v[144:147], a[132:135], v[80:83]
    buffer_atomic_add_f32 v176, v223, s[40:43], s75 offen offset:2048
    v_lshrrev_b32 v2, 4, v255
    v_mfma_f32_16x16x32_bf16 v[84:87], v[144:147], a[196:199], v[84:87]
    v_bfe_u32 v3, v255, 2, 2
    v_lshl_add_u32 v1, v2, 3, v3
    s_waitcnt lgkmcnt(2)
    v_mfma_f32_16x16x32_bf16 v[72:75], v[148:151], a[4:7], v[72:75]
    buffer_load_dwordx4 v254, s[48:51], s77 offen offset:3072 lds
    v_and_b32 v5, 3, v255
    v_mfma_f32_16x16x32_bf16 v[76:79], v[148:151], a[68:71], v[76:79]
    v_lshl_add_u32 v4, v5, 3, s97
    v_lshl_add_u32 v0, v1, 7, v4
    v_mfma_f32_16x16x32_bf16 v[88:91], v[148:151], a[132:135], v[88:91]
    v_and_b32 v8, 1, v2
    v_lshrrev_b32 v9, 1, v3
    v_mfma_f32_16x16x32_bf16 v[92:95], v[148:151], a[196:199], v[92:95]
    v_lshl_add_u32 v7, v8, 1, v9
    v_lshlrev_b32 v6, 5, v7
    v_mfma_f32_16x16x32_bf16 v[96:99], v[128:131], a[4:7], v[96:99]
    v_add_u32 v245, v0, v6
    v_xor_b32 v246, 32, v245
    v_mfma_f32_16x16x32_bf16 v[100:103], v[128:131], a[68:71], v[100:103]
    v_xor_b32 v247, 64, v245
    v_xor_b32 v248, 96, v245
    v_mfma_f32_16x16x32_bf16 v[112:115], v[128:131], a[132:135], v[112:115]
    v_mfma_f32_16x16x32_bf16 v[116:119], v[128:131], a[196:199], v[116:119]
    s_waitcnt lgkmcnt(0)
    s_waitcnt vmcnt(28)
    s_barrier
    ds_read_b64_tr_b16 v[136:137], v214 offset:0
    ds_read_b64_tr_b16 v[138:139], v214 offset:512
    v_mfma_f32_16x16x32_bf16 v[104:107], v[132:135], a[4:7], v[104:107]
    ds_read_b64_tr_b16 v[140:141], v214 offset:8192
    ds_read_b64_tr_b16 v[142:143], v214 offset:8704
    v_mfma_f32_16x16x32_bf16 v[108:111], v[132:135], a[68:71], v[108:111]
    s_add_u32 m0, s97, 65536
    s_nop 0
    buffer_load_dwordx4 v210, s[36:39], s24 offen lds
    v_mfma_f32_16x16x32_bf16 v[120:123], v[132:135], a[132:135], v[120:123]
    ds_read_b64_tr_b16 v[144:145], v215 offset:0
    ds_read_b64_tr_b16 v[146:147], v215 offset:512
    v_mfma_f32_16x16x32_bf16 v[124:127], v[132:135], a[196:199], v[124:127]
    v_and_b32 v10, 15, v255
    v_lshlrev_b32 v236, 2, v10
    s_waitcnt lgkmcnt(4)
    v_mfma_f32_16x16x32_bf16 v[64:67], v[136:139], a[8:11], v[64:67]
    ds_read_b64_tr_b16 v[148:149], v215 offset:8192
    ds_read_b64_tr_b16 v[150:151], v215 offset:8704
    v_mfma_f32_16x16x32_bf16 v[68:71], v[136:139], a[72:75], v[68:71]
    v_lshlrev_b32 v235, 7, v10
    v_lshlrev_b32 v11, 4, v10
    v_mfma_f32_16x16x32_bf16 v[80:83], v[136:139], a[136:139], v[80:83]
    ds_read_b64_tr_b16 v[128:129], v214 offset:4096
    ds_read_b64_tr_b16 v[130:131], v214 offset:4608
    v_mfma_f32_16x16x32_bf16 v[84:87], v[136:139], a[200:203], v[84:87]
    buffer_load_dwordx4 v211, s[36:39], s24 offen offset:1024 lds
    v_lshl_add_u32 v234, v2, 9, v11
    s_waitcnt lgkmcnt(6)
    v_mfma_f32_16x16x32_bf16 v[72:75], v[140:143], a[8:11], v[72:75]
    ds_read_b64_tr_b16 v[132:133], v214 offset:12288
    ds_read_b64_tr_b16 v[134:135], v214 offset:12800
    v_mfma_f32_16x16x32_bf16 v[76:79], v[140:143], a[72:75], v[76:79]
    s_lshl_b32 s101, s93, 14
    s_lshl_b32 s3, s92, 11
    v_mfma_f32_16x16x32_bf16 v[88:91], v[140:143], a[136:139], v[88:91]
    ds_read_b64_tr_b16 v[136:137], v215 offset:4096
    ds_read_b64_tr_b16 v[138:139], v215 offset:4608
    v_mfma_f32_16x16x32_bf16 v[92:95], v[140:143], a[200:203], v[92:95]
    s_add_u32 s101, s101, s3
    v_lshrrev_b32 v13, 3, v255
    s_waitcnt lgkmcnt(8)
    v_mfma_f32_16x16x32_bf16 v[96:99], v[144:147], a[8:11], v[96:99]
    ds_read_b64_tr_b16 v[140:141], v215 offset:12288
    ds_read_b64_tr_b16 v[142:143], v215 offset:12800
    v_mfma_f32_16x16x32_bf16 v[100:103], v[144:147], a[72:75], v[100:103]
    buffer_load_dwordx4 v212, s[36:39], s24 offen offset:2048 lds
    v_lshl_add_u32 v12, v13, 8, s101
    v_mfma_f32_16x16x32_bf16 v[112:115], v[144:147], a[136:139], v[112:115]
    v_add_u32 v214, 0x4000, v214
    v_add_u32 v215, 0x4000, v215
    v_mfma_f32_16x16x32_bf16 v[116:119], v[144:147], a[200:203], v[116:119]
    v_and_b32 v18, 7, v255
    v_lshlrev_b32 v17, 1, v18
    s_waitcnt lgkmcnt(6)
    v_mfma_f32_16x16x32_bf16 v[104:107], v[148:151], a[8:11], v[104:107]
    v_and_b32 v16, 8, v17
    v_and_b32 v20, 7, v17
    v_mfma_f32_16x16x32_bf16 v[108:111], v[148:151], a[72:75], v[108:111]
    v_xor_b32 v19, v20, v13
    v_add_u32 v15, v16, v19
    v_mfma_f32_16x16x32_bf16 v[120:123], v[148:151], a[136:139], v[120:123]
    buffer_load_dwordx4 v213, s[36:39], s24 offen offset:3072 lds
    v_lshlrev_b32 v14, 4, v15
    v_mfma_f32_16x16x32_bf16 v[124:127], v[148:151], a[200:203], v[124:127]
    v_add_u32 v224, v12, v14
    v_lshl_add_u32 v21, v13, 8, s101
    v_mfma_f32_16x16x32_bf16 v[64:67], v[128:131], a[12:15], v[64:67]
    v_add_u32 v25, 1, v17
    v_and_b32 v24, 8, v25
    v_mfma_f32_16x16x32_bf16 v[68:71], v[128:131], a[76:79], v[68:71]
    v_and_b32 v27, 7, v25
    v_xor_b32 v26, v27, v13
    v_mfma_f32_16x16x32_bf16 v[80:83], v[128:131], a[140:143], v[80:83]
    v_add_u32 v23, v24, v26
    v_lshlrev_b32 v22, 4, v23
    v_mfma_f32_16x16x32_bf16 v[84:87], v[128:131], a[204:207], v[84:87]
    v_add_u32 v225, v21, v22
    s_waitcnt lgkmcnt(0)
    v_mfma_f32_16x16x32_bf16 v[72:75], v[132:135], a[12:15], v[72:75]
    v_mfma_f32_16x16x32_bf16 v[76:79], v[132:135], a[76:79], v[76:79]
    v_mfma_f32_16x16x32_bf16 v[88:91], v[132:135], a[140:143], v[88:91]
    v_mfma_f32_16x16x32_bf16 v[92:95], v[132:135], a[204:207], v[92:95]
    v_mfma_f32_16x16x32_bf16 v[96:99], v[136:139], a[12:15], v[96:99]
    v_mfma_f32_16x16x32_bf16 v[100:103], v[136:139], a[76:79], v[100:103]
    v_mfma_f32_16x16x32_bf16 v[112:115], v[136:139], a[140:143], v[112:115]
    v_mfma_f32_16x16x32_bf16 v[116:119], v[136:139], a[204:207], v[116:119]
    s_waitcnt vmcnt(28)
    s_barrier
    ds_read_b64_tr_b16 v[144:145], v214 offset:0
    ds_read_b64_tr_b16 v[146:147], v214 offset:512
    v_mfma_f32_16x16x32_bf16 v[104:107], v[140:143], a[12:15], v[104:107]
    ds_read_b64_tr_b16 v[148:149], v214 offset:8192
    ds_read_b64_tr_b16 v[150:151], v214 offset:8704
    v_mfma_f32_16x16x32_bf16 v[108:111], v[140:143], a[76:79], v[108:111]
    s_add_u32 m0, s97, 81920
    s_nop 0
    buffer_load_dwordx4 v210, s[36:39], s25 offen lds
    v_mfma_f32_16x16x32_bf16 v[120:123], v[140:143], a[140:143], v[120:123]
    ds_read_b64_tr_b16 v[128:129], v215 offset:0
    ds_read_b64_tr_b16 v[130:131], v215 offset:512
    v_mfma_f32_16x16x32_bf16 v[124:127], v[140:143], a[204:207], v[124:127]
    s_waitcnt lgkmcnt(4)
    v_mfma_f32_16x16x32_bf16 v[64:67], v[144:147], a[16:19], v[64:67]
    ds_read_b64_tr_b16 v[132:133], v215 offset:8192
    ds_read_b64_tr_b16 v[134:135], v215 offset:8704
    v_mfma_f32_16x16x32_bf16 v[68:71], v[144:147], a[80:83], v[68:71]
    v_mfma_f32_16x16x32_bf16 v[80:83], v[144:147], a[144:147], v[80:83]
    ds_read_b64_tr_b16 v[136:137], v214 offset:4096
    ds_read_b64_tr_b16 v[138:139], v214 offset:4608
    v_mfma_f32_16x16x32_bf16 v[84:87], v[144:147], a[208:211], v[84:87]
    buffer_load_dwordx4 v211, s[36:39], s25 offen offset:1024 lds
    s_waitcnt lgkmcnt(6)
    v_mfma_f32_16x16x32_bf16 v[72:75], v[148:151], a[16:19], v[72:75]
    ds_read_b64_tr_b16 v[140:141], v214 offset:12288
    ds_read_b64_tr_b16 v[142:143], v214 offset:12800
    v_mfma_f32_16x16x32_bf16 v[76:79], v[148:151], a[80:83], v[76:79]
    v_mfma_f32_16x16x32_bf16 v[88:91], v[148:151], a[144:147], v[88:91]
    ds_read_b64_tr_b16 v[144:145], v215 offset:4096
    ds_read_b64_tr_b16 v[146:147], v215 offset:4608
    v_mfma_f32_16x16x32_bf16 v[92:95], v[148:151], a[208:211], v[92:95]
    s_waitcnt lgkmcnt(8)
    v_mfma_f32_16x16x32_bf16 v[96:99], v[128:131], a[16:19], v[96:99]
    ds_read_b64_tr_b16 v[148:149], v215 offset:12288
    ds_read_b64_tr_b16 v[150:151], v215 offset:12800
    v_mfma_f32_16x16x32_bf16 v[100:103], v[128:131], a[80:83], v[100:103]
    buffer_load_dwordx4 v212, s[36:39], s25 offen offset:2048 lds
    v_mfma_f32_16x16x32_bf16 v[112:115], v[128:131], a[144:147], v[112:115]
    v_add_u32 v214, 0x4000, v214
    v_add_u32 v215, 0x4000, v215
    v_mfma_f32_16x16x32_bf16 v[116:119], v[128:131], a[208:211], v[116:119]
    s_waitcnt lgkmcnt(7)
    v_mfma_f32_16x16x32_bf16 v[104:107], v[132:135], a[16:19], v[104:107]
    v_mfma_f32_16x16x32_bf16 v[108:111], v[132:135], a[80:83], v[108:111]
    v_mfma_f32_16x16x32_bf16 v[120:123], v[132:135], a[144:147], v[120:123]
    buffer_load_dwordx4 v213, s[36:39], s25 offen offset:3072 lds
    v_mfma_f32_16x16x32_bf16 v[124:127], v[132:135], a[208:211], v[124:127]
    s_waitcnt lgkmcnt(3)
    v_mfma_f32_16x16x32_bf16 v[64:67], v[136:139], a[20:23], v[64:67]
    s_waitcnt vmcnt(9)
    buffer_store_dword v243, v237, s[40:43], s74 offen sc1
    v_mfma_f32_16x16x32_bf16 v[68:71], v[136:139], a[84:87], v[68:71]
    v_mfma_f32_16x16x32_bf16 v[80:83], v[136:139], a[148:151], v[80:83]
    s_add_u32 m0, s97, 0
    v_mfma_f32_16x16x32_bf16 v[84:87], v[136:139], a[212:215], v[84:87]
    v_mfma_f32_16x16x32_bf16 v[72:75], v[140:143], a[20:23], v[72:75]
    buffer_load_dwordx4 v251, s[48:51], s83 offen lds
    v_mfma_f32_16x16x32_bf16 v[76:79], v[140:143], a[84:87], v[76:79]
    v_mfma_f32_16x16x32_bf16 v[88:91], v[140:143], a[148:151], v[88:91]
    v_mfma_f32_16x16x32_bf16 v[92:95], v[140:143], a[212:215], v[92:95]
    s_waitcnt lgkmcnt(0)
    v_mfma_f32_16x16x32_bf16 v[96:99], v[144:147], a[20:23], v[96:99]
    buffer_load_dwordx4 v252, s[48:51], s83 offen offset:1024 lds
    v_mfma_f32_16x16x32_bf16 v[100:103], v[144:147], a[84:87], v[100:103]
    v_mfma_f32_16x16x32_bf16 v[112:115], v[144:147], a[148:151], v[112:115]
    v_mfma_f32_16x16x32_bf16 v[116:119], v[144:147], a[212:215], v[116:119]
    s_barrier
    ds_read_b64_tr_b16 v[128:129], v214 offset:0
    ds_read_b64_tr_b16 v[130:131], v214 offset:512
    v_mfma_f32_16x16x32_bf16 v[104:107], v[148:151], a[20:23], v[104:107]
    ds_read_b64_tr_b16 v[132:133], v214 offset:8192
    ds_read_b64_tr_b16 v[134:135], v214 offset:8704
    v_mfma_f32_16x16x32_bf16 v[108:111], v[148:151], a[84:87], v[108:111]
    buffer_load_dwordx4 v253, s[48:51], s83 offen offset:2048 lds
    v_mfma_f32_16x16x32_bf16 v[120:123], v[148:151], a[148:151], v[120:123]
    ds_read_b64_tr_b16 v[136:137], v215 offset:0
    ds_read_b64_tr_b16 v[138:139], v215 offset:512
    v_mfma_f32_16x16x32_bf16 v[124:127], v[148:151], a[212:215], v[124:127]
    s_waitcnt lgkmcnt(4)
    v_mfma_f32_16x16x32_bf16 v[64:67], v[128:131], a[24:27], v[64:67]
    ds_read_b64_tr_b16 v[140:141], v215 offset:8192
    ds_read_b64_tr_b16 v[142:143], v215 offset:8704
    v_mfma_f32_16x16x32_bf16 v[68:71], v[128:131], a[88:91], v[68:71]
    buffer_load_dwordx4 v254, s[48:51], s83 offen offset:3072 lds
    v_mfma_f32_16x16x32_bf16 v[80:83], v[128:131], a[152:155], v[80:83]
    ds_read_b64_tr_b16 v[144:145], v214 offset:4096
    ds_read_b64_tr_b16 v[146:147], v214 offset:4608
    v_mfma_f32_16x16x32_bf16 v[84:87], v[128:131], a[216:219], v[84:87]
    s_waitcnt lgkmcnt(6)
    v_mfma_f32_16x16x32_bf16 v[72:75], v[132:135], a[24:27], v[72:75]
    ds_read_b64_tr_b16 v[148:149], v214 offset:12288
    ds_read_b64_tr_b16 v[150:151], v214 offset:12800
    v_mfma_f32_16x16x32_bf16 v[76:79], v[132:135], a[88:91], v[76:79]
    s_add_u32 m0, s97, 98304
    v_mfma_f32_16x16x32_bf16 v[88:91], v[132:135], a[152:155], v[88:91]
    ds_read_b64_tr_b16 v[128:129], v215 offset:4096
    ds_read_b64_tr_b16 v[130:131], v215 offset:4608
    v_mfma_f32_16x16x32_bf16 v[92:95], v[132:135], a[216:219], v[92:95]
    buffer_load_dwordx4 v210, s[36:39], s26 offen lds
    s_waitcnt lgkmcnt(8)
    v_mfma_f32_16x16x32_bf16 v[96:99], v[136:139], a[24:27], v[96:99]
    ds_read_b64_tr_b16 v[132:133], v215 offset:12288
    ds_read_b64_tr_b16 v[134:135], v215 offset:12800
    v_mfma_f32_16x16x32_bf16 v[100:103], v[136:139], a[88:91], v[100:103]
    v_mfma_f32_16x16x32_bf16 v[112:115], v[136:139], a[152:155], v[112:115]
    v_add_u32 v214, 0xffff4000, v214
    v_add_u32 v215, 0xffff4000, v215
    v_mfma_f32_16x16x32_bf16 v[116:119], v[136:139], a[216:219], v[116:119]
    s_waitcnt lgkmcnt(7)
    v_mfma_f32_16x16x32_bf16 v[104:107], v[140:143], a[24:27], v[104:107]
    buffer_load_dwordx4 v211, s[36:39], s26 offen offset:1024 lds
    v_mfma_f32_16x16x32_bf16 v[108:111], v[140:143], a[88:91], v[108:111]
    v_mfma_f32_16x16x32_bf16 v[120:123], v[140:143], a[152:155], v[120:123]
    v_mfma_f32_16x16x32_bf16 v[124:127], v[140:143], a[216:219], v[124:127]
    s_waitcnt lgkmcnt(3)
    v_mfma_f32_16x16x32_bf16 v[64:67], v[144:147], a[28:31], v[64:67]
    v_mfma_f32_16x16x32_bf16 v[68:71], v[144:147], a[92:95], v[68:71]
    v_mfma_f32_16x16x32_bf16 v[80:83], v[144:147], a[156:159], v[80:83]
    buffer_load_dwordx4 v212, s[36:39], s26 offen offset:2048 lds
    v_mfma_f32_16x16x32_bf16 v[84:87], v[144:147], a[220:223], v[84:87]
    v_mfma_f32_16x16x32_bf16 v[72:75], v[148:151], a[28:31], v[72:75]
    v_mfma_f32_16x16x32_bf16 v[76:79], v[148:151], a[92:95], v[76:79]
    v_mfma_f32_16x16x32_bf16 v[88:91], v[148:151], a[156:159], v[88:91]
    v_mfma_f32_16x16x32_bf16 v[92:95], v[148:151], a[220:223], v[92:95]
    s_waitcnt lgkmcnt(0)
    v_mfma_f32_16x16x32_bf16 v[96:99], v[128:131], a[28:31], v[96:99]
    buffer_load_dwordx4 v213, s[36:39], s26 offen offset:3072 lds
    v_mfma_f32_16x16x32_bf16 v[100:103], v[128:131], a[92:95], v[100:103]
    v_mfma_f32_16x16x32_bf16 v[112:115], v[128:131], a[156:159], v[112:115]
    v_mfma_f32_16x16x32_bf16 v[116:119], v[128:131], a[220:223], v[116:119]
    s_waitcnt vmcnt(13)
    s_barrier
    ds_read_b64_tr_b16 v[136:137], v214 offset:0
    ds_read_b64_tr_b16 v[138:139], v214 offset:512
    v_mfma_f32_16x16x32_bf16 v[104:107], v[132:135], a[28:31], v[104:107]
    ds_read_b64_tr_b16 v[140:141], v214 offset:8192
    ds_read_b64_tr_b16 v[142:143], v214 offset:8704
    v_mfma_f32_16x16x32_bf16 v[108:111], v[132:135], a[92:95], v[108:111]
    s_add_u32 m0, s97, 114688
    v_mfma_f32_16x16x32_bf16 v[120:123], v[132:135], a[156:159], v[120:123]
    ds_read_b64_tr_b16 v[144:145], v215 offset:0
    ds_read_b64_tr_b16 v[146:147], v215 offset:512
    v_mfma_f32_16x16x32_bf16 v[124:127], v[132:135], a[220:223], v[124:127]
    buffer_load_dwordx4 v210, s[36:39], s27 offen lds
    s_waitcnt lgkmcnt(4)
    v_mfma_f32_16x16x32_bf16 v[64:67], v[136:139], a[32:35], v[64:67]
    ds_read_b64_tr_b16 v[148:149], v215 offset:8192
    ds_read_b64_tr_b16 v[150:151], v215 offset:8704
    v_mfma_f32_16x16x32_bf16 v[68:71], v[136:139], a[96:99], v[68:71]
    v_mfma_f32_16x16x32_bf16 v[80:83], v[136:139], a[160:163], v[80:83]
    ds_read_b64_tr_b16 v[128:129], v214 offset:4096
    ds_read_b64_tr_b16 v[130:131], v214 offset:4608
    v_mfma_f32_16x16x32_bf16 v[84:87], v[136:139], a[224:227], v[84:87]
    v_add_u32 v245, 0x20000, v245
    v_add_u32 v246, 0x20000, v246
    s_waitcnt lgkmcnt(6)
    v_mfma_f32_16x16x32_bf16 v[72:75], v[140:143], a[32:35], v[72:75]
    ds_read_b64_tr_b16 v[132:133], v214 offset:12288
    ds_read_b64_tr_b16 v[134:135], v214 offset:12800
    v_mfma_f32_16x16x32_bf16 v[76:79], v[140:143], a[96:99], v[76:79]
    buffer_load_dwordx4 v211, s[36:39], s27 offen offset:1024 lds
    v_add_u32 v247, 0x20000, v247
    v_mfma_f32_16x16x32_bf16 v[88:91], v[140:143], a[160:163], v[88:91]
    ds_read_b64_tr_b16 v[136:137], v215 offset:4096
    ds_read_b64_tr_b16 v[138:139], v215 offset:4608
    v_mfma_f32_16x16x32_bf16 v[92:95], v[140:143], a[224:227], v[92:95]
    v_add_u32 v248, 0x20000, v248
    s_waitcnt lgkmcnt(8)
    v_mfma_f32_16x16x32_bf16 v[96:99], v[144:147], a[32:35], v[96:99]
    ds_read_b64_tr_b16 v[140:141], v215 offset:12288
    ds_read_b64_tr_b16 v[142:143], v215 offset:12800
    v_mfma_f32_16x16x32_bf16 v[100:103], v[144:147], a[96:99], v[100:103]
    ds_read_b64_tr_b16 a[0:1], v245 offset:0
    ds_read_b64_tr_b16 a[2:3], v245 offset:512
    v_mfma_f32_16x16x32_bf16 v[112:115], v[144:147], a[160:163], v[112:115]
    v_add_u32 v214, 0x4000, v214
    v_add_u32 v215, 0x4000, v215
    v_mfma_f32_16x16x32_bf16 v[116:119], v[144:147], a[224:227], v[116:119]
    buffer_load_dwordx4 v212, s[36:39], s27 offen offset:2048 lds
    ds_read_b64_tr_b16 a[64:65], v246 offset:0
    s_waitcnt lgkmcnt(9)
    v_mfma_f32_16x16x32_bf16 v[104:107], v[148:151], a[32:35], v[104:107]
    ds_read_b64_tr_b16 a[66:67], v246 offset:512
    ds_read_b64_tr_b16 a[128:129], v247 offset:0
    v_mfma_f32_16x16x32_bf16 v[108:111], v[148:151], a[96:99], v[108:111]
    ds_read_b64_tr_b16 a[130:131], v247 offset:512
    ds_read_b64_tr_b16 a[192:193], v248 offset:0
    v_mfma_f32_16x16x32_bf16 v[120:123], v[148:151], a[160:163], v[120:123]
    ds_read_b64_tr_b16 a[194:195], v248 offset:512
    v_mfma_f32_16x16x32_bf16 v[124:127], v[148:151], a[224:227], v[124:127]
    v_mfma_f32_16x16x32_bf16 v[64:67], v[128:131], a[36:39], v[64:67]
    v_mfma_f32_16x16x32_bf16 v[68:71], v[128:131], a[100:103], v[68:71]
    v_mfma_f32_16x16x32_bf16 v[80:83], v[128:131], a[164:167], v[80:83]
    buffer_load_dwordx4 v213, s[36:39], s27 offen offset:3072 lds
    v_mfma_f32_16x16x32_bf16 v[84:87], v[128:131], a[228:231], v[84:87]
    s_waitcnt lgkmcnt(6)
    v_mfma_f32_16x16x32_bf16 v[72:75], v[132:135], a[36:39], v[72:75]
    v_mfma_f32_16x16x32_bf16 v[76:79], v[132:135], a[100:103], v[76:79]
    v_mfma_f32_16x16x32_bf16 v[88:91], v[132:135], a[164:167], v[88:91]
    s_add_u32 m0, s97, 16384
    v_mfma_f32_16x16x32_bf16 v[92:95], v[132:135], a[228:231], v[92:95]
    v_mfma_f32_16x16x32_bf16 v[96:99], v[136:139], a[36:39], v[96:99]
    buffer_load_dwordx4 v251, s[52:55], s87 offen lds
    v_mfma_f32_16x16x32_bf16 v[100:103], v[136:139], a[100:103], v[100:103]
    v_mfma_f32_16x16x32_bf16 v[112:115], v[136:139], a[164:167], v[112:115]
    v_mfma_f32_16x16x32_bf16 v[116:119], v[136:139], a[228:231], v[116:119]
    s_waitcnt lgkmcnt(0)
    s_waitcnt vmcnt(14)
    s_barrier
    ds_read_b64_tr_b16 v[144:145], v214 offset:0
    ds_read_b64_tr_b16 v[146:147], v214 offset:512
    v_mfma_f32_16x16x32_bf16 v[104:107], v[140:143], a[36:39], v[104:107]
    ds_read_b64_tr_b16 v[148:149], v214 offset:8192
    ds_read_b64_tr_b16 v[150:151], v214 offset:8704
    v_mfma_f32_16x16x32_bf16 v[108:111], v[140:143], a[100:103], v[108:111]
    buffer_load_dwordx4 v252, s[52:55], s87 offen offset:1024 lds
    v_mfma_f32_16x16x32_bf16 v[120:123], v[140:143], a[164:167], v[120:123]
    ds_read_b64_tr_b16 v[128:129], v215 offset:0
    ds_read_b64_tr_b16 v[130:131], v215 offset:512
    v_mfma_f32_16x16x32_bf16 v[124:127], v[140:143], a[228:231], v[124:127]
    s_waitcnt lgkmcnt(4)
    v_mfma_f32_16x16x32_bf16 v[64:67], v[144:147], a[40:43], v[64:67]
    ds_read_b64_tr_b16 v[132:133], v215 offset:8192
    ds_read_b64_tr_b16 v[134:135], v215 offset:8704
    v_mfma_f32_16x16x32_bf16 v[68:71], v[144:147], a[104:107], v[68:71]
    buffer_load_dwordx4 v253, s[52:55], s87 offen offset:2048 lds
    v_mfma_f32_16x16x32_bf16 v[80:83], v[144:147], a[168:171], v[80:83]
    ds_read_b64_tr_b16 v[136:137], v214 offset:4096
    ds_read_b64_tr_b16 v[138:139], v214 offset:4608
    v_mfma_f32_16x16x32_bf16 v[84:87], v[144:147], a[232:235], v[84:87]
    v_add_u32 v245, 0xfffe0000, v245
    v_add_u32 v246, 0xfffe0000, v246
    s_waitcnt lgkmcnt(6)
    v_mfma_f32_16x16x32_bf16 v[72:75], v[148:151], a[40:43], v[72:75]
    ds_read_b64_tr_b16 v[140:141], v214 offset:12288
    ds_read_b64_tr_b16 v[142:143], v214 offset:12800
    v_mfma_f32_16x16x32_bf16 v[76:79], v[148:151], a[104:107], v[76:79]
    buffer_load_dwordx4 v254, s[52:55], s87 offen offset:3072 lds
    v_add_u32 v247, 0xfffe0000, v247
    v_mfma_f32_16x16x32_bf16 v[88:91], v[148:151], a[168:171], v[88:91]
    ds_read_b64_tr_b16 v[144:145], v215 offset:4096
    ds_read_b64_tr_b16 v[146:147], v215 offset:4608
    v_mfma_f32_16x16x32_bf16 v[92:95], v[148:151], a[232:235], v[92:95]
    s_add_u32 m0, s97, 32768
    v_add_u32 v248, 0xfffe0000, v248
    s_waitcnt lgkmcnt(8)
    v_mfma_f32_16x16x32_bf16 v[96:99], v[128:131], a[40:43], v[96:99]
    ds_read_b64_tr_b16 v[148:149], v215 offset:12288
    ds_read_b64_tr_b16 v[150:151], v215 offset:12800
    v_mfma_f32_16x16x32_bf16 v[100:103], v[128:131], a[104:107], v[100:103]
    buffer_load_dwordx4 v251, s[48:51], s78 offen lds
    v_mfma_f32_16x16x32_bf16 v[112:115], v[128:131], a[168:171], v[112:115]
    v_add_u32 v214, 0x4000, v214
    v_add_u32 v215, 0x4000, v215
    v_mfma_f32_16x16x32_bf16 v[116:119], v[128:131], a[232:235], v[116:119]
    ds_read_b64_tr_b16 a[4:5], v245 offset:49152
    ds_read_b64_tr_b16 a[6:7], v245 offset:49664
    s_waitcnt lgkmcnt(8)
    v_mfma_f32_16x16x32_bf16 v[104:107], v[132:135], a[40:43], v[104:107]
    buffer_load_dwordx4 v252, s[48:51], s78 offen offset:1024 lds
    ds_read_b64_tr_b16 a[68:69], v246 offset:49152
    v_mfma_f32_16x16x32_bf16 v[108:111], v[132:135], a[104:107], v[108:111]
    ds_read_b64_tr_b16 a[70:71], v246 offset:49664
    ds_read_b64_tr_b16 a[132:133], v247 offset:49152
L_pad_kv_2:
    s_cbranch_execz L_walked_kv
    v_mfma_f32_16x16x32_bf16 v[120:123], v[132:135], a[168:171], v[120:123]
    ds_read_b64_tr_b16 a[134:135], v247 offset:49664
    ds_read_b64_tr_b16 a[196:197], v248 offset:49152
    v_mfma_f32_16x16x32_bf16 v[124:127], v[132:135], a[232:235], v[124:127]
    ds_read_b64_tr_b16 a[198:199], v248 offset:49664
    v_mfma_f32_16x16x32_bf16 v[64:67], v[136:139], a[44:47], v[64:67]
    buffer_load_dwordx4 v253, s[48:51], s78 offen offset:2048 lds
    v_mfma_f32_16x16x32_bf16 v[68:71], v[136:139], a[108:111], v[68:71]
    v_mfma_f32_16x16x32_bf16 v[80:83], v[136:139], a[172:175], v[80:83]
    v_mfma_f32_16x16x32_bf16 v[84:87], v[136:139], a[236:239], v[84:87]
    s_waitcnt lgkmcnt(8)
    v_mfma_f32_16x16x32_bf16 v[72:75], v[140:143], a[44:47], v[72:75]
    buffer_load_dwordx4 v254, s[48:51], s78 offen offset:3072 lds
    v_mfma_f32_16x16x32_bf16 v[76:79], v[140:143], a[108:111], v[76:79]
    v_mfma_f32_16x16x32_bf16 v[88:91], v[140:143], a[172:175], v[88:91]
    s_add_u32 m0, s97, 65536
    v_mfma_f32_16x16x32_bf16 v[92:95], v[140:143], a[236:239], v[92:95]
    v_mfma_f32_16x16x32_bf16 v[96:99], v[144:147], a[44:47], v[96:99]
    buffer_load_dwordx4 v251, s[48:51], s79 offen lds
    v_mfma_f32_16x16x32_bf16 v[100:103], v[144:147], a[108:111], v[100:103]
    v_mfma_f32_16x16x32_bf16 v[112:115], v[144:147], a[172:175], v[112:115]
    v_mfma_f32_16x16x32_bf16 v[116:119], v[144:147], a[236:239], v[116:119]
    s_waitcnt lgkmcnt(0)
    s_waitcnt vmcnt(13)
    s_barrier
    ds_read_b64_tr_b16 v[128:129], v214 offset:0
    ds_read_b64_tr_b16 v[130:131], v214 offset:512
    v_mfma_f32_16x16x32_bf16 v[104:107], v[148:151], a[44:47], v[104:107]
    ds_read_b64_tr_b16 v[132:133], v214 offset:8192
    ds_read_b64_tr_b16 v[134:135], v214 offset:8704
    v_mfma_f32_16x16x32_bf16 v[108:111], v[148:151], a[108:111], v[108:111]
    v_mfma_f32_16x16x32_bf16 v[120:123], v[148:151], a[172:175], v[120:123]
    ds_read_b64_tr_b16 v[136:137], v215 offset:0
    ds_read_b64_tr_b16 v[138:139], v215 offset:512
    v_mfma_f32_16x16x32_bf16 v[124:127], v[148:151], a[236:239], v[124:127]
    buffer_load_dwordx4 v252, s[48:51], s79 offen offset:1024 lds
    s_waitcnt lgkmcnt(4)
    v_mfma_f32_16x16x32_bf16 v[64:67], v[128:131], a[48:51], v[64:67]
    ds_read_b64_tr_b16 v[140:141], v215 offset:8192
    ds_read_b64_tr_b16 v[142:143], v215 offset:8704
    v_mfma_f32_16x16x32_bf16 v[68:71], v[128:131], a[112:115], v[68:71]
    s_lshr_b32 s4, s76, 4
    s_lshr_b32 s5, s77, 4
    v_mfma_f32_16x16x32_bf16 v[80:83], v[128:131], a[176:179], v[80:83]
    ds_read_b64_tr_b16 v[144:145], v214 offset:4096
    ds_read_b64_tr_b16 v[146:147], v214 offset:4608
    v_mfma_f32_16x16x32_bf16 v[84:87], v[128:131], a[240:243], v[84:87]
    buffer_load_dwordx4 v253, s[48:51], s79 offen offset:2048 lds
    s_lshr_b32 s6, s78, 4
    s_waitcnt lgkmcnt(6)
    v_mfma_f32_16x16x32_bf16 v[72:75], v[132:135], a[48:51], v[72:75]
    ds_read_b64_tr_b16 v[148:149], v214 offset:12288
    ds_read_b64_tr_b16 v[150:151], v214 offset:12800
    v_mfma_f32_16x16x32_bf16 v[76:79], v[132:135], a[112:115], v[76:79]
    s_lshr_b32 s7, s79, 4
    s_lshr_b32 s8, s80, 4
    v_mfma_f32_16x16x32_bf16 v[88:91], v[132:135], a[176:179], v[88:91]
    ds_read_b64_tr_b16 v[128:129], v215 offset:4096
    ds_read_b64_tr_b16 v[130:131], v215 offset:4608
    v_mfma_f32_16x16x32_bf16 v[92:95], v[132:135], a[240:243], v[92:95]
    buffer_load_dwordx4 v254, s[48:51], s79 offen offset:3072 lds
    s_lshr_b32 s9, s81, 4
    s_waitcnt lgkmcnt(8)
    v_mfma_f32_16x16x32_bf16 v[96:99], v[136:139], a[48:51], v[96:99]
    ds_read_b64_tr_b16 v[132:133], v215 offset:12288
    ds_read_b64_tr_b16 v[134:135], v215 offset:12800
    v_mfma_f32_16x16x32_bf16 v[100:103], v[136:139], a[112:115], v[100:103]
    s_add_u32 m0, s97, 131072
    s_lshr_b32 s10, s82, 4
    v_mfma_f32_16x16x32_bf16 v[112:115], v[136:139], a[176:179], v[112:115]
    v_add_u32 v214, 0x4000, v214
    v_add_u32 v215, 0x4000, v215
    v_mfma_f32_16x16x32_bf16 v[116:119], v[136:139], a[240:243], v[116:119]
    buffer_load_dwordx4 v251, s[48:51], s80 offen lds
    s_lshr_b32 s11, s83, 4
    s_waitcnt lgkmcnt(6)
    v_mfma_f32_16x16x32_bf16 v[104:107], v[140:143], a[48:51], v[104:107]
    s_lshr_b32 s12, s84, 4
    s_lshr_b32 s13, s85, 4
    v_mfma_f32_16x16x32_bf16 v[108:111], v[140:143], a[112:115], v[108:111]
    s_lshr_b32 s14, s86, 4
    s_lshl_b32 s19, s98, 16
    v_mfma_f32_16x16x32_bf16 v[120:123], v[140:143], a[176:179], v[120:123]
    buffer_load_dwordx4 v252, s[48:51], s80 offen offset:1024 lds
    s_add_u32 s19, s19, 5636096
    v_mfma_f32_16x16x32_bf16 v[124:127], v[140:143], a[240:243], v[124:127]
    s_lshr_b32 s15, s87, 4
    s_add_u32 s15, s15, s19
    v_mfma_f32_16x16x32_bf16 v[64:67], v[144:147], a[52:55], v[64:67]
    s_lshr_b32 s16, s88, 4
    s_add_u32 s16, s16, s19
    v_mfma_f32_16x16x32_bf16 v[68:71], v[144:147], a[116:119], v[68:71]
    s_lshr_b32 s17, s89, 4
    s_add_u32 s17, s17, s19
    v_mfma_f32_16x16x32_bf16 v[80:83], v[144:147], a[180:183], v[80:83]
    buffer_load_dwordx4 v253, s[48:51], s80 offen offset:2048 lds
    s_lshr_b32 s18, s90, 4
    v_mfma_f32_16x16x32_bf16 v[84:87], v[144:147], a[244:247], v[84:87]
    s_add_u32 s18, s18, s19
    s_lshl_b32 s19, s98, 12
    s_waitcnt lgkmcnt(0)
    v_mfma_f32_16x16x32_bf16 v[72:75], v[148:151], a[52:55], v[72:75]
    s_add_u32 s19, s19, 7815168
    s_lshl_b32 s20, s98, 11
    v_mfma_f32_16x16x32_bf16 v[76:79], v[148:151], a[116:119], v[76:79]
    s_add_u32 s20, s20, 8011776
    s_lshl_b32 s21, s98, 8
    v_mfma_f32_16x16x32_bf16 v[88:91], v[148:151], a[180:183], v[88:91]
    buffer_load_dwordx4 v254, s[48:51], s80 offen offset:3072 lds
    s_add_u32 s21, s21, 7733248
    v_mfma_f32_16x16x32_bf16 v[92:95], v[148:151], a[244:247], v[92:95]
    v_mfma_f32_16x16x32_bf16 v[96:99], v[128:131], a[52:55], v[96:99]
    s_add_u32 m0, s97, 81920
    v_mfma_f32_16x16x32_bf16 v[100:103], v[128:131], a[116:119], v[100:103]
    v_mfma_f32_16x16x32_bf16 v[112:115], v[128:131], a[180:183], v[112:115]
    v_mfma_f32_16x16x32_bf16 v[116:119], v[128:131], a[244:247], v[116:119]
    s_waitcnt vmcnt(16)
    s_barrier
    ds_read_b64_tr_b16 v[136:137], v214 offset:0
    ds_read_b64_tr_b16 v[138:139], v214 offset:512
    buffer_load_dwordx4 v251, s[48:51], s81 offen lds
    v_mfma_f32_16x16x32_bf16 v[104:107], v[132:135], a[52:55], v[104:107]
    ds_read_b64_tr_b16 v[140:141], v214 offset:8192
    ds_read_b64_tr_b16 v[142:143], v214 offset:8704
    v_mfma_f32_16x16x32_bf16 v[108:111], v[132:135], a[116:119], v[108:111]
    v_mfma_f32_16x16x32_bf16 v[120:123], v[132:135], a[180:183], v[120:123]
    ds_read_b64_tr_b16 v[144:145], v214 offset:4096
    ds_read_b64_tr_b16 v[146:147], v214 offset:4608
    v_mfma_f32_16x16x32_bf16 v[124:127], v[132:135], a[244:247], v[124:127]
    buffer_load_dwordx4 v252, s[48:51], s81 offen offset:1024 lds
    s_waitcnt lgkmcnt(4)
    v_mfma_f32_16x16x32_bf16 v[64:67], v[136:139], a[56:59], v[64:67]
    ds_read_b64_tr_b16 v[148:149], v214 offset:12288
    ds_read_b64_tr_b16 v[150:151], v214 offset:12800
    v_mfma_f32_16x16x32_bf16 v[68:71], v[136:139], a[120:123], v[68:71]
    v_mfma_f32_16x16x32_bf16 v[80:83], v[136:139], a[184:187], v[80:83]
    ds_read_b64_tr_b16 v[128:129], v215 offset:0
    ds_read_b64_tr_b16 v[130:131], v215 offset:512
    v_mfma_f32_16x16x32_bf16 v[84:87], v[136:139], a[248:251], v[84:87]
    buffer_load_dwordx4 v253, s[48:51], s81 offen offset:2048 lds
    s_waitcnt lgkmcnt(6)
    v_mfma_f32_16x16x32_bf16 v[72:75], v[140:143], a[56:59], v[72:75]
    ds_read_b64_tr_b16 v[132:133], v215 offset:8192
    ds_read_b64_tr_b16 v[134:135], v215 offset:8704
    v_mfma_f32_16x16x32_bf16 v[76:79], v[140:143], a[120:123], v[76:79]
    v_mfma_f32_16x16x32_bf16 v[88:91], v[140:143], a[184:187], v[88:91]
    ds_read_b64_tr_b16 v[136:137], v215 offset:4096
    ds_read_b64_tr_b16 v[138:139], v215 offset:4608
    v_mfma_f32_16x16x32_bf16 v[92:95], v[140:143], a[248:251], v[92:95]
    s_waitcnt lgkmcnt(8)
    v_mfma_f32_16x16x32_bf16 v[64:67], v[144:147], a[60:63], v[64:67]
    ds_read_b64_tr_b16 v[140:141], v215 offset:12288
    ds_read_b64_tr_b16 v[142:143], v215 offset:12800
    v_mfma_f32_16x16x32_bf16 v[68:71], v[144:147], a[124:127], v[68:71]
    buffer_load_dwordx4 v254, s[48:51], s81 offen offset:3072 lds
    v_mfma_f32_16x16x32_bf16 v[80:83], v[144:147], a[188:191], v[80:83]
    s_add_u32 m0, s97, 49152
    v_mfma_f32_16x16x32_bf16 v[84:87], v[144:147], a[252:255], v[84:87]
    s_waitcnt lgkmcnt(7)
    v_mfma_f32_16x16x32_bf16 v[72:75], v[148:151], a[60:63], v[72:75]
    buffer_load_dwordx4 v251, s[48:51], s82 offen lds
    v_mfma_f32_16x16x32_bf16 v[76:79], v[148:151], a[124:127], v[76:79]
    v_mfma_f32_16x16x32_bf16 v[88:91], v[148:151], a[188:191], v[88:91]
    v_mfma_f32_16x16x32_bf16 v[92:95], v[148:151], a[252:255], v[92:95]
    s_waitcnt lgkmcnt(3)
    v_mfma_f32_16x16x32_bf16 v[96:99], v[128:131], a[56:59], v[96:99]
    buffer_load_dwordx4 v252, s[48:51], s82 offen offset:1024 lds
    v_mfma_f32_16x16x32_bf16 v[100:103], v[128:131], a[120:123], v[100:103]
    v_mfma_f32_16x16x32_bf16 v[104:107], v[132:135], a[56:59], v[104:107]
    v_mul_f32 v64, v64, v72
    v_mul_f32 v65, v65, v73
    v_mfma_f32_16x16x32_bf16 v[108:111], v[132:135], a[120:123], v[108:111]
    v_mul_f32 v66, v66, v74
    v_mul_f32 v67, v67, v75
    s_waitcnt lgkmcnt(0)
    v_mfma_f32_16x16x32_bf16 v[96:99], v[136:139], a[60:63], v[96:99]
    buffer_load_dwordx4 v253, s[48:51], s82 offen offset:2048 lds
    v_mul_f32 v68, v68, v76
    v_mfma_f32_16x16x32_bf16 v[100:103], v[136:139], a[124:127], v[100:103]
    v_mul_f32 v69, v69, v77
    v_mul_f32 v70, v70, v78
    v_mfma_f32_16x16x32_bf16 v[104:107], v[140:143], a[60:63], v[104:107]
    v_mul_f32 v71, v71, v79
    v_cvt_pk_bf16_f32 v72, v64, v65
    v_mfma_f32_16x16x32_bf16 v[108:111], v[140:143], a[124:127], v[108:111]
    v_cvt_pk_bf16_f32 v73, v66, v67
    v_cvt_pk_bf16_f32 v74, v68, v69
    v_mfma_f32_16x16x32_bf16 v[112:115], v[128:131], a[184:187], v[112:115]
    buffer_load_dwordx4 v254, s[48:51], s82 offen offset:3072 lds
    v_cvt_pk_bf16_f32 v75, v70, v71
    v_mfma_f32_16x16x32_bf16 v[116:119], v[128:131], a[248:251], v[116:119]
    v_permlane16_swap_b32 v72, v74
    v_permlane16_swap_b32 v73, v75
    v_mfma_f32_16x16x32_bf16 v[120:123], v[132:135], a[184:187], v[120:123]
    s_add_u32 m0, s97, 98304
    buffer_store_dwordx4 v[72:75], v244, s[40:43], s68 offen sc1
    v_mfma_f32_16x16x32_bf16 v[124:127], v[132:135], a[248:251], v[124:127]
    v_mul_f32 v80, v80, v88
    v_mul_f32 v81, v81, v89
    s_barrier
    v_mfma_f32_16x16x32_bf16 v[112:115], v[136:139], a[188:191], v[112:115]
    buffer_load_dwordx4 v251, s[48:51], s84 offen lds
    v_mul_f32 v82, v82, v90
    v_mfma_f32_16x16x32_bf16 v[116:119], v[136:139], a[252:255], v[116:119]
    v_mul_f32 v83, v83, v91
    v_mul_f32 v84, v84, v92
    v_mfma_f32_16x16x32_bf16 v[120:123], v[140:143], a[188:191], v[120:123]
    v_mul_f32 v85, v85, v93
    v_mul_f32 v86, v86, v94
    v_mfma_f32_16x16x32_bf16 v[124:127], v[140:143], a[252:255], v[124:127]
    v_mul_f32 v87, v87, v95
    v_cvt_pk_bf16_f32 v88, v80, v81
    v_cvt_pk_bf16_f32 v89, v82, v83
    v_cvt_pk_bf16_f32 v90, v84, v85
    v_cvt_pk_bf16_f32 v91, v86, v87
    s_nop 0
    v_permlane16_swap_b32 v88, v90
    v_permlane16_swap_b32 v89, v91
    buffer_store_dwordx4 v[88:91], v244, s[40:43], s69 offen sc1
    v_mul_f32 v96, v96, v104
    v_mul_f32 v97, v97, v105
    v_mul_f32 v98, v98, v106
    v_mul_f32 v99, v99, v107
    v_mul_f32 v100, v100, v108
    v_mul_f32 v101, v101, v109
    v_mul_f32 v102, v102, v110
    v_mul_f32 v103, v103, v111
    v_cvt_pk_bf16_f32 v104, v96, v97
    v_cvt_pk_bf16_f32 v105, v98, v99
    v_cvt_pk_bf16_f32 v106, v100, v101
    v_cvt_pk_bf16_f32 v107, v102, v103
    s_nop 0
    v_permlane16_swap_b32 v104, v106
    v_permlane16_swap_b32 v105, v107
    buffer_store_dwordx4 v[104:107], v244, s[40:43], s68 offen offset:1024 sc1
    v_mul_f32 v112, v112, v120
    v_mul_f32 v113, v113, v121
    v_mul_f32 v114, v114, v122
    v_mul_f32 v115, v115, v123
    v_mul_f32 v116, v116, v124
    v_mul_f32 v117, v117, v125
    v_mul_f32 v118, v118, v126
    v_mul_f32 v119, v119, v127
    v_cvt_pk_bf16_f32 v120, v112, v113
    v_cvt_pk_bf16_f32 v121, v114, v115
    v_cvt_pk_bf16_f32 v122, v116, v117
    v_cvt_pk_bf16_f32 v123, v118, v119
    s_nop 0
    v_permlane16_swap_b32 v120, v122
    v_permlane16_swap_b32 v121, v123
    buffer_store_dwordx4 v[120:123], v244, s[40:43], s69 offen offset:1024 sc1
    buffer_load_dwordx4 v252, s[48:51], s84 offen offset:1024 lds
    buffer_load_dwordx4 v253, s[48:51], s84 offen offset:2048 lds
    buffer_load_dwordx4 v254, s[48:51], s84 offen offset:3072 lds
    buffer_load_dword v239, v235, s[40:43], s19 offen offset:2048 sc1
    s_add_u32 m0, s97, 114688
    s_nop 0
    buffer_load_dwordx4 v251, s[48:51], s85 offen lds
    buffer_load_dwordx4 v252, s[48:51], s85 offen offset:1024 lds
    buffer_load_dwordx4 v253, s[48:51], s85 offen offset:2048 lds
    buffer_load_dwordx4 v254, s[48:51], s85 offen offset:3072 lds
    ds_read_b64_tr_b16 a[28:29], v245 offset:0
    ds_read_b64_tr_b16 a[30:31], v245 offset:512
    ds_read_b64_tr_b16 a[92:93], v246 offset:0
    ds_read_b64_tr_b16 a[94:95], v246 offset:512
    ds_read_b64_tr_b16 a[156:157], v247 offset:0
    ds_read_b64_tr_b16 a[158:159], v247 offset:512
    ds_read_b64_tr_b16 a[220:221], v248 offset:0
    ds_read_b64_tr_b16 a[222:223], v248 offset:512
    s_waitcnt lgkmcnt(0)
    s_add_u32 m0, s97, 0
    s_nop 0
    buffer_load_dwordx4 v251, s[48:51], s86 offen lds
    buffer_load_dwordx4 v252, s[48:51], s86 offen offset:1024 lds
    buffer_load_dwordx4 v253, s[48:51], s86 offen offset:2048 lds
    buffer_load_dwordx4 v254, s[48:51], s86 offen offset:3072 lds
    s_waitcnt vmcnt(37)
    ds_read_b64_tr_b16 a[44:45], v245 offset:16384
    ds_read_b64_tr_b16 a[46:47], v245 offset:16896
    ds_read_b64_tr_b16 a[108:109], v246 offset:16384
    ds_read_b64_tr_b16 a[110:111], v246 offset:16896
    ds_read_b64_tr_b16 a[172:173], v247 offset:16384
    ds_read_b64_tr_b16 a[174:175], v247 offset:16896
    ds_read_b64_tr_b16 a[236:237], v248 offset:16384
    ds_read_b64_tr_b16 a[238:239], v248 offset:16896
    s_waitcnt lgkmcnt(0)
    s_add_u32 m0, s97, 16384
    s_nop 0
    buffer_load_dwordx4 v251, s[52:55], s88 offen lds
    buffer_load_dwordx4 v252, s[52:55], s88 offen offset:1024 lds
    buffer_load_dwordx4 v253, s[52:55], s88 offen offset:2048 lds
    buffer_load_dwordx4 v254, s[52:55], s88 offen offset:3072 lds
    s_waitcnt vmcnt(37)
    ds_read_b64_tr_b16 a[8:9], v245 offset:32768
    ds_read_b64_tr_b16 a[10:11], v245 offset:33280
    ds_read_b64_tr_b16 a[72:73], v246 offset:32768
    ds_read_b64_tr_b16 a[74:75], v246 offset:33280
    ds_read_b64_tr_b16 a[136:137], v247 offset:32768
    ds_read_b64_tr_b16 a[138:139], v247 offset:33280
    ds_read_b64_tr_b16 a[200:201], v248 offset:32768
    ds_read_b64_tr_b16 a[202:203], v248 offset:33280
    s_waitcnt vmcnt(16)
    buffer_store_dword v243, v237, s[40:43], s70 offen sc1
    s_waitcnt lgkmcnt(0)
    s_add_u32 m0, s97, 32768
    s_nop 0
    buffer_load_dwordx4 v251, s[52:55], s89 offen lds
    buffer_load_dwordx4 v252, s[52:55], s89 offen offset:1024 lds
    buffer_load_dwordx4 v253, s[52:55], s89 offen offset:2048 lds
    buffer_load_dwordx4 v254, s[52:55], s89 offen offset:3072 lds
    v_add_u32 v245, 0x10000, v245
    v_add_u32 v246, 0x10000, v246
    v_add_u32 v247, 0x10000, v247
    v_add_u32 v248, 0x10000, v248
    ds_read_b64_tr_b16 a[12:13], v245 offset:0
    ds_read_b64_tr_b16 a[14:15], v245 offset:512
    ds_read_b64_tr_b16 a[76:77], v246 offset:0
    ds_read_b64_tr_b16 a[78:79], v246 offset:512
    ds_read_b64_tr_b16 a[140:141], v247 offset:0
    ds_read_b64_tr_b16 a[142:143], v247 offset:512
    ds_read_b64_tr_b16 a[204:205], v248 offset:0
    ds_read_b64_tr_b16 a[206:207], v248 offset:512
    s_waitcnt lgkmcnt(0)
    s_add_u32 m0, s97, 65536
    s_nop 0
    buffer_load_dwordx4 v251, s[52:55], s90 offen lds
    buffer_load_dwordx4 v252, s[52:55], s90 offen offset:1024 lds
    buffer_load_dwordx4 v253, s[52:55], s90 offen offset:2048 lds
    buffer_load_dwordx4 v254, s[52:55], s90 offen offset:3072 lds
    v_add_u32 v245, 0x10000, v245
    v_add_u32 v246, 0x10000, v246
    v_add_u32 v247, 0x10000, v247
    v_add_u32 v248, 0x10000, v248
    ds_read_b64_tr_b16 a[16:17], v245 offset:0
    ds_read_b64_tr_b16 a[18:19], v245 offset:512
    ds_read_b64_tr_b16 a[80:81], v246 offset:0
    ds_read_b64_tr_b16 a[82:83], v246 offset:512
    ds_read_b64_tr_b16 a[144:145], v247 offset:0
    ds_read_b64_tr_b16 a[146:147], v247 offset:512
    ds_read_b64_tr_b16 a[208:209], v248 offset:0
    ds_read_b64_tr_b16 a[210:211], v248 offset:512
    v_add_u32 v245, 0xffff0000, v245
    v_add_u32 v246, 0xffff0000, v246
    v_add_u32 v247, 0xffff0000, v247
    v_add_u32 v248, 0xffff0000, v248
    ds_read_b64_tr_b16 a[20:21], v245 offset:16384
    ds_read_b64_tr_b16 a[22:23], v245 offset:16896
    ds_read_b64_tr_b16 a[84:85], v246 offset:16384
    ds_read_b64_tr_b16 a[86:87], v246 offset:16896
    ds_read_b64_tr_b16 a[148:149], v247 offset:16384
    ds_read_b64_tr_b16 a[150:151], v247 offset:16896
    ds_read_b64_tr_b16 a[212:213], v248 offset:16384
    ds_read_b64_tr_b16 a[214:215], v248 offset:16896
    v_add_u32 v245, 0xffff0000, v245
    v_add_u32 v246, 0xffff0000, v246
    v_add_u32 v247, 0xffff0000, v247
    v_add_u32 v248, 0xffff0000, v248
    ds_read_b64_tr_b16 a[24:25], v245 offset:49152
    ds_read_b64_tr_b16 a[26:27], v245 offset:49664
    ds_read_b64_tr_b16 a[88:89], v246 offset:49152
    ds_read_b64_tr_b16 a[90:91], v246 offset:49664
    ds_read_b64_tr_b16 a[152:153], v247 offset:49152
    ds_read_b64_tr_b16 a[154:155], v247 offset:49664
    ds_read_b64_tr_b16 a[216:217], v248 offset:49152
    ds_read_b64_tr_b16 a[218:219], v248 offset:49664
    v_add_u32 v245, 0x10000, v245
    v_add_u32 v246, 0x10000, v246
    v_add_u32 v247, 0x10000, v247
    v_add_u32 v248, 0x10000, v248
    s_waitcnt vmcnt(22)
    ds_read_b64_tr_b16 a[32:33], v245 offset:32768
    ds_read_b64_tr_b16 a[34:35], v245 offset:33280
    ds_read_b64_tr_b16 a[96:97], v246 offset:32768
    ds_read_b64_tr_b16 a[98:99], v246 offset:33280
    ds_read_b64_tr_b16 a[160:161], v247 offset:32768
    ds_read_b64_tr_b16 a[162:163], v247 offset:33280
    ds_read_b64_tr_b16 a[224:225], v248 offset:32768
    ds_read_b64_tr_b16 a[226:227], v248 offset:33280
    s_waitcnt vmcnt(17)
    ds_read_b64_tr_b16 a[36:37], v245 offset:49152
    ds_read_b64_tr_b16 a[38:39], v245 offset:49664
    ds_read_b64_tr_b16 a[100:101], v246 offset:49152
    ds_read_b64_tr_b16 a[102:103], v246 offset:49664
    ds_read_b64_tr_b16 a[164:165], v247 offset:49152
    ds_read_b64_tr_b16 a[166:167], v247 offset:49664
    ds_read_b64_tr_b16 a[228:229], v248 offset:49152
    ds_read_b64_tr_b16 a[230:231], v248 offset:49664
    v_add_u32 v245, 0xffff0000, v245
    v_add_u32 v246, 0xffff0000, v246
    v_add_u32 v247, 0xffff0000, v247
    v_add_u32 v248, 0xffff0000, v248
    s_waitcnt vmcnt(13)
    ds_read_b64_tr_b16 a[40:41], v245 offset:0
    ds_read_b64_tr_b16 a[42:43], v245 offset:512
    ds_read_b64_tr_b16 a[104:105], v246 offset:0
    ds_read_b64_tr_b16 a[106:107], v246 offset:512
    ds_read_b64_tr_b16 a[168:169], v247 offset:0
    ds_read_b64_tr_b16 a[170:171], v247 offset:512
    ds_read_b64_tr_b16 a[232:233], v248 offset:0
    ds_read_b64_tr_b16 a[234:235], v248 offset:512
    v_cmp_ne_u32 vcc, v243, v239
    s_mov_b32 s101, 65536
    s_nop 3
    s_cbranch_vccz L_ok15
L_spin15:
    buffer_load_dword v239, v235, s[40:43], s19 offen offset:2048 sc1
    s_sub_u32 s101, s101, 1
    s_cmp_eq_u32 s101, 0
    s_cbranch_scc1 L_ok15
    s_waitcnt vmcnt(0)
    v_cmp_ne_u32 vcc, v243, v239
    s_nop 4
    s_cbranch_vccnz L_spin15
L_ok15:
    s_waitcnt vmcnt(9)
    buffer_load_dwordx4 v[128:131], v234, s[56:59], s4 offen sc1
    ds_read_b64_tr_b16 a[48:49], v245 offset:16384
    ds_read_b64_tr_b16 a[50:51], v245 offset:16896
    ds_read_b64_tr_b16 a[112:113], v246 offset:16384
    ds_read_b64_tr_b16 a[114:115], v246 offset:16896
    ds_read_b64_tr_b16 a[176:177], v247 offset:16384
    buffer_load_dwordx4 v[132:135], v234, s[56:59], s4 offen offset:256 sc1
    ds_read_b64_tr_b16 a[178:179], v247 offset:16896
    ds_read_b64_tr_b16 a[240:241], v248 offset:16384
    ds_read_b64_tr_b16 a[242:243], v248 offset:16896
    s_waitcnt vmcnt(6)
    ds_read_b64_tr_b16 a[52:53], v245 offset:32768
    buffer_load_dwordx4 v[136:139], v234, s[60:63], s4 offen sc1
    ds_read_b64_tr_b16 a[54:55], v245 offset:33280
    ds_read_b64_tr_b16 a[116:117], v246 offset:32768
    ds_read_b64_tr_b16 a[118:119], v246 offset:33280
    ds_read_b64_tr_b16 a[180:181], v247 offset:32768
    ds_read_b64_tr_b16 a[182:183], v247 offset:33280
    buffer_load_dwordx4 v[140:143], v234, s[60:63], s4 offen offset:256 sc1
    ds_read_b64_tr_b16 a[244:245], v248 offset:32768
    ds_read_b64_tr_b16 a[246:247], v248 offset:33280
    v_add_u32 v245, 0x10000, v245
    v_add_u32 v246, 0x10000, v246
    v_add_u32 v247, 0x10000, v247
    buffer_load_dwordx4 v[144:147], v234, s[56:59], s5 offen sc1
    v_add_u32 v248, 0x10000, v248
    s_waitcnt vmcnt(5)
    ds_read_b64_tr_b16 a[56:57], v245 offset:0
    ds_read_b64_tr_b16 a[58:59], v245 offset:512
    ds_read_b64_tr_b16 a[120:121], v246 offset:0
    buffer_load_dwordx4 v[148:151], v234, s[56:59], s5 offen offset:256 sc1
    ds_read_b64_tr_b16 a[122:123], v246 offset:512
    ds_read_b64_tr_b16 a[184:185], v247 offset:0
    ds_read_b64_tr_b16 a[186:187], v247 offset:512
    ds_read_b64_tr_b16 a[248:249], v248 offset:0
    ds_read_b64_tr_b16 a[250:251], v248 offset:512
    buffer_load_dwordx4 v[152:155], v234, s[60:63], s5 offen sc1
    buffer_load_dwordx4 v[156:159], v234, s[60:63], s5 offen offset:256 sc1
    buffer_load_dwordx4 v[160:163], v234, s[56:59], s6 offen sc1
    buffer_load_dwordx4 v[164:167], v234, s[56:59], s6 offen offset:256 sc1
    buffer_load_dwordx4 v[168:171], v234, s[60:63], s6 offen sc1
    buffer_load_dwordx4 v[172:175], v234, s[60:63], s6 offen offset:256 sc1
    s_waitcnt vmcnt(11)
    v_mfma_f32_16x16x32_bf16 v[0:3], a[0:3], v[128:131], 0
    v_mfma_f32_16x16x32_bf16 v[4:7], a[64:67], v[128:131], 0
    v_mfma_f32_16x16x32_bf16 v[8:11], a[128:131], v[128:131], 0
    v_mfma_f32_16x16x32_bf16 v[12:15], a[192:195], v[128:131], 0
    buffer_load_dwordx4 v[176:179], v234, s[56:59], s7 offen sc1
    s_waitcnt vmcnt(11)
    v_mfma_f32_16x16x32_bf16 v[16:19], a[0:3], v[132:135], 0
    buffer_load_dword v228, v236, s[40:43], s21 offen offset:0 sc1
    buffer_load_dword v229, v236, s[40:43], s21 offen offset:64 sc1
    v_mfma_f32_16x16x32_bf16 v[20:23], a[64:67], v[132:135], 0
    buffer_load_dword v232, v236, s[40:43], s21 offen offset:128 sc1
    buffer_load_dword v233, v236, s[40:43], s21 offen offset:192 sc1
    v_mfma_f32_16x16x32_bf16 v[24:27], a[128:131], v[132:135], 0
    v_mfma_f32_16x16x32_bf16 v[28:31], a[192:195], v[132:135], 0
    buffer_load_dwordx4 v[180:183], v234, s[56:59], s7 offen offset:256 sc1
    s_waitcnt vmcnt(15)
    v_mfma_f32_16x16x32_bf16 v[32:35], a[0:3], v[136:139], 0
    v_mfma_f32_16x16x32_bf16 v[36:39], a[64:67], v[136:139], 0
    v_mfma_f32_16x16x32_bf16 v[40:43], a[128:131], v[136:139], 0
    v_mfma_f32_16x16x32_bf16 v[44:47], a[192:195], v[136:139], 0
    buffer_load_dwordx4 v[184:187], v234, s[60:63], s7 offen sc1
    s_waitcnt vmcnt(15)
    v_mfma_f32_16x16x32_bf16 v[48:51], a[0:3], v[140:143], 0
    v_mfma_f32_16x16x32_bf16 v[52:55], a[64:67], v[140:143], 0
    v_mfma_f32_16x16x32_bf16 v[56:59], a[128:131], v[140:143], 0
    v_mfma_f32_16x16x32_bf16 v[60:63], a[192:195], v[140:143], 0
    buffer_load_dwordx4 v[188:191], v234, s[60:63], s7 offen offset:256 sc1
    s_waitcnt vmcnt(15)
    v_mfma_f32_16x16x32_bf16 v[0:3], a[4:7], v[144:147], v[0:3]
    v_mfma_f32_16x16x32_bf16 v[4:7], a[68:71], v[144:147], v[4:7]
    v_mfma_f32_16x16x32_bf16 v[8:11], a[132:135], v[144:147], v[8:11]
    v_mfma_f32_16x16x32_bf16 v[12:15], a[196:199], v[144:147], v[12:15]
    buffer_load_dwordx4 v[192:195], v234, s[56:59], s8 offen sc1
    s_waitcnt vmcnt(15)
    v_mfma_f32_16x16x32_bf16 v[16:19], a[4:7], v[148:151], v[16:19]
    v_mfma_f32_16x16x32_bf16 v[20:23], a[68:71], v[148:151], v[20:23]
    v_mfma_f32_16x16x32_bf16 v[24:27], a[132:135], v[148:151], v[24:27]
    v_mfma_f32_16x16x32_bf16 v[28:31], a[196:199], v[148:151], v[28:31]
    buffer_load_dwordx4 v[196:199], v234, s[56:59], s8 offen offset:256 sc1
    s_waitcnt vmcnt(15)
    v_mfma_f32_16x16x32_bf16 v[32:35], a[4:7], v[152:155], v[32:35]
    v_mfma_f32_16x16x32_bf16 v[36:39], a[68:71], v[152:155], v[36:39]
    v_mfma_f32_16x16x32_bf16 v[40:43], a[132:135], v[152:155], v[40:43]
    v_mfma_f32_16x16x32_bf16 v[44:47], a[196:199], v[152:155], v[44:47]
    buffer_load_dwordx4 v[200:203], v234, s[60:63], s8 offen sc1
    v_bfe_u32 v240, v255, 4, 1
    v_lshlrev_b32 v240, 5, v240
    v_xor_b32 v251, v251, v240
    s_lshl_b32 s101, s91, 13
    v_add_u32 v251, s101, v251
    s_mov_b32 s74, 0x8000
    v_add_u32 v242, s74, v234
    s_waitcnt vmcnt(15)
    v_mfma_f32_16x16x32_bf16 v[48:51], a[4:7], v[156:159], v[48:51]
    v_mfma_f32_16x16x32_bf16 v[52:55], a[68:71], v[156:159], v[52:55]
    v_mfma_f32_16x16x32_bf16 v[56:59], a[132:135], v[156:159], v[56:59]
    v_mfma_f32_16x16x32_bf16 v[60:63], a[196:199], v[156:159], v[60:63]
    buffer_load_dwordx4 v[204:207], v234, s[60:63], s8 offen offset:256 sc1
    s_waitcnt vmcnt(15)
    v_mfma_f32_16x16x32_bf16 v[0:3], a[8:11], v[160:163], v[0:3]
    v_mfma_f32_16x16x32_bf16 v[4:7], a[72:75], v[160:163], v[4:7]
    v_mfma_f32_16x16x32_bf16 v[8:11], a[136:139], v[160:163], v[8:11]
    v_mfma_f32_16x16x32_bf16 v[12:15], a[200:203], v[160:163], v[12:15]
    buffer_load_dword v239, v235, s[40:43], s19 offen sc1
    buffer_load_dwordx4 v[208:211], v234, s[56:59], s9 offen sc1
    s_waitcnt vmcnt(16)
    v_mfma_f32_16x16x32_bf16 v[16:19], a[8:11], v[164:167], v[16:19]
    v_mfma_f32_16x16x32_bf16 v[20:23], a[72:75], v[164:167], v[20:23]
    v_mfma_f32_16x16x32_bf16 v[24:27], a[136:139], v[164:167], v[24:27]
    v_mfma_f32_16x16x32_bf16 v[28:31], a[200:203], v[164:167], v[28:31]
    buffer_load_dwordx4 v[212:215], v234, s[56:59], s9 offen offset:256 sc1
    s_waitcnt vmcnt(16)
    v_mfma_f32_16x16x32_bf16 v[32:35], a[8:11], v[168:171], v[32:35]
    v_mfma_f32_16x16x32_bf16 v[36:39], a[72:75], v[168:171], v[36:39]
    v_mfma_f32_16x16x32_bf16 v[40:43], a[136:139], v[168:171], v[40:43]
    v_mfma_f32_16x16x32_bf16 v[44:47], a[200:203], v[168:171], v[44:47]
    buffer_load_dwordx4 v[216:219], v234, s[60:63], s9 offen sc1
    s_waitcnt vmcnt(16)
    v_mfma_f32_16x16x32_bf16 v[48:51], a[8:11], v[172:175], v[48:51]
    v_mfma_f32_16x16x32_bf16 v[52:55], a[72:75], v[172:175], v[52:55]
    v_mfma_f32_16x16x32_bf16 v[56:59], a[136:139], v[172:175], v[56:59]
    v_mfma_f32_16x16x32_bf16 v[60:63], a[200:203], v[172:175], v[60:63]
    buffer_load_dwordx4 v[220:223], v234, s[60:63], s9 offen offset:256 sc1
    s_waitcnt vmcnt(16)
    v_mfma_f32_16x16x32_bf16 v[0:3], a[12:15], v[176:179], v[0:3]
    v_mfma_f32_16x16x32_bf16 v[4:7], a[76:79], v[176:179], v[4:7]
    v_mfma_f32_16x16x32_bf16 v[8:11], a[140:143], v[176:179], v[8:11]
    v_mfma_f32_16x16x32_bf16 v[12:15], a[204:207], v[176:179], v[12:15]
    buffer_load_dwordx4 v[128:131], v234, s[56:59], s10 offen sc1
    s_waitcnt vmcnt(12)
    v_mfma_f32_16x16x32_bf16 v[16:19], a[12:15], v[180:183], v[16:19]
    v_mfma_f32_16x16x32_bf16 v[20:23], a[76:79], v[180:183], v[20:23]
    v_mfma_f32_16x16x32_bf16 v[24:27], a[140:143], v[180:183], v[24:27]
    v_mfma_f32_16x16x32_bf16 v[28:31], a[204:207], v[180:183], v[28:31]
    buffer_load_dwordx4 v[132:135], v234, s[56:59], s10 offen offset:256 sc1
    s_waitcnt vmcnt(12)
    v_mfma_f32_16x16x32_bf16 v[32:35], a[12:15], v[184:187], v[32:35]
    v_mfma_f32_16x16x32_bf16 v[36:39], a[76:79], v[184:187], v[36:39]
    v_mfma_f32_16x16x32_bf16 v[40:43], a[140:143], v[184:187], v[40:43]
    v_mfma_f32_16x16x32_bf16 v[44:47], a[204:207], v[184:187], v[44:47]
    buffer_load_dwordx4 v[136:139], v234, s[60:63], s10 offen sc1
    s_waitcnt vmcnt(12)
    v_mfma_f32_16x16x32_bf16 v[48:51], a[12:15], v[188:191], v[48:51]
    v_mfma_f32_16x16x32_bf16 v[52:55], a[76:79], v[188:191], v[52:55]
    v_mfma_f32_16x16x32_bf16 v[56:59], a[140:143], v[188:191], v[56:59]
    v_mfma_f32_16x16x32_bf16 v[60:63], a[204:207], v[188:191], v[60:63]
    buffer_load_dwordx4 v[140:143], v234, s[60:63], s10 offen offset:256 sc1
    s_waitcnt vmcnt(12) lgkmcnt(0)
    v_mfma_f32_16x16x32_bf16 v[0:3], a[16:19], v[192:195], v[0:3]
    v_mfma_f32_16x16x32_bf16 v[4:7], a[80:83], v[192:195], v[4:7]
    v_mfma_f32_16x16x32_bf16 v[8:11], a[144:147], v[192:195], v[8:11]
    v_mfma_f32_16x16x32_bf16 v[12:15], a[208:211], v[192:195], v[12:15]
    s_waitcnt vmcnt(8)
    v_cmp_ne_u32 vcc, v243, v239
    s_mov_b32 s101, 65536
    s_nop 3
    s_cbranch_vccz L_ok16
L_spin16:
    buffer_load_dword v239, v235, s[40:43], s19 offen sc1
    s_sub_u32 s101, s101, 1
    s_cmp_eq_u32 s101, 0
    s_cbranch_scc1 L_ok16
    s_waitcnt vmcnt(0)
    v_cmp_ne_u32 vcc, v243, v239
    s_nop 4
    s_cbranch_vccnz L_spin16
L_ok16:
    buffer_load_dwordx4 v[144:147], v234, s[56:59], s11 offen sc1
    v_mfma_f32_16x16x32_bf16 v[16:19], a[16:19], v[196:199], v[16:19]
    v_mfma_f32_16x16x32_bf16 v[20:23], a[80:83], v[196:199], v[20:23]
    v_mfma_f32_16x16x32_bf16 v[24:27], a[144:147], v[196:199], v[24:27]
L_pad_kv_3:
    s_cbranch_execz L_walked_kv
    v_mfma_f32_16x16x32_bf16 v[28:31], a[208:211], v[196:199], v[28:31]
    buffer_load_dwordx4 v[148:151], v234, s[56:59], s11 offen offset:256 sc1
    v_mfma_f32_16x16x32_bf16 v[32:35], a[16:19], v[200:203], v[32:35]
    v_mfma_f32_16x16x32_bf16 v[36:39], a[80:83], v[200:203], v[36:39]
    v_mfma_f32_16x16x32_bf16 v[40:43], a[144:147], v[200:203], v[40:43]
    v_mfma_f32_16x16x32_bf16 v[44:47], a[208:211], v[200:203], v[44:47]
    buffer_load_dwordx4 v[152:155], v234, s[60:63], s11 offen sc1
    v_mfma_f32_16x16x32_bf16 v[48:51], a[16:19], v[204:207], v[48:51]
    v_mfma_f32_16x16x32_bf16 v[52:55], a[80:83], v[204:207], v[52:55]
    v_mfma_f32_16x16x32_bf16 v[56:59], a[144:147], v[204:207], v[56:59]
    v_mfma_f32_16x16x32_bf16 v[60:63], a[208:211], v[204:207], v[60:63]
    buffer_load_dwordx4 v[156:159], v234, s[60:63], s11 offen offset:256 sc1
    s_waitcnt vmcnt(11)
    v_mfma_f32_16x16x32_bf16 v[0:3], a[20:23], v[208:211], v[0:3]
    v_mfma_f32_16x16x32_bf16 v[4:7], a[84:87], v[208:211], v[4:7]
    v_mfma_f32_16x16x32_bf16 v[8:11], a[148:151], v[208:211], v[8:11]
    v_mfma_f32_16x16x32_bf16 v[12:15], a[212:215], v[208:211], v[12:15]
    buffer_load_dwordx4 v[160:163], v234, s[56:59], s12 offen sc1
    s_waitcnt vmcnt(11)
    v_mfma_f32_16x16x32_bf16 v[16:19], a[20:23], v[212:215], v[16:19]
    v_mfma_f32_16x16x32_bf16 v[20:23], a[84:87], v[212:215], v[20:23]
    v_mfma_f32_16x16x32_bf16 v[24:27], a[148:151], v[212:215], v[24:27]
    v_mfma_f32_16x16x32_bf16 v[28:31], a[212:215], v[212:215], v[28:31]
    buffer_load_dwordx4 v[164:167], v234, s[56:59], s12 offen offset:256 sc1
    s_waitcnt vmcnt(11)
    v_mfma_f32_16x16x32_bf16 v[32:35], a[20:23], v[216:219], v[32:35]
    v_mfma_f32_16x16x32_bf16 v[36:39], a[84:87], v[216:219], v[36:39]
    v_mfma_f32_16x16x32_bf16 v[40:43], a[148:151], v[216:219], v[40:43]
    v_mfma_f32_16x16x32_bf16 v[44:47], a[212:215], v[216:219], v[44:47]
    buffer_load_dwordx4 v[168:171], v234, s[60:63], s12 offen sc1
    s_waitcnt vmcnt(11)
    v_mfma_f32_16x16x32_bf16 v[48:51], a[20:23], v[220:223], v[48:51]
    v_mfma_f32_16x16x32_bf16 v[52:55], a[84:87], v[220:223], v[52:55]
    v_mfma_f32_16x16x32_bf16 v[56:59], a[148:151], v[220:223], v[56:59]
    v_mfma_f32_16x16x32_bf16 v[60:63], a[212:215], v[220:223], v[60:63]
    buffer_load_dwordx4 v[172:175], v234, s[60:63], s12 offen offset:256 sc1
    s_waitcnt vmcnt(11)
    v_mfma_f32_16x16x32_bf16 v[0:3], a[24:27], v[128:131], v[0:3]
    v_mfma_f32_16x16x32_bf16 v[4:7], a[88:91], v[128:131], v[4:7]
    v_mfma_f32_16x16x32_bf16 v[8:11], a[152:155], v[128:131], v[8:11]
    v_mfma_f32_16x16x32_bf16 v[12:15], a[216:219], v[128:131], v[12:15]
    buffer_load_dword v239, v235, s[40:43], s20 offen sc1
    buffer_load_dwordx4 v[176:179], v234, s[56:59], s13 offen sc1
    s_waitcnt vmcnt(12)
    v_mfma_f32_16x16x32_bf16 v[16:19], a[24:27], v[132:135], v[16:19]
    v_mfma_f32_16x16x32_bf16 v[20:23], a[88:91], v[132:135], v[20:23]
    v_mfma_f32_16x16x32_bf16 v[24:27], a[152:155], v[132:135], v[24:27]
    v_mfma_f32_16x16x32_bf16 v[28:31], a[216:219], v[132:135], v[28:31]
    buffer_load_dwordx4 v[180:183], v234, s[56:59], s13 offen offset:256 sc1
    s_waitcnt vmcnt(12)
    v_mfma_f32_16x16x32_bf16 v[32:35], a[24:27], v[136:139], v[32:35]
    v_mfma_f32_16x16x32_bf16 v[36:39], a[88:91], v[136:139], v[36:39]
    v_mfma_f32_16x16x32_bf16 v[40:43], a[152:155], v[136:139], v[40:43]
    v_mfma_f32_16x16x32_bf16 v[44:47], a[216:219], v[136:139], v[44:47]
    buffer_load_dwordx4 v[184:187], v234, s[60:63], s13 offen sc1
    s_waitcnt vmcnt(12)
    v_mfma_f32_16x16x32_bf16 v[48:51], a[24:27], v[140:143], v[48:51]
    v_mfma_f32_16x16x32_bf16 v[52:55], a[88:91], v[140:143], v[52:55]
    v_mfma_f32_16x16x32_bf16 v[56:59], a[152:155], v[140:143], v[56:59]
    v_mfma_f32_16x16x32_bf16 v[60:63], a[216:219], v[140:143], v[60:63]
    buffer_load_dwordx4 v[188:191], v234, s[60:63], s13 offen offset:256 sc1
    s_waitcnt vmcnt(12)
    v_mfma_f32_16x16x32_bf16 v[0:3], a[28:31], v[144:147], v[0:3]
    v_mfma_f32_16x16x32_bf16 v[4:7], a[92:95], v[144:147], v[4:7]
    v_mfma_f32_16x16x32_bf16 v[8:11], a[156:159], v[144:147], v[8:11]
    v_mfma_f32_16x16x32_bf16 v[12:15], a[220:223], v[144:147], v[12:15]
    buffer_load_dwordx4 v[192:195], v234, s[56:59], s14 offen sc1
    s_waitcnt vmcnt(12)
    v_mfma_f32_16x16x32_bf16 v[16:19], a[28:31], v[148:151], v[16:19]
    v_mfma_f32_16x16x32_bf16 v[20:23], a[92:95], v[148:151], v[20:23]
    v_mfma_f32_16x16x32_bf16 v[24:27], a[156:159], v[148:151], v[24:27]
    v_mfma_f32_16x16x32_bf16 v[28:31], a[220:223], v[148:151], v[28:31]
    buffer_load_dwordx4 v[196:199], v234, s[56:59], s14 offen offset:256 sc1
    s_waitcnt vmcnt(12)
    v_mfma_f32_16x16x32_bf16 v[32:35], a[28:31], v[152:155], v[32:35]
    v_mfma_f32_16x16x32_bf16 v[36:39], a[92:95], v[152:155], v[36:39]
    v_mfma_f32_16x16x32_bf16 v[40:43], a[156:159], v[152:155], v[40:43]
    v_mfma_f32_16x16x32_bf16 v[44:47], a[220:223], v[152:155], v[44:47]
    buffer_load_dwordx4 v[200:203], v234, s[60:63], s14 offen sc1
    v_sub_f32 v230, 1.0, v228
    v_sub_f32 v231, 1.0, v229
    v_sub_f32 v249, 1.0, v232
    v_sub_f32 v250, 1.0, v233
    s_waitcnt vmcnt(12)
    v_mfma_f32_16x16x32_bf16 v[48:51], a[28:31], v[156:159], v[48:51]
    v_mfma_f32_16x16x32_bf16 v[52:55], a[92:95], v[156:159], v[52:55]
    v_mfma_f32_16x16x32_bf16 v[56:59], a[156:159], v[156:159], v[56:59]
    v_mfma_f32_16x16x32_bf16 v[60:63], a[220:223], v[156:159], v[60:63]
    buffer_load_dwordx4 v[204:207], v234, s[60:63], s14 offen offset:256 sc1
    s_waitcnt vmcnt(12)
    v_mfma_f32_16x16x32_bf16 v[0:3], a[32:35], v[160:163], v[0:3]
    v_mfma_f32_16x16x32_bf16 v[4:7], a[96:99], v[160:163], v[4:7]
    v_mfma_f32_16x16x32_bf16 v[8:11], a[160:163], v[160:163], v[8:11]
    v_mfma_f32_16x16x32_bf16 v[12:15], a[224:227], v[160:163], v[12:15]
    s_waitcnt vmcnt(8)
    v_cmp_ne_u32 vcc, v243, v239
    s_mov_b32 s101, 65536
    s_nop 3
    s_cbranch_vccz L_ok17
L_spin17:
    buffer_load_dword v239, v235, s[40:43], s20 offen sc1
    s_sub_u32 s101, s101, 1
    s_cmp_eq_u32 s101, 0
    s_cbranch_scc1 L_ok17
    s_waitcnt vmcnt(0)
    v_cmp_ne_u32 vcc, v243, v239
    s_nop 4
    s_cbranch_vccnz L_spin17
L_ok17:
    buffer_load_dwordx4 v[208:211], v234, s[40:43], s15 offen sc1
    v_mfma_f32_16x16x32_bf16 v[16:19], a[32:35], v[164:167], v[16:19]
    v_mfma_f32_16x16x32_bf16 v[20:23], a[96:99], v[164:167], v[20:23]
    v_mfma_f32_16x16x32_bf16 v[24:27], a[160:163], v[164:167], v[24:27]
    v_mfma_f32_16x16x32_bf16 v[28:31], a[224:227], v[164:167], v[28:31]
    buffer_load_dwordx4 v[212:215], v234, s[40:43], s15 offen offset:256 sc1
    v_mfma_f32_16x16x32_bf16 v[32:35], a[32:35], v[168:171], v[32:35]
    v_mfma_f32_16x16x32_bf16 v[36:39], a[96:99], v[168:171], v[36:39]
    v_mfma_f32_16x16x32_bf16 v[40:43], a[160:163], v[168:171], v[40:43]
    v_mfma_f32_16x16x32_bf16 v[44:47], a[224:227], v[168:171], v[44:47]
    buffer_load_dwordx4 v[216:219], v234, s[40:43], s16 offen sc1
    v_and_b32 v241, 15, v255
    v_lshl_add_u32 v240, v241, 8, s97
    v_lshrrev_b32 v247, 4, v255
    v_and_b32 v248, 7, v255
    v_xor_b32 v246, v247, v248
    v_lshlrev_b32 v245, 4, v246
    v_add_u32 v226, v240, v245
    v_xor_b32 v227, 64, v226
    v_mfma_f32_16x16x32_bf16 v[48:51], a[32:35], v[172:175], v[48:51]
    v_mfma_f32_16x16x32_bf16 v[52:55], a[96:99], v[172:175], v[52:55]
    v_mfma_f32_16x16x32_bf16 v[56:59], a[160:163], v[172:175], v[56:59]
    v_mfma_f32_16x16x32_bf16 v[60:63], a[224:227], v[172:175], v[60:63]
    buffer_load_dwordx4 v[220:223], v234, s[40:43], s16 offen offset:256 sc1
    s_waitcnt vmcnt(11)
    v_mfma_f32_16x16x32_bf16 v[0:3], a[36:39], v[176:179], v[0:3]
    v_mfma_f32_16x16x32_bf16 v[4:7], a[100:103], v[176:179], v[4:7]
    v_mfma_f32_16x16x32_bf16 v[8:11], a[164:167], v[176:179], v[8:11]
    v_mfma_f32_16x16x32_bf16 v[12:15], a[228:231], v[176:179], v[12:15]
    buffer_load_dwordx4 v[128:131], v234, s[40:43], s17 offen sc1
    s_waitcnt vmcnt(11)
    v_mfma_f32_16x16x32_bf16 v[16:19], a[36:39], v[180:183], v[16:19]
    v_mfma_f32_16x16x32_bf16 v[20:23], a[100:103], v[180:183], v[20:23]
    v_mfma_f32_16x16x32_bf16 v[24:27], a[164:167], v[180:183], v[24:27]
    v_mfma_f32_16x16x32_bf16 v[28:31], a[228:231], v[180:183], v[28:31]
    buffer_load_dwordx4 v[132:135], v234, s[40:43], s17 offen offset:256 sc1
    s_waitcnt vmcnt(11)
    v_mfma_f32_16x16x32_bf16 v[32:35], a[36:39], v[184:187], v[32:35]
    v_mfma_f32_16x16x32_bf16 v[36:39], a[100:103], v[184:187], v[36:39]
    v_mfma_f32_16x16x32_bf16 v[40:43], a[164:167], v[184:187], v[40:43]
    v_mfma_f32_16x16x32_bf16 v[44:47], a[228:231], v[184:187], v[44:47]
    buffer_load_dwordx4 v[136:139], v234, s[40:43], s18 offen sc1
    s_waitcnt vmcnt(11)
    v_mfma_f32_16x16x32_bf16 v[48:51], a[36:39], v[188:191], v[48:51]
    v_mfma_f32_16x16x32_bf16 v[52:55], a[100:103], v[188:191], v[52:55]
    v_mfma_f32_16x16x32_bf16 v[56:59], a[164:167], v[188:191], v[56:59]
    v_mfma_f32_16x16x32_bf16 v[60:63], a[228:231], v[188:191], v[60:63]
    buffer_load_dwordx4 v[140:143], v234, s[40:43], s18 offen offset:256 sc1
    s_waitcnt vmcnt(11)
    v_mfma_f32_16x16x32_bf16 v[0:3], a[40:43], v[192:195], v[0:3]
    v_mfma_f32_16x16x32_bf16 v[4:7], a[104:107], v[192:195], v[4:7]
    v_mfma_f32_16x16x32_bf16 v[8:11], a[168:171], v[192:195], v[8:11]
    v_mfma_f32_16x16x32_bf16 v[12:15], a[232:235], v[192:195], v[12:15]
    buffer_load_dwordx4 v[144:147], v242, s[40:43], s15 offen sc1
    s_waitcnt vmcnt(11)
    v_mfma_f32_16x16x32_bf16 v[16:19], a[40:43], v[196:199], v[16:19]
    v_mfma_f32_16x16x32_bf16 v[20:23], a[104:107], v[196:199], v[20:23]
    s_nop 0
    v_mul_f32 v0, v0, v230
    v_mul_f32 v1, v1, v230
    v_mfma_f32_16x16x32_bf16 v[24:27], a[168:171], v[196:199], v[24:27]
    v_mul_f32 v2, v2, v230
    v_mul_f32 v3, v3, v230
    v_mfma_f32_16x16x32_bf16 v[28:31], a[232:235], v[196:199], v[28:31]
    buffer_load_dwordx4 v[148:151], v242, s[40:43], s15 offen offset:256 sc1
    s_waitcnt vmcnt(11)
    v_mfma_f32_16x16x32_bf16 v[32:35], a[40:43], v[200:203], v[32:35]
    v_mul_f32 v4, v4, v230
    v_mul_f32 v5, v5, v230
    v_mfma_f32_16x16x32_bf16 v[36:39], a[104:107], v[200:203], v[36:39]
    v_mul_f32 v6, v6, v230
    v_mul_f32 v7, v7, v230
    v_mfma_f32_16x16x32_bf16 v[40:43], a[168:171], v[200:203], v[40:43]
    v_mul_f32 v8, v8, v230
    v_mul_f32 v9, v9, v230
    v_mfma_f32_16x16x32_bf16 v[44:47], a[232:235], v[200:203], v[44:47]
    buffer_load_dwordx4 v[152:155], v242, s[40:43], s16 offen sc1
    s_waitcnt vmcnt(11)
    v_mfma_f32_16x16x32_bf16 v[48:51], a[40:43], v[204:207], v[48:51]
    v_mul_f32 v10, v10, v230
    v_mul_f32 v11, v11, v230
    v_mfma_f32_16x16x32_bf16 v[52:55], a[104:107], v[204:207], v[52:55]
    v_mul_f32 v12, v12, v230
    v_mul_f32 v13, v13, v230
    v_mfma_f32_16x16x32_bf16 v[56:59], a[168:171], v[204:207], v[56:59]
    v_mul_f32 v14, v14, v230
    v_mul_f32 v15, v15, v230
    v_mfma_f32_16x16x32_bf16 v[60:63], a[232:235], v[204:207], v[60:63]
    buffer_load_dwordx4 v[156:159], v242, s[40:43], s16 offen offset:256 sc1
    s_waitcnt vmcnt(11)
    v_mfma_f32_16x16x32_bf16 v[64:67], a[44:47], v[208:211], 0
    v_mul_f32 v16, v16, v231
    v_mul_f32 v17, v17, v231
    v_mfma_f32_16x16x32_bf16 v[68:71], a[108:111], v[208:211], 0
    buffer_load_dwordx4 v[160:163], v242, s[40:43], s17 offen sc1
    v_mul_f32 v18, v18, v231
    v_mul_f32 v19, v19, v231
    s_waitcnt vmcnt(11)
    v_mfma_f32_16x16x32_bf16 v[80:83], a[44:47], v[212:215], 0
    v_mul_f32 v20, v20, v231
    v_mul_f32 v21, v21, v231
    v_mfma_f32_16x16x32_bf16 v[84:87], a[108:111], v[212:215], 0
    buffer_load_dwordx4 v[164:167], v242, s[40:43], s17 offen offset:256 sc1
    v_mul_f32 v22, v22, v231
    v_mul_f32 v23, v23, v231
    s_waitcnt vmcnt(11)
    v_mfma_f32_16x16x32_bf16 v[64:67], a[48:51], v[216:219], v[64:67]
    v_mul_f32 v24, v24, v231
    v_mul_f32 v25, v25, v231
    v_mfma_f32_16x16x32_bf16 v[68:71], a[112:115], v[216:219], v[68:71]
    buffer_load_dwordx4 v[168:171], v242, s[40:43], s18 offen sc1
    v_mul_f32 v26, v26, v231
    v_mul_f32 v27, v27, v231
    s_waitcnt vmcnt(11)
    v_mfma_f32_16x16x32_bf16 v[80:83], a[48:51], v[220:223], v[80:83]
    v_mul_f32 v28, v28, v231
    v_mul_f32 v29, v29, v231
    v_mfma_f32_16x16x32_bf16 v[84:87], a[112:115], v[220:223], v[84:87]
    buffer_load_dwordx4 v[172:175], v242, s[40:43], s18 offen offset:256 sc1
    v_mul_f32 v30, v30, v231
    v_mul_f32 v31, v31, v231
    s_waitcnt vmcnt(11)
    v_mfma_f32_16x16x32_bf16 v[64:67], a[52:55], v[128:131], v[64:67]
    v_mul_f32 v32, v32, v249
    v_mul_f32 v33, v33, v249
    v_mfma_f32_16x16x32_bf16 v[68:71], a[116:119], v[128:131], v[68:71]
    v_mul_f32 v34, v34, v249
    v_mul_f32 v35, v35, v249
    s_waitcnt vmcnt(10)
    v_mfma_f32_16x16x32_bf16 v[80:83], a[52:55], v[132:135], v[80:83]
    v_mul_f32 v36, v36, v249
    v_mul_f32 v37, v37, v249
    v_mfma_f32_16x16x32_bf16 v[84:87], a[116:119], v[132:135], v[84:87]
    v_mul_f32 v38, v38, v249
    v_mul_f32 v39, v39, v249
    s_waitcnt vmcnt(9)
    v_mfma_f32_16x16x32_bf16 v[64:67], a[56:59], v[136:139], v[64:67]
    v_mul_f32 v40, v40, v249
    v_mul_f32 v41, v41, v249
    v_mfma_f32_16x16x32_bf16 v[68:71], a[120:123], v[136:139], v[68:71]
    v_mul_f32 v42, v42, v249
    v_mul_f32 v43, v43, v249
    s_waitcnt vmcnt(8)
    v_mfma_f32_16x16x32_bf16 v[80:83], a[56:59], v[140:143], v[80:83]
    v_mul_f32 v44, v44, v249
    v_mul_f32 v45, v45, v249
    v_mfma_f32_16x16x32_bf16 v[84:87], a[120:123], v[140:143], v[84:87]
    v_mfma_f32_16x16x32_bf16 v[72:75], a[172:175], v[208:211], 0
    v_mul_f32 v46, v46, v249
    v_mul_f32 v47, v47, v249
    v_mfma_f32_16x16x32_bf16 v[76:79], a[236:239], v[208:211], 0
    v_mul_f32 v48, v48, v250
    v_mul_f32 v49, v49, v250
    v_mfma_f32_16x16x32_bf16 v[88:91], a[172:175], v[212:215], 0
    v_mul_f32 v50, v50, v250
    v_mul_f32 v51, v51, v250
    v_mfma_f32_16x16x32_bf16 v[92:95], a[236:239], v[212:215], 0
    v_fmac_f32 v0, v64, v228
    v_fmac_f32 v1, v65, v228
    v_mfma_f32_16x16x32_bf16 v[72:75], a[176:179], v[216:219], v[72:75]
    v_fmac_f32 v2, v66, v228
    v_fmac_f32 v3, v67, v228
    v_mfma_f32_16x16x32_bf16 v[76:79], a[240:243], v[216:219], v[76:79]
    ds_write_b128 v226, v[0:3] offset:0
    v_fmac_f32 v4, v68, v228
    v_mfma_f32_16x16x32_bf16 v[88:91], a[176:179], v[220:223], v[88:91]
    v_fmac_f32 v5, v69, v228
    v_fmac_f32 v6, v70, v228
    v_mfma_f32_16x16x32_bf16 v[92:95], a[240:243], v[220:223], v[92:95]
    v_fmac_f32 v7, v71, v228
    ds_write_b128 v227, v[4:7] offset:0
    v_mfma_f32_16x16x32_bf16 v[72:75], a[180:183], v[128:131], v[72:75]
    v_fmac_f32 v16, v80, v229
    v_fmac_f32 v17, v81, v229
    v_mfma_f32_16x16x32_bf16 v[76:79], a[244:247], v[128:131], v[76:79]
    v_fmac_f32 v18, v82, v229
    v_fmac_f32 v19, v83, v229
    v_mfma_f32_16x16x32_bf16 v[88:91], a[180:183], v[132:135], v[88:91]
    ds_write_b128 v226, v[16:19] offset:16384
    v_fmac_f32 v20, v84, v229
    v_mfma_f32_16x16x32_bf16 v[92:95], a[244:247], v[132:135], v[92:95]
    v_fmac_f32 v21, v85, v229
    v_fmac_f32 v22, v86, v229
    v_mfma_f32_16x16x32_bf16 v[72:75], a[184:187], v[136:139], v[72:75]
    v_fmac_f32 v23, v87, v229
    ds_write_b128 v227, v[20:23] offset:16384
    v_mfma_f32_16x16x32_bf16 v[76:79], a[248:251], v[136:139], v[76:79]
    v_mul_f32 v52, v52, v250
    v_mul_f32 v53, v53, v250
    v_mfma_f32_16x16x32_bf16 v[88:91], a[184:187], v[140:143], v[88:91]
    v_mul_f32 v54, v54, v250
    v_mul_f32 v55, v55, v250
    v_mfma_f32_16x16x32_bf16 v[92:95], a[248:251], v[140:143], v[92:95]
    s_waitcnt vmcnt(7)
    v_mfma_f32_16x16x32_bf16 v[96:99], a[44:47], v[144:147], 0
    v_mul_f32 v56, v56, v250
    v_mul_f32 v57, v57, v250
    v_mfma_f32_16x16x32_bf16 v[100:103], a[108:111], v[144:147], 0
    v_mul_f32 v58, v58, v250
    v_mul_f32 v59, v59, v250
    s_waitcnt vmcnt(6)
    v_mfma_f32_16x16x32_bf16 v[112:115], a[44:47], v[148:151], 0
    v_mul_f32 v60, v60, v250
    v_mul_f32 v61, v61, v250
    v_mfma_f32_16x16x32_bf16 v[116:119], a[108:111], v[148:151], 0
    v_mul_f32 v62, v62, v250
    v_mul_f32 v63, v63, v250
    s_waitcnt vmcnt(5)
    v_mfma_f32_16x16x32_bf16 v[96:99], a[48:51], v[152:155], v[96:99]
    v_fmac_f32 v8, v72, v228
    v_fmac_f32 v9, v73, v228
    v_mfma_f32_16x16x32_bf16 v[100:103], a[112:115], v[152:155], v[100:103]
    v_fmac_f32 v10, v74, v228
    v_fmac_f32 v11, v75, v228
    s_waitcnt vmcnt(4)
    v_mfma_f32_16x16x32_bf16 v[112:115], a[48:51], v[156:159], v[112:115]
    ds_write_b128 v226, v[8:11] offset:128
    v_fmac_f32 v12, v76, v228
    v_mfma_f32_16x16x32_bf16 v[116:119], a[112:115], v[156:159], v[116:119]
    v_fmac_f32 v13, v77, v228
    v_fmac_f32 v14, v78, v228
    s_waitcnt vmcnt(3)
    v_mfma_f32_16x16x32_bf16 v[96:99], a[52:55], v[160:163], v[96:99]
    v_fmac_f32 v15, v79, v228
    ds_write_b128 v227, v[12:15] offset:128
    v_mfma_f32_16x16x32_bf16 v[100:103], a[116:119], v[160:163], v[100:103]
    v_fmac_f32 v24, v88, v229
    v_fmac_f32 v25, v89, v229
    s_waitcnt vmcnt(2)
    v_mfma_f32_16x16x32_bf16 v[112:115], a[52:55], v[164:167], v[112:115]
    v_fmac_f32 v26, v90, v229
    v_fmac_f32 v27, v91, v229
    v_mfma_f32_16x16x32_bf16 v[116:119], a[116:119], v[164:167], v[116:119]
    ds_write_b128 v226, v[24:27] offset:16512
    v_fmac_f32 v28, v92, v229
    s_waitcnt vmcnt(1)
    v_mfma_f32_16x16x32_bf16 v[96:99], a[56:59], v[168:171], v[96:99]
    v_fmac_f32 v29, v93, v229
    v_fmac_f32 v30, v94, v229
    v_mfma_f32_16x16x32_bf16 v[100:103], a[120:123], v[168:171], v[100:103]
    v_fmac_f32 v31, v95, v229
    ds_write_b128 v227, v[28:31] offset:16512
    s_waitcnt vmcnt(0)
    v_mfma_f32_16x16x32_bf16 v[112:115], a[56:59], v[172:175], v[112:115]
    v_mfma_f32_16x16x32_bf16 v[116:119], a[120:123], v[172:175], v[116:119]
    v_mfma_f32_16x16x32_bf16 v[104:107], a[172:175], v[144:147], 0
    s_waitcnt lgkmcnt(0)
    s_barrier
    v_mfma_f32_16x16x32_bf16 v[108:111], a[236:239], v[144:147], 0
    ds_read_b128 v[176:179], v224 offset:0
    ds_read_b128 v[180:183], v225 offset:0
    v_mfma_f32_16x16x32_bf16 v[120:123], a[172:175], v[148:151], 0
    v_fmac_f32 v32, v96, v232
    v_fmac_f32 v33, v97, v232
    v_mfma_f32_16x16x32_bf16 v[124:127], a[236:239], v[148:151], 0
    v_fmac_f32 v34, v98, v232
    v_fmac_f32 v35, v99, v232
    v_mfma_f32_16x16x32_bf16 v[104:107], a[176:179], v[152:155], v[104:107]
    ds_write_b128 v226, v[32:35] offset:32768
    v_fmac_f32 v36, v100, v232
    v_mfma_f32_16x16x32_bf16 v[108:111], a[240:243], v[152:155], v[108:111]
    v_fmac_f32 v37, v101, v232
    v_fmac_f32 v38, v102, v232
    v_mfma_f32_16x16x32_bf16 v[120:123], a[176:179], v[156:159], v[120:123]
    v_fmac_f32 v39, v103, v232
    ds_write_b128 v227, v[36:39] offset:32768
    v_mfma_f32_16x16x32_bf16 v[124:127], a[240:243], v[156:159], v[124:127]
    ds_read_b128 v[184:187], v224 offset:4096
    ds_read_b128 v[188:191], v225 offset:4096
    v_mfma_f32_16x16x32_bf16 v[104:107], a[180:183], v[160:163], v[104:107]
    ds_read_b128 v[192:195], v224 offset:8192
    ds_read_b128 v[196:199], v225 offset:8192
    v_mfma_f32_16x16x32_bf16 v[108:111], a[244:247], v[160:163], v[108:111]
    ds_read_b128 v[200:203], v224 offset:12288
    ds_read_b128 v[204:207], v225 offset:12288
    v_mfma_f32_16x16x32_bf16 v[120:123], a[180:183], v[164:167], v[120:123]
    v_fmac_f32 v48, v112, v233
    v_fmac_f32 v49, v113, v233
    v_mfma_f32_16x16x32_bf16 v[124:127], a[244:247], v[164:167], v[124:127]
    v_fmac_f32 v50, v114, v233
    v_fmac_f32 v51, v115, v233
    v_mfma_f32_16x16x32_bf16 v[104:107], a[184:187], v[168:171], v[104:107]
    ds_write_b128 v226, v[48:51] offset:49152
    v_fmac_f32 v52, v116, v233
    v_mfma_f32_16x16x32_bf16 v[108:111], a[248:251], v[168:171], v[108:111]
    v_fmac_f32 v53, v117, v233
    v_fmac_f32 v54, v118, v233
    v_mfma_f32_16x16x32_bf16 v[120:123], a[184:187], v[172:175], v[120:123]
    v_fmac_f32 v55, v119, v233
    ds_write_b128 v227, v[52:55] offset:49152
    v_mfma_f32_16x16x32_bf16 v[124:127], a[248:251], v[172:175], v[124:127]
    s_waitcnt lgkmcnt(7)
    v_pk_add_f32 v[176:177], v[176:177], v[184:185]
    v_pk_add_f32 v[178:179], v[178:179], v[186:187]
    s_waitcnt lgkmcnt(6)
    v_pk_add_f32 v[180:181], v[180:181], v[188:189]
    v_pk_add_f32 v[182:183], v[182:183], v[190:191]
    s_waitcnt lgkmcnt(3)
    v_pk_add_f32 v[192:193], v[192:193], v[200:201]
    v_pk_add_f32 v[194:195], v[194:195], v[202:203]
    s_waitcnt lgkmcnt(2)
    v_pk_add_f32 v[196:197], v[196:197], v[204:205]
    v_pk_add_f32 v[198:199], v[198:199], v[206:207]
    v_pk_add_f32 v[176:177], v[176:177], v[192:193]
    v_pk_add_f32 v[178:179], v[178:179], v[194:195]
    v_pk_add_f32 v[180:181], v[180:181], v[196:197]
    v_pk_add_f32 v[182:183], v[182:183], v[198:199]
    v_cvt_pk_bf16_f32 v184, v176, v177
    v_cvt_pk_bf16_f32 v185, v178, v179
    v_cvt_pk_bf16_f32 v186, v180, v181
    v_cvt_pk_bf16_f32 v187, v182, v183
    buffer_store_dwordx4 v[184:187], v251, s[64:67], 0 offen sc1
    v_pk_fma_f32 v[40:41], v[104:105], v[232:233], v[40:41] op_sel:[0,0,0] op_sel_hi:[1,0,1]
    v_pk_fma_f32 v[42:43], v[106:107], v[232:233], v[42:43] op_sel:[0,0,0] op_sel_hi:[1,0,1]
    ds_write_b128 v226, v[40:43] offset:32896
    v_pk_fma_f32 v[44:45], v[108:109], v[232:233], v[44:45] op_sel:[0,0,0] op_sel_hi:[1,0,1]
    v_pk_fma_f32 v[46:47], v[110:111], v[232:233], v[46:47] op_sel:[0,0,0] op_sel_hi:[1,0,1]
    ds_write_b128 v227, v[44:47] offset:32896
    v_pk_fma_f32 v[56:57], v[120:121], v[232:233], v[56:57] op_sel:[0,1,0] op_sel_hi:[1,1,1]
    v_pk_fma_f32 v[58:59], v[122:123], v[232:233], v[58:59] op_sel:[0,1,0] op_sel_hi:[1,1,1]
    ds_write_b128 v226, v[56:59] offset:49280
    v_pk_fma_f32 v[60:61], v[124:125], v[232:233], v[60:61] op_sel:[0,1,0] op_sel_hi:[1,1,1]
    v_pk_fma_f32 v[62:63], v[126:127], v[232:233], v[62:63] op_sel:[0,1,0] op_sel_hi:[1,1,1]
    ds_write_b128 v227, v[60:63] offset:49280
    s_waitcnt lgkmcnt(0)
    s_barrier
    ds_read_b128 v[128:131], v224 offset:32768
    ds_read_b128 v[132:135], v225 offset:32768
    ds_read_b128 v[136:139], v224 offset:36864
    ds_read_b128 v[140:143], v225 offset:36864
    ds_read_b128 v[144:147], v224 offset:40960
    ds_read_b128 v[148:151], v225 offset:40960
    ds_read_b128 v[152:155], v224 offset:45056
    ds_read_b128 v[156:159], v225 offset:45056
    s_waitcnt lgkmcnt(5)
    v_pk_add_f32 v[128:129], v[128:129], v[136:137]
    v_pk_add_f32 v[130:131], v[130:131], v[138:139]
    s_waitcnt lgkmcnt(4)
    v_pk_add_f32 v[132:133], v[132:133], v[140:141]
    v_pk_add_f32 v[134:135], v[134:135], v[142:143]
    s_waitcnt lgkmcnt(1)
    v_pk_add_f32 v[144:145], v[144:145], v[152:153]
    v_pk_add_f32 v[146:147], v[146:147], v[154:155]
    s_waitcnt lgkmcnt(0)
    v_pk_add_f32 v[148:149], v[148:149], v[156:157]
    v_pk_add_f32 v[150:151], v[150:151], v[158:159]
    v_pk_add_f32 v[128:129], v[128:129], v[144:145]
    v_pk_add_f32 v[130:131], v[130:131], v[146:147]
    v_pk_add_f32 v[132:133], v[132:133], v[148:149]
    v_pk_add_f32 v[134:135], v[134:135], v[150:151]
    v_cvt_pk_bf16_f32 v136, v128, v129
    v_cvt_pk_bf16_f32 v137, v130, v131
    v_cvt_pk_bf16_f32 v138, v132, v133
    v_cvt_pk_bf16_f32 v139, v134, v135
    buffer_store_dwordx4 v[136:139], v251, s[64:67], s74 offen sc1
    s_endpgm
L_end:
    s_endpgm
.section .rodata,"a"
.p2align 6
.amdhsa_kernel gated_mix__linear_kernel_hedgehog__glu_gated_bilinear__prompt_kernel
  .amdhsa_next_free_vgpr 512
  .amdhsa_next_free_sgpr 102
  .amdhsa_accum_offset 256
  .amdhsa_group_segment_fixed_size 0
  .amdhsa_kernarg_size 96
  .amdhsa_user_sgpr_count 2
  .amdhsa_user_sgpr_kernarg_segment_ptr 1
  .amdhsa_system_sgpr_workgroup_id_x 1
.end_amdhsa_kernel
```
